```python
import torch

def _softmax(x, axis=-1):
    return torch.softmax(x, dim=axis)
def _gelu(x):
    return torch.nn.functional.gelu(x, approximate="tanh")
def _silu(x):
    return torch.nn.functional.silu(x)
def _sigmoid(x):
    return torch.sigmoid(x)
def _layernorm(x, axis=-1, eps=1e-5):
    m = x.mean(dim=axis, keepdim=True)
    v = x.var(dim=axis, keepdim=True, unbiased=False)
    return (x - m) / torch.sqrt(v + eps)
def _scatter_add(tgt, idx, src, axis=0):
    return tgt.clone().index_add_(axis, idx, src)
def _segment_sum(src, seg, n):
    out = torch.zeros((n,) + src.shape[1:], dtype=src.dtype)
    return out.index_add_(0, seg, src)
def _pad(x, pw):
    flat = tuple(v for pair in reversed(pw) for v in pair)
    return torch.nn.functional.pad(x, flat)

kernel_name = 'interleave_layers__linear_attn_block__softmax_full_mha__prompt'

def setup_inputs():

    _w = (lambda a: (lambda t: t.to(torch.bfloat16) if t.is_floating_point() else t)(torch.as_tensor(a)))
    def _A_setup():
        B, S, D = 1, 2048, 640
        return {
            "x": _w((lambda *s: torch.randn(*s, dtype=torch.bfloat16) * 0.05)(B, S, D)),
            "wqkv": _w((lambda *s: torch.randn(*s, dtype=torch.bfloat16) * 0.05)(D, 3 * D)),
            "wo": _w((lambda *s: torch.randn(*s, dtype=torch.bfloat16) * 0.05)(D, D)),
        }
    _A_in = _A_setup()

    def _B_setup():
        B, S, D = 1, 2048, 640
        return {
            "x": _w((lambda *s: torch.randn(*s, dtype=torch.bfloat16) * 0.05)(B, S, D)),
            "wqkv": _w((lambda *s: torch.randn(*s, dtype=torch.bfloat16) * 0.1)(D, 3 * D)),
            "wo": _w((lambda *s: torch.randn(*s, dtype=torch.bfloat16) * 0.05)(D, D)),
        }
    _B_in = _B_setup()

    return {
        "A_x": _A_in["x"],
        "A_wqkv": _A_in["wqkv"],
        "A_wo": _A_in["wo"],
        "B_x": _B_in["x"],
        "B_wqkv": _B_in["wqkv"],
        "B_wo": _B_in["wo"],
    }

def reference(A_x, A_wqkv, A_wo, B_x, B_wqkv, B_wo):
    def _A_ref(x, wqkv, wo):
        B, S, D = x.shape
        H = 32; Dh = D // H
        qkv = (lambda x, *d: x.permute(*d))((x @ wqkv).reshape(B, S, 3, H, Dh), 2, 0, 3, 1, 4)
        q, k, v = qkv[0], qkv[1], qkv[2]
        phi = lambda t: torch.where(t > 0, t + 1, torch.exp(t)) + 1e-6
        pq, pk = phi(q), phi(k)
        kv = torch.einsum("bhsd,bhse->bhde", pk, v)
        z = torch.einsum("bhsd->bhd", pk)
        num = torch.einsum("bhqd,bhde->bhqe", pq, kv)
        den = torch.einsum("bhqd,bhd->bhq", pq, z)[..., None] + 1e-6
        o = num / den
        return (lambda x, *d: x.permute(*d))(o, 0, 2, 1, 3).reshape(B, S, D) @ wo

    def _B_ref(x, wqkv, wo):
        B, S, D = x.shape
        H = 32; Dh = D // H
        qkv = (lambda x, *d: x.permute(*d))((x @ wqkv).reshape(B, S, 3, H, Dh), 2, 0, 3, 1, 4)
        q, k, v = qkv[0], qkv[1], qkv[2]
        scale = Dh ** -0.5
        scores = torch.einsum("bhqd,bhkd->bhqk", q, k) * scale
        p = _softmax(scores, axis=-1)
        o = torch.einsum("bhqk,bhkd->bhqd", p, v)
        return (lambda x, *d: x.permute(*d))(o, 0, 2, 1, 3).reshape(B, S, D) @ wo

    x = A_x
    x = x + _A_ref(_layernorm(x, axis=-1), A_wqkv, A_wo)
    x = x + _B_ref(_layernorm(x, axis=-1), B_wqkv, B_wo)
    x = x + _A_ref(_layernorm(x, axis=-1), A_wqkv, A_wo)
    x = x + _B_ref(_layernorm(x, axis=-1), B_wqkv, B_wo)
    return x
```

```asm
; @launch grid=(256,1,1) block=(256,1,1) lds=163840
.amdgcn_target "amdgcn-amd-amdhsa--gfx950"
.text
.globl interleave_layers__linear_attn_block__softmax_full_mha__prompt_kernel
.p2align 8
.type interleave_layers__linear_attn_block__softmax_full_mha__prompt_kernel,@function
interleave_layers__linear_attn_block__softmax_full_mha__prompt_kernel:
    s_cmp_ge_u32 s2, 256
    s_cbranch_scc1 END
    s_load_dwordx2 s[8:9], s[0:1], 0
    s_load_dwordx2 s[32:33], s[0:1], 8
    s_load_dwordx2 s[34:35], s[0:1], 16
    s_load_dwordx2 s[36:37], s[0:1], 32
    s_load_dwordx2 s[38:39], s[0:1], 40
    s_load_dwordx2 s[20:21], s[0:1], 48
    s_load_dwordx2 s[28:29], s[0:1], 56
    s_load_dwordx2 s[24:25], s[0:1], 64
    v_lshrrev_b32 v1, 6, v0
    v_and_b32 v255, 63, v0
    s_mov_b32 s43, -1
    v_readfirstlane_b32 s42, v1
    s_mov_b32 s10, 2621440
    s_mov_b32 s11, 0x00020000
    s_mov_b32 s14, 2457600
    s_mov_b32 s15, 0x00020000
    s_mov_b32 s18, 819200
    s_mov_b32 s19, 0x00020000
    s_mov_b32 s22, 2621440
    s_mov_b32 s23, 0x00020000
    s_mov_b32 s26, 268435456
    s_mov_b32 s27, 0x00020000
    s_mov_b32 s30, 256
    s_mov_b32 s31, 0x00020000
    s_and_b32 s54, s2, 7
    s_lshr_b32 s54, s54, 2
    s_lshl_b32 s54, s54, 3
    s_lshr_b32 s55, s2, 5
    s_add_u32 s40, s54, s55
    s_and_b32 s54, s2, 3
    s_lshl_b32 s54, s54, 2
    s_bfe_u32 s55, s2, 0x20003
    s_add_u32 s41, s54, s55
    s_and_b32 s54, s41, 8
    s_xor_b32 s54, s54, s40
    s_and_b32 s55, s40, 8
    s_lshl1_add_u32 s91, s55, s54
    s_lshl2_add_u32 s91, s91, s42
    s_xor_b32 s54, s40, s41
    s_and_b32 s54, s54, 7
    s_cmp_gt_u32 s42, 1
    s_cselect_b32 s54, s54, s54
    s_xor_b32 s96, s40, s54
    s_xor_b32 s98, s41, s54
    s_lshr_b32 s54, s41, 3
    s_lshl_b32 s54, s54, 2
    s_lshl_b32 s55, s40, 3
    s_add_u32 s54, s54, s55
    s_add_u32 s63, s54, s42
    v_lshrrev_b32 v100, 5, v255
    v_bfe_u32 v101, v255, 4, 1
    v_lshl_add_u32 v106, v101, 1, v100
    v_and_b32 v107, 15, v255
    s_and_b32 s60, s41, 7
    s_mul_i32 s57, s63, 20480
    s_mul_i32 s61, s60, 160
    s_add_u32 s57, s57, s61
    v_mul_u32_u24 v7, 1280, v107
    v_lshl_add_u32 v7, v106, 4, v7
    v_lshl_add_u32 v6, v101, 31, v7
    v_mul_u32_u24 v8, 4370, v255
    v_lshrrev_b32 v8, 16, v8
    v_mul_u32_u24 v9, 15, v8
    v_sub_u32 v9, v255, v9
    v_lshrrev_b32 v10, 2, v9
    v_and_b32 v11, 3, v9
    v_lshrrev_b32 v12, 1, v11
    v_add_u32 v12, v11, v12
    v_cmp_gt_u32 vcc, 12, v9
    s_nop 1
    v_cndmask_b32 v10, v11, v10, vcc
    v_cndmask_b32 v12, 2, v12, vcc
    v_mul_u32_u24 v8, 15360, v8
    v_mul_u32_u24 v10, 1280, v10
    v_lshl_add_u32 v12, v12, 4, v10
    v_add_u32 v13, v8, v12
    v_lshlrev_b32 v252, 4, v255
    v_mul_u32_u24 v254, 256, v255
    v_mov_b32 v247, 1
    s_mul_i32 s70, s60, 0
    s_mul_i32 s54, s96, 10
    s_and_b32 s55, s42, 1
    s_mul_i32 s55, s55, 5
    s_add_u32 s62, s54, s55
    s_lshl_b32 s58, s70, 2
    s_add_u32 s58, s58, s62
    s_mul_i32 s59, s98, 80
    s_mul_i32 s70, s60, 0
    s_lshr_b32 s70, s70, 3
    s_waitcnt lgkmcnt(0)
    s_cmp_gt_u32 s42, 1
    s_cselect_b32 s12, s36, s32
    s_cselect_b32 s13, s37, s33
    s_mov_b32 s16, s34
    s_mov_b32 s17, s35
    s_mov_b32 s84, s38
    s_mov_b32 s85, s39
    s_mov_b32 s86, 819200
    s_mov_b32 s87, 0x00020000
    s_cmp_ge_u32 s2, 1
    s_cbranch_scc1 Z_1
    v_mov_b64 v[16:17], 0
    v_mov_b64 v[18:19], 0
    s_lshl2_add_u32 s54, s2, s42
    s_mul_i32 s54, s54, 4096
    s_add_u32 s54, s54, 1048576
    buffer_store_dwordx4 v[16:19], v252, s[24:27], s54 offen sc1
    s_add_u32 s54, s54, 1024
    buffer_store_dwordx4 v[16:19], v252, s[24:27], s54 offen sc1
    s_add_u32 s54, s54, 1024
    buffer_store_dwordx4 v[16:19], v252, s[24:27], s54 offen sc1
    s_add_u32 s54, s54, 1024
    buffer_store_dwordx4 v[16:19], v252, s[24:27], s54 offen sc1
    s_add_u32 s54, s54, 1024
Z_1:
    buffer_load_dwordx4 v[80:83], v7, s[8:11], s57 offen offset:0 nt
    buffer_load_dwordx4 v[84:87], v7, s[8:11], s57 offen offset:64 nt
    buffer_load_dwordx4 v[88:91], v6, s[8:11], s57 offen offset:128 nt
    s_mov_b32 s92, s62
    s_mov_b32 s95, s61
    v_add_u32 v13, s59, v13
    s_cmp_gt_u32 s42, 1
    s_cbranch_scc1 Z_2
    s_mov_b32 exec_hi, 0x0fffffff
    s_add_u32 s55, s92, 0
    s_lshr_b32 s54, s55, 2
    s_and_b32 s55, s55, 3
    s_lshl4_add_u32 s54, s54, s55
    s_mul_i32 s54, s54, 3840
    buffer_load_dwordx4 v[32:35], v13, s[12:15], s54 offen nt
    s_add_u32 s55, s92, 1
    s_lshr_b32 s54, s55, 2
    s_and_b32 s55, s55, 3
    s_lshl4_add_u32 s54, s54, s55
    s_mul_i32 s54, s54, 3840
    buffer_load_dwordx4 v[36:39], v13, s[12:15], s54 offen nt
    s_add_u32 s55, s92, 2
    s_lshr_b32 s54, s55, 2
    s_and_b32 s55, s55, 3
    s_lshl4_add_u32 s54, s54, s55
    s_mul_i32 s54, s54, 3840
    buffer_load_dwordx4 v[40:43], v13, s[12:15], s54 offen nt
    s_add_u32 s55, s92, 3
    s_lshr_b32 s54, s55, 2
    s_and_b32 s55, s55, 3
    s_lshl4_add_u32 s54, s54, s55
    s_mul_i32 s54, s54, 3840
    buffer_load_dwordx4 v[44:47], v13, s[12:15], s54 offen nt
    s_add_u32 s55, s92, 4
    s_lshr_b32 s54, s55, 2
    s_and_b32 s55, s55, 3
    s_lshl4_add_u32 s54, s54, s55
    s_mul_i32 s54, s54, 3840
    buffer_load_dwordx4 v[48:51], v13, s[12:15], s54 offen nt
    s_mov_b32 exec_hi, -1
Z_2:
    s_lshl_b32 s54, s91, 6
    s_add_u32 s54, s54, 0
    v_add_u32 v8, s54, v255
    v_mul_u32_u24 v9, 6554, v8
    v_lshrrev_b32 v9, 16, v9
    v_mul_u32_u24 v10, 10, v9
    v_sub_u32 v10, v8, v10
    v_and_b32 v11, 0xfff3, v9
    v_and_b32 v12, 4, v9
    v_lshl_add_u32 v11, v12, 1, v11
    v_and_b32 v12, 8, v9
    v_lshrrev_b32 v12, 1, v12
    v_add_u32 v11, v11, v12
    v_mul_u32_u24 v11, 1280, v11
    v_lshl_add_u32 v14, v10, 4, v11
    buffer_load_dwordx4 v[52:55], v14, s[16:19], s95 offen nt
    s_cmp_ge_u32 s2, 1
    s_cbranch_scc1 Z_3
    s_mov_b64 exec, 1
    s_waitcnt vmcnt(9)
    s_cmp_lt_u32 s42, 2
    s_cbranch_scc1 Z_3a
    s_waitcnt vmcnt(4)
Z_3a:
    buffer_atomic_add v247, off, s[28:31], 0 sc1
    s_mov_b64 exec, -1
Z_3:
    s_mov_b32 s44, 0
    s_mov_b32 s45, 0
    s_mul_i32 s76, s40, 512
    s_add_u32 s76, s76, 1048576
    s_mov_b32 s77, s76
    s_lshr_b32 s46, s41, 3
    s_mul_i32 s46, s46, 256
    s_add_u32 s46, s46, s76
    s_mov_b32 s49, s46
    s_mul_i32 s47, s41, 512
    s_add_u32 s47, s47, 1056768
    s_lshr_b32 s51, s40, 3
    s_mul_i32 s51, s51, 256
    s_add_u32 s51, s51, s47
    s_mov_b32 s48, 400000
    s_mov_b32 s52, 0
    s_mov_b32 s53, -1
    s_mul_i32 s68, s41, 153600
    s_add_u32 s68, s68, 58720256
    s_mul_i32 s69, s60, 102400
    s_add_u32 s69, s69, 39845888
    v_mul_u32_u24 v8, 20480, v101
    v_lshl_add_u32 v8, v100, 8, v8
    v_lshl_add_u32 v253, v107, 4, v8
    v_lshrrev_b32 v8, 2, v107
    v_lshlrev_b32 v8, 1, v8
    v_add_u32 v8, v8, v100
    v_mul_u32_u24 v8, 480, v8
    v_lshl_add_u32 v8, v101, 5, v8
    v_and_b32 v9, 3, v255
    v_lshl_add_u32 v251, v9, 3, v8
    v_add_u32 v250, 61440, v251
    v_add_u32 v249, 102400, v251
    s_mov_b32 s54, 0x00100001
    s_mov_b32 s55, 0x00100001
    v_mov_b32 v9, 0x3f803f80
    v_cndmask_b32_e64 v8, 0, v9, s[54:55]
    v_accvgpr_write_b32 a208, v8
    v_accvgpr_write_b32 a209, v8
    v_accvgpr_write_b32 a210, v8
    v_accvgpr_write_b32 a211, v8
    s_mul_i32 s54, s62, 960
    s_mul_i32 s55, s98, 153600
    s_add_u32 s54, s54, s55
    s_add_u32 s54, s54, 58720256
    s_mul_i32 s90, s98, 512
    s_add_u32 s90, s90, 1056768
    s_add_u32 s88, s90, 128
    s_lshr_b32 s55, s42, 1
    s_mul_i32 s55, s55, 4194304
    s_add_u32 s93, s54, s55
    s_lshl_b32 s55, s91, 10
    s_add_u32 s94, s69, s55
    s_sub_u32 s94, s94, 2097152
    s_xor_b32 s89, s47, 4096
    s_waitcnt vmcnt(0)
    s_cmp_gt_u32 s42, 1
    s_cbranch_scc1 Z_4
    s_mov_b32 exec_hi, 0x0fffffff
    buffer_store_dwordx4 v[32:35], v252, s[24:27], s93 offen offset:0 sc1
    buffer_store_dwordx4 v[36:39], v252, s[24:27], s93 offen offset:960 sc1
    buffer_store_dwordx4 v[40:43], v252, s[24:27], s93 offen offset:1920 sc1
    buffer_store_dwordx4 v[44:47], v252, s[24:27], s93 offen offset:2880 sc1
    buffer_store_dwordx4 v[48:51], v252, s[24:27], s93 offen offset:3840 sc1
    s_mov_b32 exec_hi, -1
Z_4:
    s_cmp_ge_u32 s91, 100
    s_cbranch_scc1 Z_4a
    buffer_store_dwordx4 v[52:55], v252, s[24:27], s94 offen sc1
Z_4a:
    v_permlane16_swap_b32 v80, v82
    v_permlane16_swap_b32 v81, v83
    v_permlane16_swap_b32 v84, v86
    v_permlane16_swap_b32 v85, v87
    v_permlane16_swap_b32 v88, v90
    v_permlane16_swap_b32 v89, v91
    v_lshlrev_b32 v8, 16, v80
    v_and_b32 v9, 0xffff0000, v80
    v_accvgpr_write_b32 a236, v8
    v_accvgpr_write_b32 a237, v9
    v_lshlrev_b32 v8, 16, v81
    v_and_b32 v9, 0xffff0000, v81
    v_accvgpr_write_b32 a238, v8
    v_accvgpr_write_b32 a239, v9
    v_lshlrev_b32 v8, 16, v82
    v_and_b32 v9, 0xffff0000, v82
    v_accvgpr_write_b32 a240, v8
    v_accvgpr_write_b32 a241, v9
    v_lshlrev_b32 v8, 16, v83
    v_and_b32 v9, 0xffff0000, v83
    v_accvgpr_write_b32 a242, v8
    v_accvgpr_write_b32 a243, v9
    v_lshlrev_b32 v8, 16, v84
    v_and_b32 v9, 0xffff0000, v84
    v_accvgpr_write_b32 a244, v8
    v_accvgpr_write_b32 a245, v9
    v_lshlrev_b32 v8, 16, v85
    v_and_b32 v9, 0xffff0000, v85
    v_accvgpr_write_b32 a246, v8
    v_accvgpr_write_b32 a247, v9
    v_lshlrev_b32 v8, 16, v86
    v_and_b32 v9, 0xffff0000, v86
    v_accvgpr_write_b32 a248, v8
    v_accvgpr_write_b32 a249, v9
    v_lshlrev_b32 v8, 16, v87
    v_and_b32 v9, 0xffff0000, v87
    v_accvgpr_write_b32 a250, v8
    v_accvgpr_write_b32 a251, v9
    v_lshlrev_b32 v8, 16, v88
    v_and_b32 v9, 0xffff0000, v88
    v_accvgpr_write_b32 a252, v8
    v_accvgpr_write_b32 a253, v9
    v_lshlrev_b32 v8, 16, v89
    v_and_b32 v9, 0xffff0000, v89
    v_accvgpr_write_b32 a254, v8
    v_accvgpr_write_b32 a255, v9
    s_branch XEPI
QKV_GEN:
    s_lshl_b32 s54, s40, 2
    s_add_u32 s54, s54, s42
    s_lshl_b32 s55, s54, 11
    s_mul_i32 s56, s43, 131072
    s_add_u32 s55, s55, s56
    s_add_u32 s63, s55, 19922944
    s_mul_i32 s54, s54, 40960
    s_mul_i32 s56, s43, 2621440
    s_add_u32 s54, s54, s56
    s_add_u32 s60, s54, 0x2a80000
    v_and_b32 v232, 31, v255
    v_lshrrev_b32 v233, 5, v255
    v_lshlrev_b32 v232, 3, v232
    v_lshl_add_u32 v232, v233, 10, v232
    s_mul_i32 s54, s42, 15360
    s_add_u32 m0, s54, 33792
    s_xor_b32 s71, s68, 4194304
    s_add_u32 s71, s54, s71
    s_add_u32 s71, s71, 33792
    s_cmp_gt_u32 s42, 0
    s_cbranch_scc1 PX_7
    s_mov_b64 exec, 1
PL_5:
    v_mov_b32 v246, 0
    buffer_atomic_add v246, off, s[24:27], s46 sc0 sc1
    s_waitcnt vmcnt(0)
    v_cmp_gt_u32 vcc, s44, v246
    s_nop 4
    s_cbranch_vccz PD_6
    s_sub_u32 s48, s48, 1
    s_cmp_gt_i32 s48, 0
    s_cbranch_scc1 PL_5
    s_mov_b64 exec, -1
PX_7:
    buffer_load_dwordx4 v252, s[24:27], s71 offen offset:0 sc1 lds
    buffer_load_dwordx4 v252, s[24:27], s71 offen offset:1024 sc1 lds
    buffer_load_dwordx4 v252, s[24:27], s71 offen offset:2048 sc1 lds
    buffer_load_dwordx4 v252, s[24:27], s71 offen offset:3072 sc1 lds
    s_add_u32 m0, m0, 4096
    s_add_u32 s71, s71, 4096
    buffer_load_dwordx4 v252, s[24:27], s71 offen offset:0 sc1 lds
    buffer_load_dwordx4 v252, s[24:27], s71 offen offset:1024 sc1 lds
    buffer_load_dwordx4 v252, s[24:27], s71 offen offset:2048 sc1 lds
    buffer_load_dwordx4 v252, s[24:27], s71 offen offset:3072 sc1 lds
    s_add_u32 m0, m0, 4096
    s_add_u32 s71, s71, 4096
    buffer_load_dwordx4 v252, s[24:27], s71 offen offset:0 sc1 lds
    buffer_load_dwordx4 v252, s[24:27], s71 offen offset:1024 sc1 lds
    buffer_load_dwordx4 v252, s[24:27], s71 offen offset:2048 sc1 lds
    buffer_load_dwordx4 v252, s[24:27], s71 offen offset:3072 sc1 lds
    s_add_u32 m0, m0, 4096
    s_add_u32 s71, s71, 4096
    buffer_load_dwordx4 v252, s[24:27], s71 offen offset:0 sc1 lds
    buffer_load_dwordx4 v252, s[24:27], s71 offen offset:1024 sc1 lds
    buffer_load_dwordx4 v252, s[24:27], s71 offen offset:2048 sc1 lds
PD_6:
    s_mov_b64 exec, -1
    s_cmp_eq_u32 s43, 1
    s_cbranch_scc1 QKV_1
    s_cmp_eq_u32 s43, 2
    s_cbranch_scc1 QKV_2
    s_cmp_eq_u32 s43, 3
    s_cbranch_scc1 QKV_3
QKV_0:
    s_mul_i32 s54, s42, 3840
    v_add_u32 v236, s54, v251
    v_add_u32 v237, s54, v249
    v_add_u32 v239, s54, v250
    s_lshl_b32 s54, s42, 9
    s_add_u32 s54, s54, 65536
    v_add_u32 v238, s54, v252
    s_waitcnt vmcnt(15)
    s_cmp_lt_u32 s42, 2
    s_cbranch_scc1 Z_8
    s_waitcnt vmcnt(63)
    s_mov_b32 exec_hi, 0x0fffffff
    buffer_store_dwordx4 v[32:35], v252, s[24:27], s93 offen offset:0 sc1
    buffer_store_dwordx4 v[36:39], v252, s[24:27], s93 offen offset:960 sc1
    buffer_store_dwordx4 v[40:43], v252, s[24:27], s93 offen offset:1920 sc1
    buffer_store_dwordx4 v[44:47], v252, s[24:27], s93 offen offset:2880 sc1
    buffer_store_dwordx4 v[48:51], v252, s[24:27], s93 offen offset:3840 sc1
    s_mov_b32 exec_hi, -1
    s_cmp_ge_u32 s91, 100
    s_cbranch_scc1 Z_8
    s_add_u32 s94, s94, 2095104
    buffer_store_dwordx4 v[52:55], v252, s[24:27], s94 offen offset:2048 sc1
    buffer_store_dwordx4 v[56:59], v252, s[24:27], s94 offen sc1
Z_8:
    s_barrier
    buffer_load_dwordx2 v[224:225], v232, s[24:27], s63 offen offset:0 sc1
    buffer_load_dwordx2 v[226:227], v232, s[24:27], s63 offen offset:256 sc1
    buffer_load_dwordx2 v[228:229], v232, s[24:27], s63 offen offset:512 sc1
    buffer_load_dwordx2 v[230:231], v232, s[24:27], s63 offen offset:768 sc1
    buffer_load_dwordx4 v[64:67], v253, s[24:27], s60 offen offset:0 sc1
    buffer_load_dwordx4 v[68:71], v253, s[24:27], s60 offen offset:512 sc1
    buffer_load_dwordx4 v[72:75], v253, s[24:27], s60 offen offset:1024 sc1
    buffer_load_dwordx4 v[76:79], v253, s[24:27], s60 offen offset:1536 sc1
    buffer_load_dwordx4 v[80:83], v253, s[24:27], s60 offen offset:2048 sc1
    s_add_u32 s60, s60, 2560
    buffer_load_dwordx4 v[84:87], v253, s[24:27], s60 offen offset:0 sc1
    buffer_load_dwordx4 v[88:91], v253, s[24:27], s60 offen offset:512 sc1
    buffer_load_dwordx4 v[92:95], v253, s[24:27], s60 offen offset:1024 sc1
    ds_read_b64_tr_b16 a[64:65], v236 offset:0
    ds_read_b64_tr_b16 a[66:67], v236 offset:240
    ds_read_b64_tr_b16 a[68:69], v236 offset:64
    ds_read_b64_tr_b16 a[70:71], v236 offset:304
    ds_read_b64_tr_b16 a[72:73], v236 offset:128
    ds_read_b64_tr_b16 a[74:75], v236 offset:368
    ds_read_b64_tr_b16 a[76:77], v236 offset:176
    ds_read_b64_tr_b16 a[78:79], v236 offset:416
    ds_read_b64_tr_b16 a[80:81], v236 offset:15360
    ds_read_b64_tr_b16 a[82:83], v236 offset:15600
    ds_read_b64_tr_b16 a[84:85], v236 offset:15424
    ds_read_b64_tr_b16 a[86:87], v236 offset:15664
    ds_read_b64_tr_b16 a[88:89], v236 offset:15488
    ds_read_b64_tr_b16 a[90:91], v236 offset:15728
    s_waitcnt lgkmcnt(12)
    v_mfma_f32_16x16x32_bf16 a[48:51], a[208:211], a[64:67], 0
    ds_read_b64_tr_b16 a[92:93], v236 offset:15536
    ds_read_b64_tr_b16 a[94:95], v236 offset:15776
    s_waitcnt lgkmcnt(12)
    v_mfma_f32_16x16x32_bf16 a[52:55], a[208:211], a[68:71], 0
    ds_read_b64_tr_b16 a[64:65], v236 offset:30720
    ds_read_b64_tr_b16 a[66:67], v236 offset:30960
    s_waitcnt lgkmcnt(12)
    v_mfma_f32_16x16x32_bf16 a[56:59], a[208:211], a[72:75], 0
    ds_read_b64_tr_b16 a[68:69], v236 offset:30784
    ds_read_b64_tr_b16 a[70:71], v236 offset:31024
    s_waitcnt lgkmcnt(12)
    v_mfma_f32_16x16x32_bf16 a[60:63], a[208:211], a[76:79], 0
    ds_read_b64_tr_b16 a[72:73], v236 offset:30848
    ds_read_b64_tr_b16 a[74:75], v236 offset:31088
    s_waitcnt lgkmcnt(12)
    v_mfma_f32_16x16x32_bf16 a[48:51], a[208:211], a[80:83], a[48:51]
    ds_read_b64_tr_b16 a[76:77], v236 offset:30896
    ds_read_b64_tr_b16 a[78:79], v236 offset:31136
    s_waitcnt lgkmcnt(12)
    v_mfma_f32_16x16x32_bf16 a[52:55], a[208:211], a[84:87], a[52:55]
    s_waitcnt lgkmcnt(10)
    v_mfma_f32_16x16x32_bf16 a[56:59], a[208:211], a[88:91], a[56:59]
    s_waitcnt lgkmcnt(8)
    v_mfma_f32_16x16x32_bf16 a[60:63], a[208:211], a[92:95], a[60:63]
    s_waitcnt lgkmcnt(6)
    v_mfma_f32_16x16x32_bf16 a[48:51], a[208:211], a[64:67], a[48:51]
    s_waitcnt lgkmcnt(4)
    v_mfma_f32_16x16x32_bf16 a[52:55], a[208:211], a[68:71], a[52:55]
    s_waitcnt lgkmcnt(2)
    v_mfma_f32_16x16x32_bf16 a[56:59], a[208:211], a[72:75], a[56:59]
    s_waitcnt lgkmcnt(0)
    v_mfma_f32_16x16x32_bf16 a[60:63], a[208:211], a[76:79], a[60:63]
    ds_read_b64_tr_b16 a[0:1], v251 offset:0
    ds_read_b64_tr_b16 a[2:3], v251 offset:240
    ds_read_b64_tr_b16 a[4:5], v251 offset:64
    ds_read_b64_tr_b16 a[6:7], v251 offset:304
    ds_read_b64_tr_b16 a[8:9], v251 offset:128
    ds_read_b64_tr_b16 a[10:11], v251 offset:368
    ds_read_b64_tr_b16 a[12:13], v251 offset:176
    ds_read_b64_tr_b16 a[14:15], v251 offset:416
    ds_read_b64_tr_b16 a[16:17], v251 offset:3840
    ds_read_b64_tr_b16 a[18:19], v251 offset:4080
    ds_read_b64_tr_b16 a[20:21], v251 offset:3904
    ds_read_b64_tr_b16 a[22:23], v251 offset:4144
    ds_read_b64_tr_b16 a[24:25], v251 offset:3968
    ds_read_b64_tr_b16 a[26:27], v251 offset:4208
    ds_read_b64_tr_b16 a[28:29], v251 offset:4016
    ds_read_b64_tr_b16 a[30:31], v251 offset:4256
    s_mul_i32 s54, s42, 15360
    s_add_u32 m0, s54, 102400
    s_xor_b32 s71, s68, 4194304
    s_add_u32 s71, s54, s71
    s_add_u32 s71, s71, 92160
    s_waitcnt vmcnt(7) lgkmcnt(14)
    v_mfma_f32_32x32x16_bf16 v[0:15], a[0:3], v[64:67], 0
    buffer_load_dwordx4 v[96:99], v253, s[24:27], s60 offen offset:1536 sc1
    ds_read_b64_tr_b16 a[32:33], v251 offset:7680
    ds_read_b64_tr_b16 a[34:35], v251 offset:7920
    s_waitcnt lgkmcnt(14)
    v_mfma_f32_32x32x16_bf16 v[16:31], a[4:7], v[64:67], 0
    ds_read_b64_tr_b16 a[36:37], v251 offset:7744
    ds_read_b64_tr_b16 a[38:39], v251 offset:7984
    s_waitcnt lgkmcnt(14)
    v_mfma_f32_32x32x16_bf16 v[32:47], a[8:11], v[64:67], 0
    buffer_load_dwordx4 v252, s[24:27], s71 offen offset:0 sc1 lds
    ds_read_b64_tr_b16 a[40:41], v251 offset:7808
    ds_read_b64_tr_b16 a[42:43], v251 offset:8048
    s_waitcnt lgkmcnt(14)
    v_mfma_f32_32x32x16_bf16 v[48:63], a[12:15], v[64:67], 0
    ds_read_b64_tr_b16 a[44:45], v251 offset:7856
    ds_read_b64_tr_b16 a[46:47], v251 offset:8096
    s_waitcnt vmcnt(8) lgkmcnt(14)
    v_mfma_f32_32x32x16_bf16 v[0:15], a[16:19], v[68:71], v[0:15]
    buffer_load_dwordx4 v[100:103], v253, s[24:27], s60 offen offset:2048 sc1
    ds_read_b64_tr_b16 a[0:1], v251 offset:11520
    ds_read_b64_tr_b16 a[2:3], v251 offset:11760
    s_waitcnt lgkmcnt(14)
    v_mfma_f32_32x32x16_bf16 v[16:31], a[20:23], v[68:71], v[16:31]
    ds_read_b64_tr_b16 a[4:5], v251 offset:11584
    ds_read_b64_tr_b16 a[6:7], v251 offset:11824
    s_waitcnt lgkmcnt(14)
    v_mfma_f32_32x32x16_bf16 v[32:47], a[24:27], v[68:71], v[32:47]
    buffer_load_dwordx4 v252, s[24:27], s71 offen offset:1024 sc1 lds
    ds_read_b64_tr_b16 a[8:9], v251 offset:11648
    ds_read_b64_tr_b16 a[10:11], v251 offset:11888
    s_waitcnt lgkmcnt(14)
    v_mfma_f32_32x32x16_bf16 v[48:63], a[28:31], v[68:71], v[48:63]
    ds_read_b64_tr_b16 a[12:13], v251 offset:11696
    ds_read_b64_tr_b16 a[14:15], v251 offset:11936
    s_waitcnt vmcnt(9) lgkmcnt(14)
    v_mfma_f32_32x32x16_bf16 v[0:15], a[32:35], v[72:75], v[0:15]
    s_add_u32 s60, s60, 2560
    buffer_load_dwordx4 v[104:107], v253, s[24:27], s60 offen offset:0 sc1
    ds_read_b64_tr_b16 a[16:17], v251 offset:15360
    ds_read_b64_tr_b16 a[18:19], v251 offset:15600
    s_waitcnt lgkmcnt(14)
    v_mfma_f32_32x32x16_bf16 v[16:31], a[36:39], v[72:75], v[16:31]
    ds_read_b64_tr_b16 a[20:21], v251 offset:15424
    ds_read_b64_tr_b16 a[22:23], v251 offset:15664
    v_pk_add_f32 v[224:225], v[224:225], v[226:227]
    s_waitcnt lgkmcnt(14)
    v_mfma_f32_32x32x16_bf16 v[32:47], a[40:43], v[72:75], v[32:47]
    buffer_load_dwordx4 v252, s[24:27], s71 offen offset:2048 sc1 lds
    ds_read_b64_tr_b16 a[24:25], v251 offset:15488
    ds_read_b64_tr_b16 a[26:27], v251 offset:15728
    v_pk_add_f32 v[228:229], v[228:229], v[230:231]
    s_waitcnt lgkmcnt(14)
    v_mfma_f32_32x32x16_bf16 v[48:63], a[44:47], v[72:75], v[48:63]
    ds_read_b64_tr_b16 a[28:29], v251 offset:15536
    ds_read_b64_tr_b16 a[30:31], v251 offset:15776
    s_waitcnt vmcnt(10) lgkmcnt(14)
    v_mfma_f32_32x32x16_bf16 v[0:15], a[0:3], v[76:79], v[0:15]
    buffer_load_dwordx4 v[108:111], v253, s[24:27], s60 offen offset:512 sc1
    ds_read_b64_tr_b16 a[32:33], v251 offset:19200
    ds_read_b64_tr_b16 a[34:35], v251 offset:19440
    s_waitcnt lgkmcnt(14)
    v_mfma_f32_32x32x16_bf16 v[16:31], a[4:7], v[76:79], v[16:31]
    ds_read_b64_tr_b16 a[36:37], v251 offset:19264
    ds_read_b64_tr_b16 a[38:39], v251 offset:19504
    v_pk_add_f32 v[240:241], v[224:225], v[228:229]
    s_waitcnt lgkmcnt(14)
    v_mfma_f32_32x32x16_bf16 v[32:47], a[8:11], v[76:79], v[32:47]
    buffer_load_dwordx4 v252, s[24:27], s71 offen offset:3072 sc1 lds
    s_add_u32 m0, m0, 4096
    s_add_u32 s71, s71, 4096
    ds_read_b64_tr_b16 a[40:41], v251 offset:19328
    ds_read_b64_tr_b16 a[42:43], v251 offset:19568
    v_mov_b32 v224, v240
    s_waitcnt lgkmcnt(14)
    v_mfma_f32_32x32x16_bf16 v[48:63], a[12:15], v[76:79], v[48:63]
    ds_read_b64_tr_b16 a[44:45], v251 offset:19376
    ds_read_b64_tr_b16 a[46:47], v251 offset:19616
    s_waitcnt vmcnt(11) lgkmcnt(14)
    v_mfma_f32_32x32x16_bf16 v[0:15], a[16:19], v[80:83], v[0:15]
    buffer_load_dwordx4 v[112:115], v253, s[24:27], s60 offen offset:1024 sc1
    ds_read_b64_tr_b16 a[0:1], v251 offset:23040
    ds_read_b64_tr_b16 a[2:3], v251 offset:23280
    s_waitcnt lgkmcnt(14)
    v_mfma_f32_32x32x16_bf16 v[16:31], a[20:23], v[80:83], v[16:31]
    ds_read_b64_tr_b16 a[4:5], v251 offset:23104
    ds_read_b64_tr_b16 a[6:7], v251 offset:23344
    v_mov_b32 v225, v241
    s_waitcnt lgkmcnt(14)
    v_mfma_f32_32x32x16_bf16 v[32:47], a[24:27], v[80:83], v[32:47]
    buffer_load_dwordx4 v252, s[24:27], s71 offen offset:0 sc1 lds
    ds_read_b64_tr_b16 a[8:9], v251 offset:23168
    ds_read_b64_tr_b16 a[10:11], v251 offset:23408
    v_permlane32_swap_b32 v240, v224
    s_waitcnt lgkmcnt(14)
    v_mfma_f32_32x32x16_bf16 v[48:63], a[28:31], v[80:83], v[48:63]
    ds_read_b64_tr_b16 a[12:13], v251 offset:23216
    ds_read_b64_tr_b16 a[14:15], v251 offset:23456
    s_waitcnt vmcnt(12) lgkmcnt(14)
    v_mfma_f32_32x32x16_bf16 v[0:15], a[32:35], v[84:87], v[0:15]
    buffer_load_dwordx4 v[116:119], v253, s[24:27], s60 offen offset:1536 sc1
    ds_read_b64_tr_b16 a[16:17], v251 offset:26880
    ds_read_b64_tr_b16 a[18:19], v251 offset:27120
    s_waitcnt lgkmcnt(14)
    v_mfma_f32_32x32x16_bf16 v[16:31], a[36:39], v[84:87], v[16:31]
    ds_read_b64_tr_b16 a[20:21], v251 offset:26944
    ds_read_b64_tr_b16 a[22:23], v251 offset:27184
    v_permlane32_swap_b32 v241, v225
    s_waitcnt lgkmcnt(14)
    v_mfma_f32_32x32x16_bf16 v[32:47], a[40:43], v[84:87], v[32:47]
    buffer_load_dwordx4 v252, s[24:27], s71 offen offset:1024 sc1 lds
    ds_read_b64_tr_b16 a[24:25], v251 offset:27008
    ds_read_b64_tr_b16 a[26:27], v251 offset:27248
    v_add_f32 v240, v240, v224
    s_waitcnt lgkmcnt(14)
    v_mfma_f32_32x32x16_bf16 v[48:63], a[44:47], v[84:87], v[48:63]
    ds_read_b64_tr_b16 a[28:29], v251 offset:27056
    ds_read_b64_tr_b16 a[30:31], v251 offset:27296
    s_waitcnt vmcnt(13) lgkmcnt(14)
    v_mfma_f32_32x32x16_bf16 v[0:15], a[0:3], v[88:91], v[0:15]
    buffer_load_dwordx4 v[120:123], v253, s[24:27], s60 offen offset:2048 sc1
    ds_read_b64_tr_b16 a[32:33], v251 offset:30720
    ds_read_b64_tr_b16 a[34:35], v251 offset:30960
    s_waitcnt lgkmcnt(14)
    v_mfma_f32_32x32x16_bf16 v[16:31], a[4:7], v[88:91], v[16:31]
    ds_read_b64_tr_b16 a[36:37], v251 offset:30784
    ds_read_b64_tr_b16 a[38:39], v251 offset:31024
    v_add_f32 v241, v241, v225
    s_waitcnt lgkmcnt(14)
    v_mfma_f32_32x32x16_bf16 v[32:47], a[8:11], v[88:91], v[32:47]
    buffer_load_dwordx4 v252, s[24:27], s71 offen offset:2048 sc1 lds
    ds_read_b64_tr_b16 a[40:41], v251 offset:30848
    ds_read_b64_tr_b16 a[42:43], v251 offset:31088
    v_mul_f32 v240, 0x3acccccd, v240
    s_waitcnt lgkmcnt(14)
    v_mfma_f32_32x32x16_bf16 v[48:63], a[12:15], v[88:91], v[48:63]
    ds_read_b64_tr_b16 a[44:45], v251 offset:30896
    ds_read_b64_tr_b16 a[46:47], v251 offset:31136
    s_waitcnt vmcnt(14) lgkmcnt(14)
    v_mfma_f32_32x32x16_bf16 v[0:15], a[16:19], v[92:95], v[0:15]
    s_add_u32 s60, s60, 2560
    buffer_load_dwordx4 v[124:127], v253, s[24:27], s60 offen offset:0 sc1
    ds_read_b64_tr_b16 a[0:1], v251 offset:34560
    ds_read_b64_tr_b16 a[2:3], v251 offset:34800
    s_waitcnt lgkmcnt(14)
    v_mfma_f32_32x32x16_bf16 v[16:31], a[20:23], v[92:95], v[16:31]
    ds_read_b64_tr_b16 a[4:5], v251 offset:34624
    ds_read_b64_tr_b16 a[6:7], v251 offset:34864
    v_mul_f32 v241, 0x3acccccd, v241
    s_waitcnt lgkmcnt(14)
    v_mfma_f32_32x32x16_bf16 v[32:47], a[24:27], v[92:95], v[32:47]
    buffer_load_dwordx4 v252, s[24:27], s71 offen offset:3072 sc1 lds
    s_add_u32 m0, m0, 4096
    s_add_u32 s71, s71, 4096
    ds_read_b64_tr_b16 a[8:9], v251 offset:34688
    ds_read_b64_tr_b16 a[10:11], v251 offset:34928
    v_fma_f32 v241, -v240, v240, v241
    s_waitcnt lgkmcnt(14)
    v_mfma_f32_32x32x16_bf16 v[48:63], a[28:31], v[92:95], v[48:63]
    ds_read_b64_tr_b16 a[12:13], v251 offset:34736
    ds_read_b64_tr_b16 a[14:15], v251 offset:34976
    s_waitcnt vmcnt(15) lgkmcnt(14)
    v_mfma_f32_32x32x16_bf16 v[0:15], a[32:35], v[96:99], v[0:15]
    buffer_load_dwordx4 v[128:131], v253, s[24:27], s60 offen offset:512 sc1
    ds_read_b64_tr_b16 a[16:17], v251 offset:38400
    ds_read_b64_tr_b16 a[18:19], v251 offset:38640
    s_waitcnt lgkmcnt(14)
    v_mfma_f32_32x32x16_bf16 v[16:31], a[36:39], v[96:99], v[16:31]
    ds_read_b64_tr_b16 a[20:21], v251 offset:38464
    ds_read_b64_tr_b16 a[22:23], v251 offset:38704
    v_max_f32 v241, 0, v241
    s_waitcnt lgkmcnt(14)
    v_mfma_f32_32x32x16_bf16 v[32:47], a[40:43], v[96:99], v[32:47]
    buffer_load_dwordx4 v252, s[24:27], s71 offen offset:0 sc1 lds
    ds_read_b64_tr_b16 a[24:25], v251 offset:38528
    ds_read_b64_tr_b16 a[26:27], v251 offset:38768
    v_add_f32 v241, 0x3727c5ac, v241
    s_waitcnt lgkmcnt(14)
    v_mfma_f32_32x32x16_bf16 v[48:63], a[44:47], v[96:99], v[48:63]
    ds_read_b64_tr_b16 a[28:29], v251 offset:38576
    ds_read_b64_tr_b16 a[30:31], v251 offset:38816
    s_waitcnt vmcnt(15) lgkmcnt(14)
    v_mfma_f32_32x32x16_bf16 v[0:15], a[0:3], v[100:103], v[0:15]
    buffer_load_dwordx4 v[132:135], v253, s[24:27], s60 offen offset:1024 sc1
    ds_read_b64_tr_b16 a[32:33], v251 offset:42240
    ds_read_b64_tr_b16 a[34:35], v251 offset:42480
    s_waitcnt lgkmcnt(14)
    v_mfma_f32_32x32x16_bf16 v[16:31], a[4:7], v[100:103], v[16:31]
    ds_read_b64_tr_b16 a[36:37], v251 offset:42304
    ds_read_b64_tr_b16 a[38:39], v251 offset:42544
    v_rsq_f32 v242, v241
    s_waitcnt lgkmcnt(14)
    v_mfma_f32_32x32x16_bf16 v[32:47], a[8:11], v[100:103], v[32:47]
    buffer_load_dwordx4 v252, s[24:27], s71 offen offset:1024 sc1 lds
    ds_read_b64_tr_b16 a[40:41], v251 offset:42368
    ds_read_b64_tr_b16 a[42:43], v251 offset:42608
    v_and_b32 v224, 0xffff0000, v240
    s_waitcnt lgkmcnt(14)
    v_mfma_f32_32x32x16_bf16 v[48:63], a[12:15], v[100:103], v[48:63]
    ds_read_b64_tr_b16 a[44:45], v251 offset:42416
    ds_read_b64_tr_b16 a[46:47], v251 offset:42656
    s_barrier
    s_add_u32 s100, s100, 16
    v_mov_b32 v247, 1
    s_waitcnt vmcnt(63)
    s_cmp_lg_u32 s42, 0
    s_cbranch_scc1 SG_9
    s_mov_b64 exec, 0x3
    buffer_atomic_add v247, v254, s[24:27], s88 offen sc1
    s_mov_b64 exec, -1
SG_9:
    s_waitcnt vmcnt(15) lgkmcnt(14)
    v_mfma_f32_32x32x16_bf16 v[0:15], a[16:19], v[104:107], v[0:15]
    buffer_load_dwordx4 v[136:139], v253, s[24:27], s60 offen offset:1536 sc1
    ds_read_b64_tr_b16 a[0:1], v251 offset:46080
    ds_read_b64_tr_b16 a[2:3], v251 offset:46320
    s_waitcnt lgkmcnt(14)
    v_mfma_f32_32x32x16_bf16 v[16:31], a[20:23], v[104:107], v[16:31]
    ds_read_b64_tr_b16 a[4:5], v251 offset:46144
    ds_read_b64_tr_b16 a[6:7], v251 offset:46384
    ds_read_b64_tr_b16 a[80:81], v236 offset:46080
    ds_read_b64_tr_b16 a[82:83], v236 offset:46320
    v_sub_f32 v225, v224, v240
    s_waitcnt lgkmcnt(14)
    v_mfma_f32_32x32x16_bf16 v[32:47], a[24:27], v[104:107], v[32:47]
    buffer_load_dwordx4 v252, s[24:27], s71 offen offset:2048 sc1 lds
    ds_read_b64_tr_b16 a[8:9], v251 offset:46208
    ds_read_b64_tr_b16 a[10:11], v251 offset:46448
    v_cvt_pk_bf16_f32 v244, -v224, -v224
    s_waitcnt lgkmcnt(14)
    v_mfma_f32_32x32x16_bf16 v[48:63], a[28:31], v[104:107], v[48:63]
    ds_read_b64_tr_b16 a[12:13], v251 offset:46256
    ds_read_b64_tr_b16 a[14:15], v251 offset:46496
    s_waitcnt vmcnt(15) lgkmcnt(14)
    v_mfma_f32_32x32x16_bf16 v[0:15], a[32:35], v[108:111], v[0:15]
    buffer_load_dwordx4 v[140:143], v253, s[24:27], s60 offen offset:2048 sc1
    ds_read_b64_tr_b16 a[16:17], v251 offset:49920
    ds_read_b64_tr_b16 a[18:19], v251 offset:50160
    s_waitcnt lgkmcnt(14)
    v_mfma_f32_32x32x16_bf16 v[16:31], a[36:39], v[108:111], v[16:31]
    ds_read_b64_tr_b16 a[20:21], v251 offset:49984
    ds_read_b64_tr_b16 a[22:23], v251 offset:50224
    ds_read_b64_tr_b16 a[84:85], v236 offset:46144
    ds_read_b64_tr_b16 a[86:87], v236 offset:46384
    v_cvt_pk_bf16_f32 v245, v225, 0
    s_waitcnt lgkmcnt(14)
    v_mfma_f32_32x32x16_bf16 v[32:47], a[40:43], v[108:111], v[32:47]
    buffer_load_dwordx4 v252, s[24:27], s71 offen offset:3072 sc1 lds
    s_add_u32 m0, m0, 4096
    s_add_u32 s71, s71, 4096
    ds_read_b64_tr_b16 a[24:25], v251 offset:50048
    ds_read_b64_tr_b16 a[26:27], v251 offset:50288
    v_cndmask_b32_e64 v244, v244, 0, s[52:53]
    s_waitcnt lgkmcnt(14)
    v_mfma_f32_32x32x16_bf16 v[48:63], a[44:47], v[108:111], v[48:63]
    ds_read_b64_tr_b16 a[28:29], v251 offset:50096
    ds_read_b64_tr_b16 a[30:31], v251 offset:50336
    s_waitcnt vmcnt(15) lgkmcnt(14)
    v_mfma_f32_32x32x16_bf16 v[0:15], a[0:3], v[112:115], v[0:15]
    s_add_u32 s60, s60, 2560
    buffer_load_dwordx4 v[144:147], v253, s[24:27], s60 offen offset:0 sc1
    ds_read_b64_tr_b16 a[32:33], v251 offset:53760
    ds_read_b64_tr_b16 a[34:35], v251 offset:54000
    s_waitcnt lgkmcnt(14)
    v_mfma_f32_32x32x16_bf16 v[16:31], a[4:7], v[112:115], v[16:31]
    ds_read_b64_tr_b16 a[36:37], v251 offset:53824
    ds_read_b64_tr_b16 a[38:39], v251 offset:54064
    v_mfma_f32_16x16x32_bf16 a[48:51], a[208:211], a[80:83], a[48:51]
    ds_read_b64_tr_b16 a[88:89], v236 offset:46208
    ds_read_b64_tr_b16 a[90:91], v236 offset:46448
    v_cndmask_b32_e64 v245, v245, 0, s[52:53]
    s_waitcnt lgkmcnt(14)
    v_mfma_f32_32x32x16_bf16 v[32:47], a[8:11], v[112:115], v[32:47]
    buffer_load_dwordx4 v252, s[24:27], s71 offen offset:0 sc1 lds
    ds_read_b64_tr_b16 a[40:41], v251 offset:53888
    ds_read_b64_tr_b16 a[42:43], v251 offset:54128
    s_waitcnt lgkmcnt(14)
    v_mfma_f32_32x32x16_bf16 v[48:63], a[12:15], v[112:115], v[48:63]
    ds_read_b64_tr_b16 a[44:45], v251 offset:53936
    ds_read_b64_tr_b16 a[46:47], v251 offset:54176
    s_waitcnt vmcnt(15) lgkmcnt(14)
    v_mfma_f32_32x32x16_bf16 v[0:15], a[16:19], v[116:119], v[0:15]
    buffer_load_dwordx4 v[148:151], v253, s[24:27], s60 offen offset:512 sc1
    ds_read_b64_tr_b16 a[0:1], v251 offset:57600
    ds_read_b64_tr_b16 a[2:3], v251 offset:57840
    s_waitcnt lgkmcnt(14)
    v_mfma_f32_32x32x16_bf16 v[16:31], a[20:23], v[116:119], v[16:31]
    ds_read_b64_tr_b16 a[4:5], v251 offset:57664
    ds_read_b64_tr_b16 a[6:7], v251 offset:57904
    v_mfma_f32_16x16x32_bf16 a[52:55], a[208:211], a[84:87], a[52:55]
    ds_read_b64_tr_b16 a[92:93], v236 offset:46256
    ds_read_b64_tr_b16 a[94:95], v236 offset:46496
    s_waitcnt lgkmcnt(14)
    v_mfma_f32_32x32x16_bf16 v[32:47], a[24:27], v[116:119], v[32:47]
    buffer_load_dwordx4 v252, s[24:27], s71 offen offset:1024 sc1 lds
    ds_read_b64_tr_b16 a[8:9], v251 offset:57728
    ds_read_b64_tr_b16 a[10:11], v251 offset:57968
    s_waitcnt lgkmcnt(14)
    v_mfma_f32_32x32x16_bf16 v[48:63], a[28:31], v[116:119], v[48:63]
    ds_read_b64_tr_b16 a[12:13], v251 offset:57776
    ds_read_b64_tr_b16 a[14:15], v251 offset:58016
    s_waitcnt vmcnt(15) lgkmcnt(14)
    v_mfma_f32_32x32x16_bf16 v[0:15], a[32:35], v[120:123], v[0:15]
    buffer_load_dwordx4 v[152:155], v253, s[24:27], s60 offen offset:1024 sc1
    ds_read_b64_tr_b16 a[16:17], v250 offset:0
    ds_read_b64_tr_b16 a[18:19], v250 offset:240
    s_waitcnt lgkmcnt(14)
    v_mfma_f32_32x32x16_bf16 v[16:31], a[36:39], v[120:123], v[16:31]
    ds_read_b64_tr_b16 a[20:21], v250 offset:64
    ds_read_b64_tr_b16 a[22:23], v250 offset:304
    v_mfma_f32_16x16x32_bf16 a[56:59], a[208:211], a[88:91], a[56:59]
    ds_read_b64_tr_b16 a[64:65], v239 offset:0
    ds_read_b64_tr_b16 a[66:67], v239 offset:240
    s_waitcnt lgkmcnt(14)
    v_mfma_f32_32x32x16_bf16 v[32:47], a[40:43], v[120:123], v[32:47]
    buffer_load_dwordx4 v252, s[24:27], s71 offen offset:2048 sc1 lds
    ds_read_b64_tr_b16 a[24:25], v250 offset:128
    ds_read_b64_tr_b16 a[26:27], v250 offset:368
    s_waitcnt lgkmcnt(14)
    v_mfma_f32_32x32x16_bf16 v[48:63], a[44:47], v[120:123], v[48:63]
    ds_read_b64_tr_b16 a[28:29], v250 offset:176
    ds_read_b64_tr_b16 a[30:31], v250 offset:416
    s_waitcnt vmcnt(15) lgkmcnt(14)
    v_mfma_f32_32x32x16_bf16 v[0:15], a[0:3], v[124:127], v[0:15]
    buffer_load_dwordx4 v[156:159], v253, s[24:27], s60 offen offset:1536 sc1
    ds_read_b64_tr_b16 a[32:33], v250 offset:3840
    ds_read_b64_tr_b16 a[34:35], v250 offset:4080
    s_waitcnt lgkmcnt(14)
    v_mfma_f32_32x32x16_bf16 v[16:31], a[4:7], v[124:127], v[16:31]
    ds_read_b64_tr_b16 a[36:37], v250 offset:3904
    ds_read_b64_tr_b16 a[38:39], v250 offset:4144
    v_mfma_f32_16x16x32_bf16 a[60:63], a[208:211], a[92:95], a[60:63]
    ds_read_b64_tr_b16 a[68:69], v239 offset:64
    ds_read_b64_tr_b16 a[70:71], v239 offset:304
    s_waitcnt lgkmcnt(14)
    v_mfma_f32_32x32x16_bf16 v[32:47], a[8:11], v[124:127], v[32:47]
    buffer_load_dwordx4 v[160:163], v253, s[24:27], s60 offen offset:2048 sc1
    ds_read_b64_tr_b16 a[40:41], v250 offset:3968
    ds_read_b64_tr_b16 a[42:43], v250 offset:4208
    s_waitcnt lgkmcnt(14)
    v_mfma_f32_32x32x16_bf16 v[48:63], a[12:15], v[124:127], v[48:63]
    ds_read_b64_tr_b16 a[44:45], v250 offset:4016
    ds_read_b64_tr_b16 a[46:47], v250 offset:4256
    s_waitcnt vmcnt(15) lgkmcnt(14)
    v_mfma_f32_32x32x16_bf16 v[0:15], a[16:19], v[128:131], v[0:15]
    s_add_u32 s60, s60, 2560
    buffer_load_dwordx4 v[164:167], v253, s[24:27], s60 offen offset:0 sc1
    ds_read_b64_tr_b16 a[0:1], v250 offset:7680
    ds_read_b64_tr_b16 a[2:3], v250 offset:7920
    s_waitcnt lgkmcnt(14)
    v_mfma_f32_32x32x16_bf16 v[16:31], a[20:23], v[128:131], v[16:31]
    ds_read_b64_tr_b16 a[4:5], v250 offset:7744
    ds_read_b64_tr_b16 a[6:7], v250 offset:7984
    v_mfma_f32_16x16x32_bf16 a[48:51], a[208:211], a[64:67], a[48:51]
    ds_read_b64_tr_b16 a[72:73], v239 offset:128
    ds_read_b64_tr_b16 a[74:75], v239 offset:368
    s_waitcnt lgkmcnt(14)
    v_mfma_f32_32x32x16_bf16 v[32:47], a[24:27], v[128:131], v[32:47]
    buffer_load_dwordx4 v[168:171], v253, s[24:27], s60 offen offset:512 sc1
    ds_read_b64_tr_b16 a[8:9], v250 offset:7808
    ds_read_b64_tr_b16 a[10:11], v250 offset:8048
    s_waitcnt lgkmcnt(14)
    v_mfma_f32_32x32x16_bf16 v[48:63], a[28:31], v[128:131], v[48:63]
    ds_read_b64_tr_b16 a[12:13], v250 offset:7856
    ds_read_b64_tr_b16 a[14:15], v250 offset:8096
    s_waitcnt vmcnt(15) lgkmcnt(14)
    v_mfma_f32_32x32x16_bf16 v[0:15], a[32:35], v[132:135], v[0:15]
    buffer_load_dwordx4 v[172:175], v253, s[24:27], s60 offen offset:1024 sc1
    ds_read_b64_tr_b16 a[16:17], v250 offset:11520
    ds_read_b64_tr_b16 a[18:19], v250 offset:11760
    s_waitcnt lgkmcnt(14)
    v_mfma_f32_32x32x16_bf16 v[16:31], a[36:39], v[132:135], v[16:31]
    ds_read_b64_tr_b16 a[20:21], v250 offset:11584
    ds_read_b64_tr_b16 a[22:23], v250 offset:11824
    v_mfma_f32_16x16x32_bf16 a[52:55], a[208:211], a[68:71], a[52:55]
    ds_read_b64_tr_b16 a[76:77], v239 offset:176
    ds_read_b64_tr_b16 a[78:79], v239 offset:416
    s_waitcnt lgkmcnt(14)
    v_mfma_f32_32x32x16_bf16 v[32:47], a[40:43], v[132:135], v[32:47]
    buffer_load_dwordx4 v[176:179], v253, s[24:27], s60 offen offset:1536 sc1
    ds_read_b64_tr_b16 a[24:25], v250 offset:11648
    ds_read_b64_tr_b16 a[26:27], v250 offset:11888
    s_waitcnt lgkmcnt(14)
    v_mfma_f32_32x32x16_bf16 v[48:63], a[44:47], v[132:135], v[48:63]
    ds_read_b64_tr_b16 a[28:29], v250 offset:11696
    ds_read_b64_tr_b16 a[30:31], v250 offset:11936
    s_waitcnt vmcnt(15) lgkmcnt(14)
    v_mfma_f32_32x32x16_bf16 v[0:15], a[0:3], v[136:139], v[0:15]
    buffer_load_dwordx4 v[180:183], v253, s[24:27], s60 offen offset:2048 sc1
    ds_read_b64_tr_b16 a[32:33], v250 offset:15360
    ds_read_b64_tr_b16 a[34:35], v250 offset:15600
    s_waitcnt lgkmcnt(14)
    v_mfma_f32_32x32x16_bf16 v[16:31], a[4:7], v[136:139], v[16:31]
    ds_read_b64_tr_b16 a[36:37], v250 offset:15424
    ds_read_b64_tr_b16 a[38:39], v250 offset:15664
    v_mfma_f32_16x16x32_bf16 a[56:59], a[208:211], a[72:75], a[56:59]
    ds_read_b64_tr_b16 a[80:81], v239 offset:15360
    ds_read_b64_tr_b16 a[82:83], v239 offset:15600
    s_waitcnt lgkmcnt(14)
    v_mfma_f32_32x32x16_bf16 v[32:47], a[8:11], v[136:139], v[32:47]
    s_add_u32 s60, s60, 2560
    buffer_load_dwordx4 v[184:187], v253, s[24:27], s60 offen offset:0 sc1
    ds_read_b64_tr_b16 a[40:41], v250 offset:15488
    ds_read_b64_tr_b16 a[42:43], v250 offset:15728
    s_waitcnt lgkmcnt(14)
    v_mfma_f32_32x32x16_bf16 v[48:63], a[12:15], v[136:139], v[48:63]
    ds_read_b64_tr_b16 a[44:45], v250 offset:15536
    ds_read_b64_tr_b16 a[46:47], v250 offset:15776
    s_waitcnt vmcnt(15) lgkmcnt(14)
    v_mfma_f32_32x32x16_bf16 v[0:15], a[16:19], v[140:143], v[0:15]
    buffer_load_dwordx4 v[188:191], v253, s[24:27], s60 offen offset:512 sc1
    ds_read_b64_tr_b16 a[0:1], v250 offset:19200
    ds_read_b64_tr_b16 a[2:3], v250 offset:19440
    s_waitcnt lgkmcnt(14)
    v_mfma_f32_32x32x16_bf16 v[16:31], a[20:23], v[140:143], v[16:31]
    ds_read_b64_tr_b16 a[4:5], v250 offset:19264
    ds_read_b64_tr_b16 a[6:7], v250 offset:19504
    v_mfma_f32_16x16x32_bf16 a[60:63], a[208:211], a[76:79], a[60:63]
    ds_read_b64_tr_b16 a[84:85], v239 offset:15424
    ds_read_b64_tr_b16 a[86:87], v239 offset:15664
    s_waitcnt lgkmcnt(14)
    v_mfma_f32_32x32x16_bf16 v[32:47], a[24:27], v[140:143], v[32:47]
    buffer_load_dwordx4 v[192:195], v253, s[24:27], s60 offen offset:1024 sc1
    ds_read_b64_tr_b16 a[8:9], v250 offset:19328
    ds_read_b64_tr_b16 a[10:11], v250 offset:19568
    s_waitcnt lgkmcnt(14)
    v_mfma_f32_32x32x16_bf16 v[48:63], a[28:31], v[140:143], v[48:63]
    ds_read_b64_tr_b16 a[12:13], v250 offset:19376
    ds_read_b64_tr_b16 a[14:15], v250 offset:19616
    s_waitcnt vmcnt(15) lgkmcnt(14)
    v_mfma_f32_32x32x16_bf16 v[0:15], a[32:35], v[144:147], v[0:15]
    buffer_load_dwordx4 v[196:199], v253, s[24:27], s60 offen offset:1536 sc1
    ds_read_b64_tr_b16 a[16:17], v250 offset:23040
    ds_read_b64_tr_b16 a[18:19], v250 offset:23280
    s_waitcnt lgkmcnt(14)
    v_mfma_f32_32x32x16_bf16 v[16:31], a[36:39], v[144:147], v[16:31]
    ds_read_b64_tr_b16 a[20:21], v250 offset:23104
    ds_read_b64_tr_b16 a[22:23], v250 offset:23344
    v_mfma_f32_16x16x32_bf16 a[48:51], a[208:211], a[80:83], a[48:51]
    ds_read_b64_tr_b16 a[88:89], v239 offset:15488
    ds_read_b64_tr_b16 a[90:91], v239 offset:15728
    s_waitcnt lgkmcnt(14)
    v_mfma_f32_32x32x16_bf16 v[32:47], a[40:43], v[144:147], v[32:47]
    buffer_load_dwordx4 v[200:203], v253, s[24:27], s60 offen offset:2048 sc1
    ds_read_b64_tr_b16 a[24:25], v250 offset:23168
    ds_read_b64_tr_b16 a[26:27], v250 offset:23408
    s_waitcnt lgkmcnt(14)
    v_mfma_f32_32x32x16_bf16 v[48:63], a[44:47], v[144:147], v[48:63]
    ds_read_b64_tr_b16 a[28:29], v250 offset:23216
    ds_read_b64_tr_b16 a[30:31], v250 offset:23456
    s_waitcnt vmcnt(15) lgkmcnt(14)
    v_mfma_f32_32x32x16_bf16 v[0:15], a[0:3], v[148:151], v[0:15]
    s_add_u32 s60, s60, 2560
    buffer_load_dwordx4 v[204:207], v253, s[24:27], s60 offen offset:0 sc1
    ds_read_b64_tr_b16 a[32:33], v250 offset:26880
    ds_read_b64_tr_b16 a[34:35], v250 offset:27120
    s_waitcnt lgkmcnt(14)
    v_mfma_f32_32x32x16_bf16 v[16:31], a[4:7], v[148:151], v[16:31]
    ds_read_b64_tr_b16 a[36:37], v250 offset:26944
    ds_read_b64_tr_b16 a[38:39], v250 offset:27184
    v_mfma_f32_16x16x32_bf16 a[52:55], a[208:211], a[84:87], a[52:55]
    ds_read_b64_tr_b16 a[92:93], v239 offset:15536
    ds_read_b64_tr_b16 a[94:95], v239 offset:15776
    s_waitcnt lgkmcnt(14)
    v_mfma_f32_32x32x16_bf16 v[32:47], a[8:11], v[148:151], v[32:47]
    buffer_load_dwordx4 v[208:211], v253, s[24:27], s60 offen offset:512 sc1
    ds_read_b64_tr_b16 a[40:41], v250 offset:27008
    ds_read_b64_tr_b16 a[42:43], v250 offset:27248
    s_waitcnt lgkmcnt(14)
    v_mfma_f32_32x32x16_bf16 v[48:63], a[12:15], v[148:151], v[48:63]
    ds_read_b64_tr_b16 a[44:45], v250 offset:27056
    ds_read_b64_tr_b16 a[46:47], v250 offset:27296
    s_waitcnt vmcnt(14)
    s_barrier
    s_waitcnt vmcnt(15) lgkmcnt(14)
    v_mfma_f32_32x32x16_bf16 v[0:15], a[16:19], v[152:155], v[0:15]
    buffer_load_dwordx4 v[212:215], v253, s[24:27], s60 offen offset:1024 sc1
    ds_read_b64_tr_b16 a[0:1], v249 offset:0
    ds_read_b64_tr_b16 a[2:3], v249 offset:240
    ds_read_b64_tr_b16 a[64:65], v237 offset:0
    ds_read_b64_tr_b16 a[66:67], v237 offset:240
    s_waitcnt lgkmcnt(14)
    v_mfma_f32_32x32x16_bf16 v[16:31], a[20:23], v[152:155], v[16:31]
    ds_read_b64_tr_b16 a[4:5], v249 offset:64
    ds_read_b64_tr_b16 a[6:7], v249 offset:304
    v_mfma_f32_16x16x32_bf16 a[56:59], a[208:211], a[88:91], a[56:59]
    ds_read_b64_tr_b16 a[68:69], v237 offset:64
    ds_read_b64_tr_b16 a[70:71], v237 offset:304
    s_waitcnt lgkmcnt(14)
    v_mfma_f32_32x32x16_bf16 v[32:47], a[24:27], v[152:155], v[32:47]
    ds_read_b64_tr_b16 a[8:9], v249 offset:128
    ds_read_b64_tr_b16 a[10:11], v249 offset:368
    ds_read_b64_tr_b16 a[72:73], v237 offset:128
    ds_read_b64_tr_b16 a[74:75], v237 offset:368
    s_waitcnt lgkmcnt(14)
    v_mfma_f32_32x32x16_bf16 v[48:63], a[28:31], v[152:155], v[48:63]
    ds_read_b64_tr_b16 a[12:13], v249 offset:176
    ds_read_b64_tr_b16 a[14:15], v249 offset:416
    ds_read_b64_tr_b16 a[76:77], v237 offset:176
    ds_read_b64_tr_b16 a[78:79], v237 offset:416
    s_waitcnt vmcnt(14) lgkmcnt(14)
    v_mfma_f32_32x32x16_bf16 v[0:15], a[32:35], v[156:159], v[0:15]
    buffer_load_dwordx4 v[216:219], v253, s[24:27], s60 offen offset:1536 sc1
    ds_read_b64_tr_b16 a[16:17], v249 offset:3840
    ds_read_b64_tr_b16 a[18:19], v249 offset:4080
    s_waitcnt lgkmcnt(14)
    v_mfma_f32_32x32x16_bf16 v[16:31], a[36:39], v[156:159], v[16:31]
    ds_read_b64_tr_b16 a[20:21], v249 offset:3904
    ds_read_b64_tr_b16 a[22:23], v249 offset:4144
    v_mfma_f32_16x16x32_bf16 a[60:63], a[208:211], a[92:95], a[60:63]
    ds_read_b64_tr_b16 a[80:81], v237 offset:15360
    ds_read_b64_tr_b16 a[82:83], v237 offset:15600
    s_waitcnt lgkmcnt(14)
    v_mfma_f32_32x32x16_bf16 v[32:47], a[40:43], v[156:159], v[32:47]
    ds_read_b64_tr_b16 a[24:25], v249 offset:3968
    ds_read_b64_tr_b16 a[26:27], v249 offset:4208
    s_waitcnt lgkmcnt(14)
    v_mfma_f32_32x32x16_bf16 v[48:63], a[44:47], v[156:159], v[48:63]
    ds_read_b64_tr_b16 a[28:29], v249 offset:4016
    ds_read_b64_tr_b16 a[30:31], v249 offset:4256
    s_waitcnt vmcnt(14) lgkmcnt(14)
    v_mfma_f32_32x32x16_bf16 v[0:15], a[0:3], v[160:163], v[0:15]
    buffer_load_dwordx4 v[220:223], v253, s[24:27], s60 offen offset:2048 sc1
    ds_read_b64_tr_b16 a[32:33], v249 offset:7680
    ds_read_b64_tr_b16 a[34:35], v249 offset:7920
    v_mfma_f32_16x16x32_bf16 a[48:51], a[208:211], a[64:67], a[48:51]
    s_waitcnt lgkmcnt(14)
    v_mfma_f32_32x32x16_bf16 v[16:31], a[4:7], v[160:163], v[16:31]
    ds_read_b64_tr_b16 a[36:37], v249 offset:7744
    ds_read_b64_tr_b16 a[38:39], v249 offset:7984
    v_mfma_f32_16x16x32_bf16 a[52:55], a[208:211], a[68:71], a[52:55]
    ds_read_b64_tr_b16 a[84:85], v237 offset:15424
    ds_read_b64_tr_b16 a[86:87], v237 offset:15664
    s_waitcnt lgkmcnt(14)
    v_mfma_f32_32x32x16_bf16 v[32:47], a[8:11], v[160:163], v[32:47]
    ds_read_b64_tr_b16 a[40:41], v249 offset:7808
    ds_read_b64_tr_b16 a[42:43], v249 offset:8048
    v_mfma_f32_16x16x32_bf16 a[56:59], a[208:211], a[72:75], a[56:59]
    s_waitcnt lgkmcnt(14)
    v_mfma_f32_32x32x16_bf16 v[48:63], a[12:15], v[160:163], v[48:63]
    ds_read_b64_tr_b16 a[44:45], v249 offset:7856
    ds_read_b64_tr_b16 a[46:47], v249 offset:8096
    v_mfma_f32_16x16x32_bf16 a[60:63], a[208:211], a[76:79], a[60:63]
    s_barrier
    s_mul_i32 s54, s42, 25600
    s_add_u32 m0, s54, 0
    s_add_u32 s71, s54, s69
    s_waitcnt vmcnt(14) lgkmcnt(14)
    v_mfma_f32_32x32x16_bf16 v[0:15], a[16:19], v[164:167], v[0:15]
    ds_read_b64_tr_b16 a[0:1], v249 offset:11520
    ds_read_b64_tr_b16 a[2:3], v249 offset:11760
    s_waitcnt lgkmcnt(14)
    v_mfma_f32_32x32x16_bf16 v[16:31], a[20:23], v[164:167], v[16:31]
    buffer_load_dwordx4 v252, s[24:27], s71 offen offset:0 sc1 lds
    ds_read_b64_tr_b16 a[4:5], v249 offset:11584
    ds_read_b64_tr_b16 a[6:7], v249 offset:11824
    v_mfma_f32_16x16x32_bf16 a[48:51], a[208:211], a[80:83], a[48:51]
    ds_read_b64_tr_b16 a[88:89], v237 offset:15488
    ds_read_b64_tr_b16 a[90:91], v237 offset:15728
    s_waitcnt lgkmcnt(14)
    v_mfma_f32_32x32x16_bf16 v[32:47], a[24:27], v[164:167], v[32:47]
    buffer_load_dwordx4 v252, s[24:27], s71 offen offset:1024 sc1 lds
    ds_read_b64_tr_b16 a[8:9], v249 offset:11648
    ds_read_b64_tr_b16 a[10:11], v249 offset:11888
    s_waitcnt lgkmcnt(14)
    v_mfma_f32_32x32x16_bf16 v[48:63], a[28:31], v[164:167], v[48:63]
    ds_read_b64_tr_b16 a[12:13], v249 offset:11696
    ds_read_b64_tr_b16 a[14:15], v249 offset:11936
    s_waitcnt vmcnt(15) lgkmcnt(14)
    v_mfma_f32_32x32x16_bf16 v[0:15], a[32:35], v[168:171], v[0:15]
    ds_read_b64_tr_b16 a[16:17], v249 offset:15360
    ds_read_b64_tr_b16 a[18:19], v249 offset:15600
    s_mov_b32 s60, 0x35c1a2a0
    s_mov_b32 s61, 0x3f317218
    s_waitcnt lgkmcnt(14)
    v_mfma_f32_32x32x16_bf16 v[16:31], a[36:39], v[168:171], v[16:31]
    buffer_load_dwordx4 v252, s[24:27], s71 offen offset:2048 sc1 lds
    ds_read_b64_tr_b16 a[20:21], v249 offset:15424
    ds_read_b64_tr_b16 a[22:23], v249 offset:15664
    v_mfma_f32_16x16x32_bf16 a[52:55], a[208:211], a[84:87], a[52:55]
    ds_read_b64_tr_b16 a[92:93], v237 offset:15536
    ds_read_b64_tr_b16 a[94:95], v237 offset:15776
    v_mul_f32 v224, 0x3fb8aa3b, v242
    s_waitcnt lgkmcnt(14)
    v_mfma_f32_32x32x16_bf16 v[32:47], a[40:43], v[168:171], v[32:47]
    buffer_load_dwordx4 v252, s[24:27], s71 offen offset:3072 sc1 lds
    s_add_u32 m0, m0, 4096
    s_add_u32 s71, s71, 4096
    ds_read_b64_tr_b16 a[24:25], v249 offset:15488
    ds_read_b64_tr_b16 a[26:27], v249 offset:15728
    v_and_b32 v225, 31, v255
    s_waitcnt lgkmcnt(14)
    v_mfma_f32_32x32x16_bf16 v[48:63], a[44:47], v[168:171], v[48:63]
    ds_read_b64_tr_b16 a[28:29], v249 offset:15536
    ds_read_b64_tr_b16 a[30:31], v249 offset:15776
    v_lshrrev_b32 v226, 5, v255
    s_lshl_b32 s54, s42, 8
    s_waitcnt vmcnt(16) lgkmcnt(14)
    v_mfma_f32_32x32x16_bf16 v[0:15], a[0:3], v[172:175], v[0:15]
    ds_read_b64_tr_b16 a[32:33], v249 offset:19200
    ds_read_b64_tr_b16 a[34:35], v249 offset:19440
    s_add_u32 s54, s54, 104448
    v_lshl_add_u32 v227, v225, 3, s54
    s_waitcnt lgkmcnt(14)
    v_mfma_f32_32x32x16_bf16 v[16:31], a[4:7], v[172:175], v[16:31]
    buffer_load_dwordx4 v252, s[24:27], s71 offen offset:0 sc1 lds
    ds_read_b64_tr_b16 a[36:37], v249 offset:19264
    ds_read_b64_tr_b16 a[38:39], v249 offset:19504
    v_mfma_f32_16x16x32_bf16 a[56:59], a[208:211], a[88:91], a[56:59]
    ds_read_b64_tr_b16 a[64:65], v237 offset:30720
    ds_read_b64_tr_b16 a[66:67], v237 offset:30960
    v_mul_u32_u24 v228, 1056, v226
    s_waitcnt lgkmcnt(14)
    v_mfma_f32_32x32x16_bf16 v[32:47], a[8:11], v[172:175], v[32:47]
    buffer_load_dwordx4 v252, s[24:27], s71 offen offset:1024 sc1 lds
    ds_read_b64_tr_b16 a[40:41], v249 offset:19328
    ds_read_b64_tr_b16 a[42:43], v249 offset:19568
    v_add_u32 v227, v227, v228
    s_waitcnt lgkmcnt(14)
    v_mfma_f32_32x32x16_bf16 v[48:63], a[12:15], v[172:175], v[48:63]
    ds_read_b64_tr_b16 a[44:45], v249 offset:19376
    ds_read_b64_tr_b16 a[46:47], v249 offset:19616
    v_add_u32 v228, v227, v228
    v_mov_b32 v110, 0x3f80
    s_waitcnt vmcnt(17) lgkmcnt(14)
    v_mfma_f32_32x32x16_bf16 v[0:15], a[16:19], v[176:179], v[0:15]
    ds_read_b64_tr_b16 a[0:1], v249 offset:23040
    ds_read_b64_tr_b16 a[2:3], v249 offset:23280
    v_mov_b32 v111, 0
    v_and_b32 v229, 3, v255
    s_waitcnt lgkmcnt(14)
    v_mfma_f32_32x32x16_bf16 v[16:31], a[20:23], v[176:179], v[16:31]
    buffer_load_dwordx4 v252, s[24:27], s71 offen offset:2048 sc1 lds
    ds_read_b64_tr_b16 a[4:5], v249 offset:23104
    ds_read_b64_tr_b16 a[6:7], v249 offset:23344
    v_mfma_f32_16x16x32_bf16 a[60:63], a[208:211], a[92:95], a[60:63]
    ds_read_b64_tr_b16 a[68:69], v237 offset:30784
    ds_read_b64_tr_b16 a[70:71], v237 offset:31024
    v_bfe_u32 v230, v255, 2, 2
    s_waitcnt lgkmcnt(14)
    v_mfma_f32_32x32x16_bf16 v[32:47], a[24:27], v[176:179], v[32:47]
    buffer_load_dwordx4 v252, s[24:27], s71 offen offset:3072 sc1 lds
    s_add_u32 m0, m0, 4096
    s_add_u32 s71, s71, 4096
    ds_read_b64_tr_b16 a[8:9], v249 offset:23168
    ds_read_b64_tr_b16 a[10:11], v249 offset:23408
    v_lshl_add_u32 v230, v226, 3, v230
    s_waitcnt lgkmcnt(14)
    v_mfma_f32_32x32x16_bf16 v[48:63], a[28:31], v[176:179], v[48:63]
    ds_read_b64_tr_b16 a[12:13], v249 offset:23216
    ds_read_b64_tr_b16 a[14:15], v249 offset:23456
    v_lshlrev_b32 v230, 3, v230
    v_add_u32 v230, 104448, v230
    s_waitcnt vmcnt(18) lgkmcnt(14)
    v_mfma_f32_32x32x16_bf16 v[0:15], a[32:35], v[180:183], v[0:15]
    ds_read_b64_tr_b16 a[16:17], v249 offset:26880
    ds_read_b64_tr_b16 a[18:19], v249 offset:27120
    s_lshl_b32 s54, s42, 2
    v_add_u32 v231, s54, v229
    s_waitcnt lgkmcnt(14)
    v_mfma_f32_32x32x16_bf16 v[16:31], a[36:39], v[180:183], v[16:31]
    buffer_load_dwordx4 v252, s[24:27], s71 offen offset:0 sc1 lds
    ds_read_b64_tr_b16 a[20:21], v249 offset:26944
    ds_read_b64_tr_b16 a[22:23], v249 offset:27184
    v_mfma_f32_16x16x32_bf16 a[48:51], a[208:211], a[64:67], a[48:51]
    ds_read_b64_tr_b16 a[72:73], v237 offset:30848
    ds_read_b64_tr_b16 a[74:75], v237 offset:31088
    v_and_b32 v232, 1, v229
    s_waitcnt lgkmcnt(14)
    v_mfma_f32_32x32x16_bf16 v[32:47], a[40:43], v[180:183], v[32:47]
    buffer_load_dwordx4 v252, s[24:27], s71 offen offset:1024 sc1 lds
    ds_read_b64_tr_b16 a[24:25], v249 offset:27008
    ds_read_b64_tr_b16 a[26:27], v249 offset:27248
    v_add_u32 v232, 8, v232
    s_waitcnt lgkmcnt(14)
    v_mfma_f32_32x32x16_bf16 v[48:63], a[44:47], v[180:183], v[48:63]
    ds_read_b64_tr_b16 a[28:29], v249 offset:27056
    ds_read_b64_tr_b16 a[30:31], v249 offset:27296
    v_cmp_gt_u32 vcc, 16, v225
    s_add_u32 s55, s42, 8
    s_waitcnt vmcnt(19) lgkmcnt(14)
    v_mfma_f32_32x32x16_bf16 v[0:15], a[0:3], v[184:187], v[0:15]
    ds_read_b64_tr_b16 a[32:33], v249 offset:30720
    ds_read_b64_tr_b16 a[34:35], v249 offset:30960
    v_mov_b32 v233, s55
    v_cndmask_b32 v232, v232, v231, vcc
    s_waitcnt lgkmcnt(14)
    v_mfma_f32_32x32x16_bf16 v[16:31], a[4:7], v[184:187], v[16:31]
    buffer_load_dwordx4 v252, s[24:27], s71 offen offset:2048 sc1 lds
    ds_read_b64_tr_b16 a[36:37], v249 offset:30784
    ds_read_b64_tr_b16 a[38:39], v249 offset:31024
    v_mfma_f32_16x16x32_bf16 a[52:55], a[208:211], a[68:71], a[52:55]
    ds_read_b64_tr_b16 a[76:77], v237 offset:30896
    ds_read_b64_tr_b16 a[78:79], v237 offset:31136
    v_cmp_eq_u32 s[56:57], 0, v229
    s_waitcnt lgkmcnt(14)
    v_mfma_f32_32x32x16_bf16 v[32:47], a[8:11], v[184:187], v[32:47]
    buffer_load_dwordx4 v252, s[24:27], s71 offen offset:3072 sc1 lds
    s_add_u32 m0, m0, 4096
    s_add_u32 s71, s71, 4096
    ds_read_b64_tr_b16 a[40:41], v249 offset:30848
    ds_read_b64_tr_b16 a[42:43], v249 offset:31088
    v_mul_u32_u24 v232, 1056, v232
    s_waitcnt lgkmcnt(14)
    v_mfma_f32_32x32x16_bf16 v[48:63], a[12:15], v[184:187], v[48:63]
    ds_read_b64_tr_b16 a[44:45], v249 offset:30896
    ds_read_b64_tr_b16 a[46:47], v249 offset:31136
    v_cndmask_b32_e64 v233, 10, v233, s[56:57]
    v_cndmask_b32 v233, v233, v231, vcc
    s_waitcnt vmcnt(20) lgkmcnt(14)
    v_mfma_f32_32x32x16_bf16 v[0:15], a[16:19], v[188:191], v[0:15]
    ds_read_b64_tr_b16 a[0:1], v249 offset:34560
    ds_read_b64_tr_b16 a[2:3], v249 offset:34800
    v_mul_u32_u24 v233, 1056, v233
    v_add_u32 v232, v232, v230
    s_waitcnt lgkmcnt(14)
    v_mfma_f32_32x32x16_bf16 v[16:31], a[20:23], v[188:191], v[16:31]
    buffer_load_dwordx4 v252, s[24:27], s71 offen offset:0 sc1 lds
    ds_read_b64_tr_b16 a[4:5], v249 offset:34624
    ds_read_b64_tr_b16 a[6:7], v249 offset:34864
    v_mfma_f32_16x16x32_bf16 a[56:59], a[208:211], a[72:75], a[56:59]
    ds_read_b64_tr_b16 a[80:81], v237 offset:46080
    ds_read_b64_tr_b16 a[82:83], v237 offset:46320
    v_add_u32 v233, v233, v230
    s_waitcnt lgkmcnt(14)
    v_mfma_f32_32x32x16_bf16 v[32:47], a[24:27], v[188:191], v[32:47]
    buffer_load_dwordx4 v252, s[24:27], s71 offen offset:1024 sc1 lds
    ds_read_b64_tr_b16 a[8:9], v249 offset:34688
    ds_read_b64_tr_b16 a[10:11], v249 offset:34928
    v_cmp_gt_u32 vcc, 24, v225
    s_waitcnt lgkmcnt(14)
    v_mfma_f32_32x32x16_bf16 v[48:63], a[28:31], v[188:191], v[48:63]
    ds_read_b64_tr_b16 a[12:13], v249 offset:34736
    ds_read_b64_tr_b16 a[14:15], v249 offset:34976
    v_mov_b32 v234, 0x80000000
    v_cndmask_b32 v234, v234, v252, vcc
    s_waitcnt vmcnt(21) lgkmcnt(14)
    v_mfma_f32_32x32x16_bf16 v[0:15], a[32:35], v[192:195], v[0:15]
    ds_read_b64_tr_b16 a[16:17], v249 offset:38400
    ds_read_b64_tr_b16 a[18:19], v249 offset:38640
    s_lshl_b32 s54, s41, 4
    s_lshr_b32 s55, s43, 1
    s_waitcnt lgkmcnt(14)
    v_mfma_f32_32x32x16_bf16 v[16:31], a[36:39], v[192:195], v[16:31]
    buffer_load_dwordx4 v252, s[24:27], s71 offen offset:2048 sc1 lds
    ds_read_b64_tr_b16 a[20:21], v249 offset:38464
    ds_read_b64_tr_b16 a[22:23], v249 offset:38704
    v_mfma_f32_16x16x32_bf16 a[60:63], a[208:211], a[76:79], a[60:63]
    ds_read_b64_tr_b16 a[84:85], v237 offset:46144
    ds_read_b64_tr_b16 a[86:87], v237 offset:46384
    s_mul_i32 s55, s55, 1310720
    s_waitcnt lgkmcnt(14)
    v_mfma_f32_32x32x16_bf16 v[32:47], a[40:43], v[192:195], v[32:47]
    buffer_load_dwordx4 v252, s[24:27], s71 offen offset:3072 sc1 lds
    s_add_u32 m0, m0, 4096
    s_add_u32 s71, s71, 4096
    ds_read_b64_tr_b16 a[24:25], v249 offset:38528
    ds_read_b64_tr_b16 a[26:27], v249 offset:38768
    s_mul_i32 s54, s54, 5120
    s_waitcnt lgkmcnt(14)
    v_mfma_f32_32x32x16_bf16 v[48:63], a[44:47], v[192:195], v[48:63]
    ds_read_b64_tr_b16 a[28:29], v249 offset:38576
    ds_read_b64_tr_b16 a[30:31], v249 offset:38816
    s_add_u32 s54, s54, s55
    s_add_u32 s62, s54, 20971520
    s_waitcnt vmcnt(22) lgkmcnt(14)
    v_mfma_f32_32x32x16_bf16 v[0:15], a[0:3], v[196:199], v[0:15]
    ds_read_b64_tr_b16 a[32:33], v249 offset:42240
    ds_read_b64_tr_b16 a[34:35], v249 offset:42480
    s_lshl_b32 s54, s40, 10
    s_add_u32 s54, s54, s62
    s_waitcnt lgkmcnt(14)
    v_mfma_f32_32x32x16_bf16 v[16:31], a[4:7], v[196:199], v[16:31]
    buffer_load_dwordx4 v252, s[24:27], s71 offen offset:0 sc1 lds
    ds_read_b64_tr_b16 a[36:37], v249 offset:42304
    ds_read_b64_tr_b16 a[38:39], v249 offset:42544
    v_mfma_f32_16x16x32_bf16 a[48:51], a[208:211], a[80:83], a[48:51]
    ds_read_b64_tr_b16 a[88:89], v237 offset:46208
    ds_read_b64_tr_b16 a[90:91], v237 offset:46448
    s_lshl_b32 s55, s42, 15
    s_waitcnt lgkmcnt(14)
    v_mfma_f32_32x32x16_bf16 v[32:47], a[8:11], v[196:199], v[32:47]
    buffer_load_dwordx4 v252, s[24:27], s71 offen offset:1024 sc1 lds
    ds_read_b64_tr_b16 a[40:41], v249 offset:42368
    ds_read_b64_tr_b16 a[42:43], v249 offset:42608
    s_add_u32 s55, s55, s54
    s_waitcnt lgkmcnt(14)
    v_mfma_f32_32x32x16_bf16 v[48:63], a[12:15], v[196:199], v[48:63]
    ds_read_b64_tr_b16 a[44:45], v249 offset:42416
    ds_read_b64_tr_b16 a[46:47], v249 offset:42656
    s_add_u32 s56, s55, 16384
    s_add_u32 s54, s54, 65536
    s_waitcnt vmcnt(23) lgkmcnt(14)
    v_mfma_f32_32x32x16_bf16 v[0:15], a[16:19], v[200:203], v[0:15]
    ds_read_b64_tr_b16 a[0:1], v249 offset:46080
    ds_read_b64_tr_b16 a[2:3], v249 offset:46320
    v_cmp_eq_u32 vcc, s42, v226
    v_mov_b32 v235, 0x80000000
    s_waitcnt lgkmcnt(14)
    v_mfma_f32_32x32x16_bf16 v[16:31], a[20:23], v[200:203], v[16:31]
    buffer_load_dwordx4 v252, s[24:27], s71 offen offset:2048 sc1 lds
    ds_read_b64_tr_b16 a[4:5], v249 offset:46144
    ds_read_b64_tr_b16 a[6:7], v249 offset:46384
    v_mfma_f32_16x16x32_bf16 a[52:55], a[208:211], a[84:87], a[52:55]
    ds_read_b64_tr_b16 a[92:93], v237 offset:46256
    ds_read_b64_tr_b16 a[94:95], v237 offset:46496
    v_cndmask_b32 v235, v235, v234, vcc
    s_waitcnt lgkmcnt(14)
    v_mfma_f32_32x32x16_bf16 v[32:47], a[24:27], v[200:203], v[32:47]
    buffer_load_dwordx4 v252, s[24:27], s71 offen offset:3072 sc1 lds
    s_add_u32 m0, m0, 4096
    s_add_u32 s71, s71, 4096
    ds_read_b64_tr_b16 a[8:9], v249 offset:46208
    ds_read_b64_tr_b16 a[10:11], v249 offset:46448
    v_lshlrev_b32 v64, 4, v225
    s_waitcnt lgkmcnt(14)
    v_mfma_f32_32x32x16_bf16 v[48:63], a[28:31], v[200:203], v[48:63]
    ds_read_b64_tr_b16 a[12:13], v249 offset:46256
    ds_read_b64_tr_b16 a[14:15], v249 offset:46496
    v_add_u32 v64, 102400, v64
    s_waitcnt vmcnt(24) lgkmcnt(14)
    v_mfma_f32_32x32x16_bf16 v[0:15], a[32:35], v[204:207], v[0:15]
    ds_read_b64_tr_b16 a[16:17], v249 offset:49920
    ds_read_b64_tr_b16 a[18:19], v249 offset:50160
    s_waitcnt lgkmcnt(14)
    v_mfma_f32_32x32x16_bf16 v[16:31], a[36:39], v[204:207], v[16:31]
    buffer_load_dwordx4 v252, s[24:27], s71 offen offset:0 sc1 lds
    ds_read_b64_tr_b16 a[20:21], v249 offset:49984
    ds_read_b64_tr_b16 a[22:23], v249 offset:50224
    v_mfma_f32_16x16x32_bf16 a[56:59], a[208:211], a[88:91], a[56:59]
    s_waitcnt lgkmcnt(14)
    v_mfma_f32_32x32x16_bf16 v[32:47], a[40:43], v[204:207], v[32:47]
    buffer_load_dwordx4 v252, s[24:27], s71 offen offset:1024 sc1 lds
    ds_read_b64_tr_b16 a[24:25], v249 offset:50048
    ds_read_b64_tr_b16 a[26:27], v249 offset:50288
    s_waitcnt lgkmcnt(14)
    v_mfma_f32_32x32x16_bf16 v[48:63], a[44:47], v[204:207], v[48:63]
    ds_read_b64_tr_b16 a[28:29], v249 offset:50096
    ds_read_b64_tr_b16 a[30:31], v249 offset:50336
    s_waitcnt vmcnt(25) lgkmcnt(14)
    v_mfma_f32_32x32x16_bf16 v[0:15], a[0:3], v[208:211], v[0:15]
    ds_read_b64_tr_b16 a[32:33], v249 offset:53760
    ds_read_b64_tr_b16 a[34:35], v249 offset:54000
    s_waitcnt lgkmcnt(14)
    v_mfma_f32_32x32x16_bf16 v[16:31], a[4:7], v[208:211], v[16:31]
    buffer_load_dwordx4 v252, s[24:27], s71 offen offset:2048 sc1 lds
    ds_read_b64_tr_b16 a[36:37], v249 offset:53824
    ds_read_b64_tr_b16 a[38:39], v249 offset:54064
    v_mfma_f32_16x16x32_bf16 a[60:63], a[208:211], a[92:95], a[60:63]
    s_waitcnt lgkmcnt(14)
    v_mfma_f32_32x32x16_bf16 v[32:47], a[8:11], v[208:211], v[32:47]
    buffer_load_dwordx4 v252, s[24:27], s71 offen offset:3072 sc1 lds
    s_add_u32 m0, m0, 4096
    s_add_u32 s71, s71, 4096
    ds_read_b64_tr_b16 a[40:41], v249 offset:53888
    ds_read_b64_tr_b16 a[42:43], v249 offset:54128
    s_waitcnt lgkmcnt(14)
    v_mfma_f32_32x32x16_bf16 v[48:63], a[12:15], v[208:211], v[48:63]
    ds_read_b64_tr_b16 a[44:45], v249 offset:53936
    ds_read_b64_tr_b16 a[46:47], v249 offset:54176
    s_waitcnt vmcnt(26) lgkmcnt(14)
    v_mfma_f32_32x32x16_bf16 v[0:15], a[16:19], v[212:215], v[0:15]
    ds_read_b64_tr_b16 a[0:1], v249 offset:57600
    ds_read_b64_tr_b16 a[2:3], v249 offset:57840
    s_waitcnt lgkmcnt(14)
    v_mfma_f32_32x32x16_bf16 v[16:31], a[20:23], v[212:215], v[16:31]
    buffer_load_dwordx4 v252, s[24:27], s71 offen offset:0 sc1 lds
    ds_read_b64_tr_b16 a[4:5], v249 offset:57664
    ds_read_b64_tr_b16 a[6:7], v249 offset:57904
    s_waitcnt lgkmcnt(14)
    v_mfma_f32_32x32x16_bf16 v[32:47], a[24:27], v[212:215], v[32:47]
    ds_read_b64_tr_b16 a[8:9], v249 offset:57728
    ds_read_b64_tr_b16 a[10:11], v249 offset:57968
    s_waitcnt lgkmcnt(14)
    v_mfma_f32_32x32x16_bf16 v[48:63], a[28:31], v[212:215], v[48:63]
    ds_read_b64_tr_b16 a[12:13], v249 offset:57776
    ds_read_b64_tr_b16 a[14:15], v249 offset:58016
    s_mov_b32 exec_hi, 0
    ds_write_b32 v238, a48 offset:36864
    ds_write_b32 v238, a52 offset:36868
    ds_write_b32 v238, a56 offset:36872
    ds_write_b32 v238, a60 offset:36876
    s_mov_b32 exec_hi, -1
    s_waitcnt vmcnt(26) lgkmcnt(14)
    v_mfma_f32_32x32x16_bf16 v[0:15], a[32:35], v[216:219], v[0:15]
    s_waitcnt lgkmcnt(12)
    v_mfma_f32_32x32x16_bf16 v[16:31], a[36:39], v[216:219], v[16:31]
    s_waitcnt lgkmcnt(10)
    v_mfma_f32_32x32x16_bf16 v[32:47], a[40:43], v[216:219], v[32:47]
    s_waitcnt lgkmcnt(8)
    v_mfma_f32_32x32x16_bf16 v[48:63], a[44:47], v[216:219], v[48:63]
    s_waitcnt vmcnt(25) lgkmcnt(6)
    v_mfma_f32_32x32x16_bf16 v[0:15], a[0:3], v[220:223], v[0:15]
    s_waitcnt lgkmcnt(4)
    v_mfma_f32_32x32x16_bf16 v[16:31], a[4:7], v[220:223], v[16:31]
    s_waitcnt lgkmcnt(2)
    v_mfma_f32_32x32x16_bf16 v[32:47], a[8:11], v[220:223], v[32:47]
    s_waitcnt lgkmcnt(0)
    v_mfma_f32_32x32x16_bf16 v[48:63], a[12:15], v[220:223], v[48:63]
    s_barrier
    ds_read_b128 v[68:71], v64 offset:0
    ds_read_b128 v[72:75], v64 offset:512
    ds_read_b128 v[76:79], v64 offset:1024
    ds_read_b128 v[80:83], v64 offset:1536
    s_waitcnt lgkmcnt(0)
    v_add_f32 v69, v69, v73
    v_add_f32 v77, v77, v81
    v_add_f32 v69, v69, v77
    v_and_b32 v73, 0xffff0000, v69
    v_sub_f32 v69, v69, v73
    v_cvt_pk_bf16_f32 v69, v73, v69
    v_lshrrev_b32 v73, 16, v73
    v_accvgpr_write_b32 a222, v69
    v_accvgpr_write_b32 a223, v73
    s_nop 1
    v_mfma_f32_32x32x8_bf16 v[16:31], a[222:223], v[244:245], v[16:31]
    v_add_f32 v71, v71, v75
    v_add_f32 v79, v79, v83
    v_add_f32 v71, v71, v79
    v_and_b32 v75, 0xffff0000, v71
    v_sub_f32 v71, v71, v75
    v_cvt_pk_bf16_f32 v71, v75, v71
    v_lshrrev_b32 v75, 16, v75
    v_accvgpr_write_b32 a226, v71
    v_accvgpr_write_b32 a227, v75
    s_nop 1
    v_mfma_f32_32x32x8_bf16 v[48:63], a[226:227], v[244:245], v[48:63]
    v_add_f32 v70, v70, v74
    v_add_f32 v78, v78, v82
    v_add_f32 v70, v70, v78
    v_and_b32 v74, 0xffff0000, v70
    v_sub_f32 v70, v70, v74
    v_cvt_pk_bf16_f32 v70, v74, v70
    v_lshrrev_b32 v74, 16, v74
    v_accvgpr_write_b32 a224, v70
    v_accvgpr_write_b32 a225, v74
    s_nop 1
    v_mfma_f32_32x32x8_bf16 v[32:47], a[224:225], v[244:245], v[32:47]
    v_add_f32 v68, v68, v72
    v_add_f32 v76, v76, v80
    v_add_f32 v68, v68, v76
    v_and_b32 v72, 0xffff0000, v68
    v_sub_f32 v68, v68, v72
    v_cvt_pk_bf16_f32 v68, v72, v68
    v_lshrrev_b32 v72, 16, v72
    v_accvgpr_write_b32 a220, v68
    v_accvgpr_write_b32 a221, v72
    s_nop 1
    v_mfma_f32_32x32x8_bf16 v[0:15], a[220:221], v[244:245], v[0:15]
EPI_A:
    ds_write_b64 v227, v[110:111] offset:21120
    s_nop 5
    v_fma_f32 v16, v16, v224, s60
    v_fma_f32 v17, v17, v224, s60
    v_fma_f32 v18, v18, v224, s60
    v_fma_f32 v19, v19, v224, s60
    v_fma_f32 v20, v20, v224, s60
    v_fma_f32 v21, v21, v224, s60
    v_fma_f32 v22, v22, v224, s60
    v_fma_f32 v23, v23, v224, s60
    v_fma_f32 v24, v24, v224, s60
    v_fma_f32 v25, v25, v224, s60
    v_fma_f32 v26, v26, v224, s60
    v_fma_f32 v27, v27, v224, s60
    v_fma_f32 v28, v28, v224, s60
    v_fma_f32 v29, v29, v224, s60
    v_fma_f32 v30, v30, v224, s60
    v_fma_f32 v31, v31, v224, s60
    v_fma_f32 v56, v56, v224, s60
    v_fma_f32 v57, v57, v224, s60
    v_fma_f32 v58, v58, v224, s60
    v_fma_f32 v59, v59, v224, s60
    v_exp_f32_e64 v64, v16 clamp
    v_max_f32 v16, s60, v16
    v_exp_f32_e64 v65, v17 clamp
    v_max_f32 v17, s60, v17
    v_exp_f32_e64 v66, v18 clamp
    v_max_f32 v18, s60, v18
    v_exp_f32_e64 v67, v19 clamp
    v_max_f32 v19, s60, v19
    v_exp_f32_e64 v68, v20 clamp
    v_max_f32 v20, s60, v20
    v_exp_f32_e64 v69, v21 clamp
    v_max_f32 v21, s60, v21
    v_exp_f32_e64 v70, v22 clamp
    v_max_f32 v22, s60, v22
    v_exp_f32_e64 v71, v23 clamp
    v_max_f32 v23, s60, v23
    v_exp_f32_e64 v72, v24 clamp
    v_max_f32 v24, s60, v24
    v_exp_f32_e64 v73, v25 clamp
    v_max_f32 v25, s60, v25
    v_exp_f32_e64 v74, v26 clamp
    v_max_f32 v26, s60, v26
    v_exp_f32_e64 v75, v27 clamp
    v_max_f32 v27, s60, v27
    v_exp_f32_e64 v76, v28 clamp
    v_max_f32 v28, s60, v28
    v_exp_f32_e64 v77, v29 clamp
    v_max_f32 v29, s60, v29
    v_exp_f32_e64 v78, v30 clamp
    v_max_f32 v30, s60, v30
    v_exp_f32_e64 v79, v31 clamp
    v_max_f32 v31, s60, v31
    v_exp_f32_e64 v80, v56 clamp
    v_max_f32 v56, s60, v56
    v_exp_f32_e64 v81, v57 clamp
    v_max_f32 v57, s60, v57
    v_exp_f32_e64 v82, v58 clamp
    v_max_f32 v58, s60, v58
    v_exp_f32_e64 v83, v59 clamp
    v_max_f32 v59, s60, v59
    v_fmac_f32 v64, s61, v16
    v_fmac_f32 v65, s61, v17
    v_fmac_f32 v66, s61, v18
    v_fmac_f32 v67, s61, v19
    v_fmac_f32 v68, s61, v20
    v_fmac_f32 v69, s61, v21
    v_fmac_f32 v70, s61, v22
    v_fmac_f32 v71, s61, v23
    v_fmac_f32 v72, s61, v24
    v_fmac_f32 v73, s61, v25
    v_fmac_f32 v74, s61, v26
    v_fmac_f32 v75, s61, v27
    v_fmac_f32 v76, s61, v28
    v_fmac_f32 v77, s61, v29
    v_fmac_f32 v78, s61, v30
    v_fmac_f32 v79, s61, v31
    v_fmac_f32 v80, s61, v56
    v_fmac_f32 v81, s61, v57
    v_fmac_f32 v82, s61, v58
    v_fmac_f32 v83, s61, v59
    v_cvt_pk_bf16_f32 v88, v64, v65
    v_cvt_pk_bf16_f32 v89, v66, v67
    v_cvt_pk_bf16_f32 v90, v68, v69
    v_cvt_pk_bf16_f32 v91, v70, v71
    v_cvt_pk_bf16_f32 v92, v72, v73
    v_cvt_pk_bf16_f32 v93, v74, v75
    v_cvt_pk_bf16_f32 v94, v76, v77
    v_cvt_pk_bf16_f32 v95, v78, v79
    v_cvt_pk_bf16_f32 v96, v80, v81
    v_cvt_pk_bf16_f32 v97, v82, v83
    ds_write_b64 v227, v[88:89] offset:0
    ds_write_b64 v227, v[90:91] offset:2112
    ds_write_b64 v227, v[92:93] offset:4224
    ds_write_b64 v227, v[94:95] offset:6336
    ds_write_b64 v227, v[96:97] offset:8448
    v_pk_mul_f32 v[32:33], v[32:33], v[242:243] op_sel_hi:[1,0]
    v_pk_mul_f32 v[34:35], v[34:35], v[242:243] op_sel_hi:[1,0]
    v_pk_mul_f32 v[36:37], v[36:37], v[242:243] op_sel_hi:[1,0]
    v_pk_mul_f32 v[38:39], v[38:39], v[242:243] op_sel_hi:[1,0]
    v_pk_mul_f32 v[40:41], v[40:41], v[242:243] op_sel_hi:[1,0]
    v_pk_mul_f32 v[42:43], v[42:43], v[242:243] op_sel_hi:[1,0]
    v_pk_mul_f32 v[44:45], v[44:45], v[242:243] op_sel_hi:[1,0]
    v_pk_mul_f32 v[46:47], v[46:47], v[242:243] op_sel_hi:[1,0]
    v_pk_mul_f32 v[60:61], v[60:61], v[242:243] op_sel_hi:[1,0]
    v_pk_mul_f32 v[62:63], v[62:63], v[242:243] op_sel_hi:[1,0]
    v_cvt_pk_bf16_f32 v100, v32, v33
    v_cvt_pk_bf16_f32 v101, v34, v35
    v_cvt_pk_bf16_f32 v102, v36, v37
    v_cvt_pk_bf16_f32 v103, v38, v39
    v_cvt_pk_bf16_f32 v104, v40, v41
    v_cvt_pk_bf16_f32 v105, v42, v43
    v_cvt_pk_bf16_f32 v106, v44, v45
    v_cvt_pk_bf16_f32 v107, v46, v47
    v_cvt_pk_bf16_f32 v108, v60, v61
    v_cvt_pk_bf16_f32 v109, v62, v63
    ds_write_b64 v228, v[100:101] offset:10560
    ds_write_b64 v228, v[102:103] offset:11616
    ds_write_b64 v228, v[104:105] offset:14784
    ds_write_b64 v228, v[106:107] offset:15840
    ds_write_b64 v227, v[108:109] offset:19008
    s_waitcnt lgkmcnt(0)
    s_barrier
    s_cmp_gt_u32 s42, 1
    s_cbranch_scc1 KV_10
    ds_read_b64_tr_b16 v[128:129], v232 offset:0
    ds_read_b64_tr_b16 v[130:131], v232 offset:32
    ds_read_b64_tr_b16 v[132:133], v233 offset:10560
    ds_read_b64_tr_b16 v[134:135], v233 offset:10592
    ds_read_b64_tr_b16 v[136:137], v232 offset:128
    ds_read_b64_tr_b16 v[138:139], v232 offset:160
    ds_read_b64_tr_b16 v[140:141], v233 offset:10688
    ds_read_b64_tr_b16 v[142:143], v233 offset:10720
    ds_read_b64_tr_b16 v[144:145], v232 offset:256
    ds_read_b64_tr_b16 v[146:147], v232 offset:288
    ds_read_b64_tr_b16 v[148:149], v233 offset:10816
    ds_read_b64_tr_b16 v[150:151], v233 offset:10848
    s_waitcnt lgkmcnt(8)
    v_mfma_f32_32x32x16_bf16 v[112:127], v[128:131], v[132:135], 0
    ds_read_b64_tr_b16 v[152:153], v232 offset:384
    ds_read_b64_tr_b16 v[154:155], v232 offset:416
    ds_read_b64_tr_b16 v[156:157], v233 offset:10944
    ds_read_b64_tr_b16 v[158:159], v233 offset:10976
    s_waitcnt lgkmcnt(8)
    v_mfma_f32_32x32x16_bf16 v[112:127], v[136:139], v[140:143], v[112:127]
    ds_read_b64_tr_b16 v[160:161], v232 offset:512
    ds_read_b64_tr_b16 v[162:163], v232 offset:544
    ds_read_b64_tr_b16 v[164:165], v233 offset:11072
    ds_read_b64_tr_b16 v[166:167], v233 offset:11104
    s_waitcnt lgkmcnt(8)
    v_mfma_f32_32x32x16_bf16 v[112:127], v[144:147], v[148:151], v[112:127]
    ds_read_b64_tr_b16 v[168:169], v232 offset:640
    ds_read_b64_tr_b16 v[170:171], v232 offset:672
    ds_read_b64_tr_b16 v[172:173], v233 offset:11200
    ds_read_b64_tr_b16 v[174:175], v233 offset:11232
    s_waitcnt lgkmcnt(8)
    v_mfma_f32_32x32x16_bf16 v[112:127], v[152:155], v[156:159], v[112:127]
    ds_read_b64_tr_b16 v[176:177], v232 offset:768
    ds_read_b64_tr_b16 v[178:179], v232 offset:800
    ds_read_b64_tr_b16 v[180:181], v233 offset:11328
    ds_read_b64_tr_b16 v[182:183], v233 offset:11360
    s_waitcnt lgkmcnt(8)
    v_mfma_f32_32x32x16_bf16 v[112:127], v[160:163], v[164:167], v[112:127]
    ds_read_b64_tr_b16 v[184:185], v232 offset:896
    ds_read_b64_tr_b16 v[186:187], v232 offset:928
    ds_read_b64_tr_b16 v[188:189], v233 offset:11456
    ds_read_b64_tr_b16 v[190:191], v233 offset:11488
    s_waitcnt lgkmcnt(8)
    v_mfma_f32_32x32x16_bf16 v[112:127], v[168:171], v[172:175], v[112:127]
    s_waitcnt lgkmcnt(4)
    v_mfma_f32_32x32x16_bf16 v[112:127], v[176:179], v[180:183], v[112:127]
    s_waitcnt lgkmcnt(0)
    v_mfma_f32_32x32x16_bf16 v[112:127], v[184:187], v[188:191], v[112:127]
    s_nop 11
    buffer_store_dwordx4 v[112:115], v234, s[24:27], s55 offen sc1
    buffer_store_dwordx4 v[116:119], v234, s[24:27], s56 offen sc1
    buffer_store_dwordx4 v[120:123], v235, s[24:27], s54 offen sc1
KV_10:
    v_fma_f32 v0, v0, v224, s60
    v_fma_f32 v1, v1, v224, s60
    v_fma_f32 v2, v2, v224, s60
    v_fma_f32 v3, v3, v224, s60
    v_fma_f32 v4, v4, v224, s60
    v_fma_f32 v5, v5, v224, s60
    v_fma_f32 v6, v6, v224, s60
    v_fma_f32 v7, v7, v224, s60
    v_fma_f32 v8, v8, v224, s60
    v_fma_f32 v9, v9, v224, s60
    v_fma_f32 v10, v10, v224, s60
    v_fma_f32 v11, v11, v224, s60
    v_fma_f32 v12, v12, v224, s60
    v_fma_f32 v13, v13, v224, s60
    v_fma_f32 v14, v14, v224, s60
    v_fma_f32 v15, v15, v224, s60
    v_fma_f32 v52, v52, v224, s60
    v_fma_f32 v53, v53, v224, s60
    v_fma_f32 v54, v54, v224, s60
    v_fma_f32 v55, v55, v224, s60
    v_exp_f32_e64 v64, v0 clamp
    v_max_f32 v0, s60, v0
    v_exp_f32_e64 v65, v1 clamp
    v_max_f32 v1, s60, v1
    v_exp_f32_e64 v66, v2 clamp
    v_max_f32 v2, s60, v2
    v_exp_f32_e64 v67, v3 clamp
    v_max_f32 v3, s60, v3
    v_exp_f32_e64 v68, v4 clamp
    v_max_f32 v4, s60, v4
    v_exp_f32_e64 v69, v5 clamp
    v_max_f32 v5, s60, v5
    v_exp_f32_e64 v70, v6 clamp
    v_max_f32 v6, s60, v6
    v_exp_f32_e64 v71, v7 clamp
    v_max_f32 v7, s60, v7
    v_exp_f32_e64 v72, v8 clamp
    v_max_f32 v8, s60, v8
    v_exp_f32_e64 v73, v9 clamp
    v_max_f32 v9, s60, v9
    v_exp_f32_e64 v74, v10 clamp
    v_max_f32 v10, s60, v10
    v_exp_f32_e64 v75, v11 clamp
    v_max_f32 v11, s60, v11
    v_exp_f32_e64 v76, v12 clamp
    v_max_f32 v12, s60, v12
    v_exp_f32_e64 v77, v13 clamp
    v_max_f32 v13, s60, v13
    v_exp_f32_e64 v78, v14 clamp
    v_max_f32 v14, s60, v14
    v_exp_f32_e64 v79, v15 clamp
    v_max_f32 v15, s60, v15
    v_exp_f32_e64 v80, v52 clamp
    v_max_f32 v52, s60, v52
    v_exp_f32_e64 v81, v53 clamp
    v_max_f32 v53, s60, v53
    v_exp_f32_e64 v82, v54 clamp
    v_max_f32 v54, s60, v54
    v_exp_f32_e64 v83, v55 clamp
    v_max_f32 v55, s60, v55
    v_fmac_f32 v64, s61, v0
    v_fmac_f32 v65, s61, v1
    v_fmac_f32 v66, s61, v2
    v_fmac_f32 v67, s61, v3
    v_fmac_f32 v68, s61, v4
    v_fmac_f32 v69, s61, v5
    v_fmac_f32 v70, s61, v6
    v_fmac_f32 v71, s61, v7
    v_fmac_f32 v72, s61, v8
    v_fmac_f32 v73, s61, v9
    v_fmac_f32 v74, s61, v10
    v_fmac_f32 v75, s61, v11
    v_fmac_f32 v76, s61, v12
    v_fmac_f32 v77, s61, v13
    v_fmac_f32 v78, s61, v14
    v_fmac_f32 v79, s61, v15
    v_fmac_f32 v80, s61, v52
    v_fmac_f32 v81, s61, v53
    v_fmac_f32 v82, s61, v54
    v_fmac_f32 v83, s61, v55
    v_cvt_pk_bf16_f32 v88, v64, v65
    v_cvt_pk_bf16_f32 v89, v66, v67
    v_cvt_pk_bf16_f32 v90, v68, v69
    v_cvt_pk_bf16_f32 v91, v70, v71
    v_cvt_pk_bf16_f32 v92, v72, v73
    v_cvt_pk_bf16_f32 v93, v74, v75
    v_cvt_pk_bf16_f32 v94, v76, v77
    v_cvt_pk_bf16_f32 v95, v78, v79
    v_cvt_pk_bf16_f32 v96, v80, v81
    v_cvt_pk_bf16_f32 v97, v82, v83
    v_cndmask_b32_e64 v98, 0, v96, s[52:53]
    v_cndmask_b32_e64 v99, 0, v97, s[52:53]
    v_cndmask_b32_e64 v96, v96, 0, s[52:53]
    v_cndmask_b32_e64 v97, v97, 0, s[52:53]
    s_lshl_b32 s54, s42, 8
    s_add_u32 s63, s62, s54
    s_add_u32 s63, s63, 65536
    s_lshl_b32 s54, s42, 14
    s_add_u32 s62, s62, s54
    s_and_b32 s54, s42, 1
    s_lshl_b32 s55, s54, 3
    v_and_b32 v229, 15, v255
    v_lshrrev_b32 v230, 4, v255
    v_lshlrev_b32 v231, 4, v229
    v_lshl_add_u32 v231, v230, 10, v231
    v_and_b32 v232, s55, v229
    v_lshl_add_u32 v231, v232, 28, v231
    s_lshr_b32 s54, s42, 1
    s_lshl_b32 s54, s54, 10
    s_add_u32 s54, s54, s55
    s_add_u32 s54, s54, 129024
    v_add_u32 v228, s54, v252
    s_lshl_b32 s54, s42, 7
    s_add_u32 s54, s54, 131072
    v_lshl_add_u32 v229, v229, 3, s54
    v_lshl_add_u32 v229, v226, 1, v229
    v_and_b32 v230, 1, v230
    v_lshl_add_u32 v229, v230, 2, v229
    v_add_u32 v230, 129024, v252
    v_lshlrev_b32 v232, 3, v255
    v_add_u32 v232, 131072, v232
    s_add_u32 s45, s45, 16
    v_mov_b32 v247, 1
    s_waitcnt vmcnt(0)
    s_barrier
    s_cmp_lg_u32 s42, 0
    s_cbranch_scc1 SG_12
    s_mov_b64 exec, 0x3
    buffer_atomic_add v247, v254, s[24:27], s47 offen sc1
    s_mov_b64 exec, -1
SG_12:
    s_lshl_b32 s96, s42, 7
    s_add_u32 s96, s96, s51
    s_cmp_eq_u32 s42, 0
    s_cselect_b32 s100, s45, 16
    s_cmp_gt_u32 s42, 1
    s_cbranch_scc1 PX_15
    s_mov_b64 exec, 1
PL_13:
    v_mov_b32 v246, 0
    buffer_atomic_add v246, off, s[24:27], s96 sc0 sc1
    s_waitcnt vmcnt(0)
    v_cmp_gt_u32 vcc, s100, v246
    s_nop 4
    s_cbranch_vccz PD_14
    s_sub_u32 s48, s48, 1
    s_cmp_gt_i32 s48, 0
    s_cbranch_scc1 PL_13
    s_mov_b64 exec, -1
PX_15:
PD_14:
    s_mov_b64 exec, -1
    s_barrier
    buffer_load_dwordx4 v[64:67], v231, s[24:27], s63 offen sc1
    s_add_u32 s63, s63, 4096
    buffer_load_dwordx4 v[68:71], v231, s[24:27], s63 offen sc1
    s_add_u32 s63, s63, 4096
    buffer_load_dwordx4 v[72:75], v231, s[24:27], s63 offen sc1
    s_add_u32 s63, s63, 4096
    buffer_load_dwordx4 v[76:79], v231, s[24:27], s63 offen sc1
    buffer_load_dwordx4 v[0:3], v234, s[24:27], s62 offen offset:0 sc1
    buffer_load_dwordx4 v[4:7], v234, s[24:27], s62 offen offset:1024 sc1
    buffer_load_dwordx4 v[8:11], v234, s[24:27], s62 offen offset:2048 sc1
    buffer_load_dwordx4 v[12:15], v234, s[24:27], s62 offen offset:3072 sc1
    s_add_u32 s62, s62, 4096
    buffer_load_dwordx4 v[16:19], v234, s[24:27], s62 offen offset:0 sc1
    buffer_load_dwordx4 v[20:23], v234, s[24:27], s62 offen offset:1024 sc1
    buffer_load_dwordx4 v[24:27], v234, s[24:27], s62 offen offset:2048 sc1
    buffer_load_dwordx4 v[28:31], v234, s[24:27], s62 offen offset:3072 sc1
    s_add_u32 s62, s62, 4096
    buffer_load_dwordx4 v[32:35], v234, s[24:27], s62 offen offset:0 sc1
    buffer_load_dwordx4 v[36:39], v234, s[24:27], s62 offen offset:1024 sc1
    buffer_load_dwordx4 v[40:43], v234, s[24:27], s62 offen offset:2048 sc1
    buffer_load_dwordx4 v[44:47], v234, s[24:27], s62 offen offset:3072 sc1
    s_add_u32 s62, s62, 4096
    buffer_load_dwordx4 v[48:51], v234, s[24:27], s62 offen offset:0 sc1
    buffer_load_dwordx4 v[52:55], v234, s[24:27], s62 offen offset:1024 sc1
    buffer_load_dwordx4 v[56:59], v234, s[24:27], s62 offen offset:2048 sc1
    buffer_load_dwordx4 v[60:63], v234, s[24:27], s62 offen offset:3072 sc1
    s_waitcnt vmcnt(16)
    v_pk_add_f32 v[64:65], v[64:65], v[68:69]
    v_pk_add_f32 v[66:67], v[66:67], v[70:71]
    v_pk_add_f32 v[72:73], v[72:73], v[76:77]
    v_pk_add_f32 v[74:75], v[74:75], v[78:79]
    v_pk_add_f32 v[64:65], v[64:65], v[72:73]
    v_pk_add_f32 v[66:67], v[66:67], v[74:75]
    s_nop 0
    v_permlane32_swap_b32 v64, v65
    v_permlane32_swap_b32 v66, v67
    v_add_f32 v64, v64, v65
    v_add_f32 v66, v66, v67
    s_nop 1
    v_permlane16_swap_b32 v64, v66
    v_add_f32 v64, v64, v66
    v_cvt_pk_bf16_f32 v64, v64, v64
    ds_write_b16 v229, v64
    s_waitcnt vmcnt(12)
    v_pk_add_f32 v[0:1], v[0:1], v[4:5]
    v_pk_add_f32 v[2:3], v[2:3], v[6:7]
    v_pk_add_f32 v[8:9], v[8:9], v[12:13]
    v_pk_add_f32 v[10:11], v[10:11], v[14:15]
    s_waitcnt vmcnt(8)
    v_pk_add_f32 v[16:17], v[16:17], v[20:21]
    v_pk_add_f32 v[18:19], v[18:19], v[22:23]
    v_pk_add_f32 v[24:25], v[24:25], v[28:29]
    v_pk_add_f32 v[26:27], v[26:27], v[30:31]
    v_pk_add_f32 v[0:1], v[0:1], v[16:17]
    v_pk_add_f32 v[2:3], v[2:3], v[18:19]
    v_pk_add_f32 v[8:9], v[8:9], v[24:25]
    v_pk_add_f32 v[10:11], v[10:11], v[26:27]
    s_waitcnt vmcnt(4)
    v_pk_add_f32 v[32:33], v[32:33], v[36:37]
    v_pk_add_f32 v[34:35], v[34:35], v[38:39]
    v_pk_add_f32 v[40:41], v[40:41], v[44:45]
    v_pk_add_f32 v[42:43], v[42:43], v[46:47]
    v_pk_add_f32 v[0:1], v[0:1], v[32:33]
    v_pk_add_f32 v[2:3], v[2:3], v[34:35]
    v_pk_add_f32 v[8:9], v[8:9], v[40:41]
    v_pk_add_f32 v[10:11], v[10:11], v[42:43]
    s_waitcnt vmcnt(0)
    v_pk_add_f32 v[48:49], v[48:49], v[52:53]
    v_pk_add_f32 v[50:51], v[50:51], v[54:55]
    v_pk_add_f32 v[56:57], v[56:57], v[60:61]
    v_pk_add_f32 v[58:59], v[58:59], v[62:63]
    v_pk_add_f32 v[0:1], v[0:1], v[48:49]
    v_pk_add_f32 v[2:3], v[2:3], v[50:51]
    v_pk_add_f32 v[8:9], v[8:9], v[56:57]
    v_pk_add_f32 v[10:11], v[10:11], v[58:59]
    v_pk_add_f32 v[0:1], v[0:1], v[8:9]
    v_pk_add_f32 v[2:3], v[2:3], v[10:11]
    v_cvt_pk_bf16_f32 v4, v0, v1
    v_cvt_pk_bf16_f32 v5, v2, v3
    ds_write_b64 v228, v[4:5]
    s_waitcnt lgkmcnt(0)
    s_barrier
    ds_read_b128 v[100:103], v230
    ds_read_b128 v[104:107], v230 offset:1024
    ds_read_b64 v[108:109], v232
    s_waitcnt lgkmcnt(0)
    v_mfma_f32_32x32x16_bf16 v[160:175], v[100:103], v[88:91], 0
    v_mfma_f32_32x32x16_bf16 v[176:191], v[104:107], v[92:95], 0
    v_mfma_f32_32x32x8_bf16 v[160:175], v[108:109], v[96:97], v[160:175]
    v_mfma_f32_32x32x8_bf16 v[176:191], v[108:109], v[98:99], v[176:191]
    s_mov_b32 s60, 0x358637bd
FIN:
    s_lshl_b32 s54, s40, 2
    s_add_u32 s54, s54, s42
    s_mul_i32 s54, s54, 40960
    s_mul_i32 s55, s41, 1280
    s_add_u32 s54, s54, s55
    s_mul_i32 s62, s43, 2621440
    s_add_u32 s62, s62, 9437184
    s_add_u32 s54, s54, s62
    v_mov_b32 v196, 0x80000000
    v_cndmask_b32_e64 v196, v253, v196, s[52:53]
    v_mov_b32 v192, v168
    v_mov_b32 v194, v184
    s_nop 1
    v_permlane32_swap_b32 v192, v194
    v_add_f32 v194, s60, v194
    v_rcp_f32 v194, v194
    s_nop 0
    v_mov_b32 v192, v194
    s_nop 1
    v_permlane32_swap_b32 v192, v194
    v_pk_mul_f32 v[160:161], v[160:161], v[192:193] op_sel_hi:[1,0]
    v_pk_mul_f32 v[162:163], v[162:163], v[192:193] op_sel_hi:[1,0]
    v_pk_mul_f32 v[164:165], v[164:165], v[192:193] op_sel_hi:[1,0]
    v_pk_mul_f32 v[166:167], v[166:167], v[192:193] op_sel_hi:[1,0]
    v_pk_mul_f32 v[168:169], v[168:169], v[192:193] op_sel_hi:[1,0]
    v_pk_mul_f32 v[170:171], v[170:171], v[192:193] op_sel_hi:[1,0]
    v_pk_mul_f32 v[176:177], v[176:177], v[194:195] op_sel_hi:[1,0]
    v_pk_mul_f32 v[178:179], v[178:179], v[194:195] op_sel_hi:[1,0]
    v_pk_mul_f32 v[180:181], v[180:181], v[194:195] op_sel_hi:[1,0]
    v_pk_mul_f32 v[182:183], v[182:183], v[194:195] op_sel_hi:[1,0]
    v_pk_mul_f32 v[184:185], v[184:185], v[194:195] op_sel_hi:[1,0]
    v_pk_mul_f32 v[186:187], v[186:187], v[194:195] op_sel_hi:[1,0]
    v_cvt_pk_bf16_f32 v200, v160, v161
    v_cvt_pk_bf16_f32 v201, v162, v163
    v_cvt_pk_bf16_f32 v202, v164, v165
    v_cvt_pk_bf16_f32 v203, v166, v167
    buffer_store_dwordx4 v[200:203], v253, s[24:27], s54 offen sc1
    v_cvt_pk_bf16_f32 v204, v176, v177
    v_cvt_pk_bf16_f32 v205, v178, v179
    v_cvt_pk_bf16_f32 v206, v180, v181
    v_cvt_pk_bf16_f32 v207, v182, v183
    buffer_store_dwordx4 v[204:207], v253, s[24:27], s54 offen offset:768 sc1
    v_cvt_pk_bf16_f32 v208, v168, v169
    v_cvt_pk_bf16_f32 v209, v170, v171
    v_cvt_pk_bf16_f32 v210, v184, v185
    v_cvt_pk_bf16_f32 v211, v186, v187
    buffer_store_dwordx4 v[208:211], v196, s[24:27], s54 offen offset:512 sc1
    s_lshr_b32 s54, s41, 3
    s_lshl_b32 s54, s54, 2
    s_lshl_b32 s55, s40, 3
    s_add_u32 s54, s54, s55
    s_add_u32 s63, s54, s42
    v_lshrrev_b32 v100, 5, v255
    v_bfe_u32 v101, v255, 4, 1
    v_lshl_add_u32 v106, v101, 1, v100
    v_and_b32 v107, 15, v255
    s_mul_i32 s54, s63, 20480
    s_add_u32 s62, s62, s54
    v_bfe_u32 v102, v255, 2, 2
    v_and_b32 v103, 3, v255
    v_lshl_add_u32 v104, v100, 2, v101
    v_lshl_add_u32 v104, v104, 2, v102
    v_mul_u32_u24 v104, 160, v104
    v_lshl_add_u32 v104, v103, 3, v104
    v_add_u32 v105, 51200, v104
    s_cmp_eq_u32 s43, 3
    s_cselect_b32 s61, 0x80000000, 0
    v_or_b32 v111, s61, v252
    s_waitcnt vmcnt(3)
    s_barrier
    s_mul_i32 s54, s42, 15360
    s_add_u32 m0, s54, 102400
    s_add_u32 s71, s54, s68
    s_add_u32 s71, s71, 92160
    buffer_load_dwordx4 v111, s[24:27], s71 offen offset:0 sc1 lds
    ds_read_b64_tr_b16 a[0:1], v104 offset:0
    ds_read_b64_tr_b16 a[2:3], v104 offset:1280
    ds_read_b64_tr_b16 a[4:5], v104 offset:32
    ds_read_b64_tr_b16 a[6:7], v104 offset:1312
    ds_read_b64_tr_b16 a[8:9], v104 offset:64
    ds_read_b64_tr_b16 a[10:11], v104 offset:1344
    ds_read_b64_tr_b16 a[12:13], v104 offset:96
    ds_read_b64_tr_b16 a[14:15], v104 offset:1376
    buffer_load_dwordx4 v111, s[24:27], s71 offen offset:1024 sc1 lds
    ds_read_b64_tr_b16 a[16:17], v104 offset:128
    ds_read_b64_tr_b16 a[18:19], v104 offset:1408
    ds_read_b64_tr_b16 a[20:21], v104 offset:5120
    ds_read_b64_tr_b16 a[22:23], v104 offset:6400
    ds_read_b64_tr_b16 a[24:25], v104 offset:5152
    ds_read_b64_tr_b16 a[26:27], v104 offset:6432
    ds_read_b64_tr_b16 a[28:29], v104 offset:5184
    ds_read_b64_tr_b16 a[30:31], v104 offset:6464
    buffer_load_dwordx4 v111, s[24:27], s71 offen offset:2048 sc1 lds
    ds_read_b64_tr_b16 a[32:33], v104 offset:5216
    ds_read_b64_tr_b16 a[34:35], v104 offset:6496
    ds_read_b64_tr_b16 a[36:37], v104 offset:5248
    ds_read_b64_tr_b16 a[38:39], v104 offset:6528
    ds_read_b64_tr_b16 a[40:41], v104 offset:10240
    ds_read_b64_tr_b16 a[42:43], v104 offset:11520
    ds_read_b64_tr_b16 a[44:45], v104 offset:10272
    ds_read_b64_tr_b16 a[46:47], v104 offset:11552
    ds_read_b64_tr_b16 a[48:49], v104 offset:10304
    ds_read_b64_tr_b16 a[50:51], v104 offset:11584
    buffer_load_dwordx4 v111, s[24:27], s71 offen offset:3072 sc1 lds
    s_add_u32 m0, m0, 4096
    s_add_u32 s71, s71, 4096
    ds_read_b64_tr_b16 a[52:53], v104 offset:10336
    ds_read_b64_tr_b16 a[54:55], v104 offset:11616
    ds_read_b64_tr_b16 a[56:57], v104 offset:10368
    ds_read_b64_tr_b16 a[58:59], v104 offset:11648
    ds_read_b64_tr_b16 a[60:61], v104 offset:15360
    ds_read_b64_tr_b16 a[62:63], v104 offset:16640
    ds_read_b64_tr_b16 a[64:65], v104 offset:15392
    ds_read_b64_tr_b16 a[66:67], v104 offset:16672
    buffer_load_dwordx4 v111, s[24:27], s71 offen offset:0 sc1 lds
    ds_read_b64_tr_b16 a[68:69], v104 offset:15424
    ds_read_b64_tr_b16 a[70:71], v104 offset:16704
    ds_read_b64_tr_b16 a[72:73], v104 offset:15456
    ds_read_b64_tr_b16 a[74:75], v104 offset:16736
    ds_read_b64_tr_b16 a[76:77], v104 offset:15488
    ds_read_b64_tr_b16 a[78:79], v104 offset:16768
    ds_read_b64_tr_b16 a[80:81], v104 offset:20480
    ds_read_b64_tr_b16 a[82:83], v104 offset:21760
    ds_read_b64_tr_b16 a[84:85], v104 offset:20512
    ds_read_b64_tr_b16 a[86:87], v104 offset:21792
    s_add_u32 s44, s44, 16
    v_mov_b32 v247, 1
    s_waitcnt vmcnt(5)
    s_barrier
    s_cmp_lg_u32 s42, 0
    s_cbranch_scc1 SG_16
    s_mov_b64 exec, 0x3
    buffer_atomic_add v247, v254, s[24:27], s76 offen sc1
    s_mov_b64 exec, -1
SG_16:
    buffer_load_dwordx4 v111, s[24:27], s71 offen offset:1024 sc1 lds
    ds_read_b64_tr_b16 a[88:89], v104 offset:20544
    ds_read_b64_tr_b16 a[90:91], v104 offset:21824
    ds_read_b64_tr_b16 a[92:93], v104 offset:20576
    ds_read_b64_tr_b16 a[94:95], v104 offset:21856
    buffer_load_dwordx4 v111, s[24:27], s71 offen offset:2048 sc1 lds
    ds_read_b64_tr_b16 a[96:97], v104 offset:20608
    ds_read_b64_tr_b16 a[98:99], v104 offset:21888
    ds_read_b64_tr_b16 a[100:101], v104 offset:25600
    ds_read_b64_tr_b16 a[102:103], v104 offset:26880
    ds_read_b64_tr_b16 a[104:105], v104 offset:25632
    ds_read_b64_tr_b16 a[106:107], v104 offset:26912
    buffer_load_dwordx4 v111, s[24:27], s71 offen offset:3072 sc1 lds
    s_add_u32 m0, m0, 4096
    s_add_u32 s71, s71, 4096
    ds_read_b64_tr_b16 a[108:109], v104 offset:25664
    ds_read_b64_tr_b16 a[110:111], v104 offset:26944
    ds_read_b64_tr_b16 a[112:113], v104 offset:25696
    ds_read_b64_tr_b16 a[114:115], v104 offset:26976
    ds_read_b64_tr_b16 a[116:117], v104 offset:25728
    ds_read_b64_tr_b16 a[118:119], v104 offset:27008
    buffer_load_dwordx4 v111, s[24:27], s71 offen offset:0 sc1 lds
    ds_read_b64_tr_b16 a[120:121], v104 offset:30720
    ds_read_b64_tr_b16 a[122:123], v104 offset:32000
    ds_read_b64_tr_b16 a[124:125], v104 offset:30752
    ds_read_b64_tr_b16 a[126:127], v104 offset:32032
    ds_read_b64_tr_b16 a[128:129], v104 offset:30784
    ds_read_b64_tr_b16 a[130:131], v104 offset:32064
    buffer_load_dwordx4 v111, s[24:27], s71 offen offset:1024 sc1 lds
    ds_read_b64_tr_b16 a[132:133], v104 offset:30816
    ds_read_b64_tr_b16 a[134:135], v104 offset:32096
    ds_read_b64_tr_b16 a[136:137], v104 offset:30848
    ds_read_b64_tr_b16 a[138:139], v104 offset:32128
    ds_read_b64_tr_b16 a[140:141], v104 offset:35840
    ds_read_b64_tr_b16 a[142:143], v104 offset:37120
    buffer_load_dwordx4 v111, s[24:27], s71 offen offset:2048 sc1 lds
    ds_read_b64_tr_b16 a[144:145], v104 offset:35872
    ds_read_b64_tr_b16 a[146:147], v104 offset:37152
    ds_read_b64_tr_b16 a[148:149], v104 offset:35904
    ds_read_b64_tr_b16 a[150:151], v104 offset:37184
    buffer_load_dwordx4 v111, s[24:27], s71 offen offset:3072 sc1 lds
    s_add_u32 m0, m0, 4096
    s_add_u32 s71, s71, 4096
    ds_read_b64_tr_b16 a[152:153], v104 offset:35936
    ds_read_b64_tr_b16 a[154:155], v104 offset:37216
    ds_read_b64_tr_b16 a[156:157], v104 offset:35968
    ds_read_b64_tr_b16 a[158:159], v104 offset:37248
    ds_read_b64_tr_b16 a[160:161], v104 offset:40960
    ds_read_b64_tr_b16 a[162:163], v104 offset:42240
    buffer_load_dwordx4 v111, s[24:27], s71 offen offset:0 sc1 lds
    ds_read_b64_tr_b16 a[164:165], v104 offset:40992
    ds_read_b64_tr_b16 a[166:167], v104 offset:42272
    ds_read_b64_tr_b16 a[168:169], v104 offset:41024
    ds_read_b64_tr_b16 a[170:171], v104 offset:42304
    ds_read_b64_tr_b16 a[172:173], v104 offset:41056
    ds_read_b64_tr_b16 a[174:175], v104 offset:42336
    buffer_load_dwordx4 v111, s[24:27], s71 offen offset:1024 sc1 lds
    ds_read_b64_tr_b16 a[176:177], v104 offset:41088
    ds_read_b64_tr_b16 a[178:179], v104 offset:42368
    ds_read_b64_tr_b16 a[180:181], v104 offset:46080
    ds_read_b64_tr_b16 a[182:183], v104 offset:47360
    ds_read_b64_tr_b16 a[184:185], v104 offset:46112
    ds_read_b64_tr_b16 a[186:187], v104 offset:47392
    buffer_load_dwordx4 v111, s[24:27], s71 offen offset:2048 sc1 lds
    ds_read_b64_tr_b16 a[188:189], v104 offset:46144
    ds_read_b64_tr_b16 a[190:191], v104 offset:47424
    ds_read_b64_tr_b16 a[192:193], v104 offset:46176
    ds_read_b64_tr_b16 a[194:195], v104 offset:47456
    ds_read_b64_tr_b16 a[196:197], v104 offset:46208
    ds_read_b64_tr_b16 a[198:199], v104 offset:47488
    s_cmp_gt_u32 s42, 0
    s_cbranch_scc1 PX_19
    s_mov_b64 exec, 1
PL_17:
    v_mov_b32 v246, 0
    buffer_atomic_add v246, off, s[24:27], s49 sc0 sc1
    s_waitcnt vmcnt(0)
    v_cmp_gt_u32 vcc, s44, v246
    s_nop 4
    s_cbranch_vccz PD_18
    s_sub_u32 s48, s48, 1
    s_cmp_gt_i32 s48, 0
    s_cbranch_scc1 PL_17
    s_mov_b64 exec, -1
PX_19:
PD_18:
    s_mov_b64 exec, -1
    s_barrier
    buffer_load_dwordx4 v[0:3], v252, s[24:27], s62 offen offset:0 sc1
    buffer_load_dwordx4 v[4:7], v252, s[24:27], s62 offen offset:1024 sc1
    buffer_load_dwordx4 v[8:11], v252, s[24:27], s62 offen offset:2048 sc1
    buffer_load_dwordx4 v[12:15], v252, s[24:27], s62 offen offset:3072 sc1
    s_add_u32 s62, s62, 4096
    buffer_load_dwordx4 v[16:19], v252, s[24:27], s62 offen offset:0 sc1
    buffer_load_dwordx4 v[20:23], v252, s[24:27], s62 offen offset:1024 sc1
    buffer_load_dwordx4 v[24:27], v252, s[24:27], s62 offen offset:2048 sc1
    buffer_load_dwordx4 v[28:31], v252, s[24:27], s62 offen offset:3072 sc1
    s_add_u32 s62, s62, 4096
    buffer_load_dwordx4 v[32:35], v252, s[24:27], s62 offen offset:0 sc1
    buffer_load_dwordx4 v[36:39], v252, s[24:27], s62 offen offset:1024 sc1
    s_mul_i32 s54, s42, 12288
    s_add_u32 m0, s54, 0
    s_add_u32 s71, s54, s68
    s_waitcnt vmcnt(9) lgkmcnt(0)
    v_mfma_f32_16x16x32_bf16 a[236:239], a[0:3], v[0:3], a[236:239]
    buffer_load_dwordx4 v[40:43], v252, s[24:27], s62 offen offset:2048 sc1
    ds_read_b64_tr_b16 a[200:201], v105 offset:0
    ds_read_b64_tr_b16 a[202:203], v105 offset:1280
    v_mfma_f32_16x16x32_bf16 a[240:243], a[4:7], v[0:3], a[240:243]
    ds_read_b64_tr_b16 a[204:205], v105 offset:32
    ds_read_b64_tr_b16 a[206:207], v105 offset:1312
    v_mfma_f32_16x16x32_bf16 a[244:247], a[8:11], v[0:3], a[244:247]
    ds_read_b64_tr_b16 a[0:1], v105 offset:64
    ds_read_b64_tr_b16 a[2:3], v105 offset:1344
    v_mfma_f32_16x16x32_bf16 a[248:251], a[12:15], v[0:3], a[248:251]
    ds_read_b64_tr_b16 a[4:5], v105 offset:96
    ds_read_b64_tr_b16 a[6:7], v105 offset:1376
    v_mfma_f32_16x16x32_bf16 a[252:255], a[16:19], v[0:3], a[252:255]
    ds_read_b64_tr_b16 a[8:9], v105 offset:128
    ds_read_b64_tr_b16 a[10:11], v105 offset:1408
    s_waitcnt vmcnt(9)
    v_mfma_f32_16x16x32_bf16 a[236:239], a[20:23], v[4:7], a[236:239]
    buffer_load_dwordx4 v[44:47], v252, s[24:27], s62 offen offset:3072 sc1
    s_add_u32 s62, s62, 4096
    v_mfma_f32_16x16x32_bf16 a[240:243], a[24:27], v[4:7], a[240:243]
    ds_read_b64_tr_b16 a[12:13], v105 offset:5120
    ds_read_b64_tr_b16 a[14:15], v105 offset:6400
    v_mfma_f32_16x16x32_bf16 a[244:247], a[28:31], v[4:7], a[244:247]
    ds_read_b64_tr_b16 a[16:17], v105 offset:5152
    ds_read_b64_tr_b16 a[18:19], v105 offset:6432
    v_mfma_f32_16x16x32_bf16 a[248:251], a[32:35], v[4:7], a[248:251]
    ds_read_b64_tr_b16 a[20:21], v105 offset:5184
    ds_read_b64_tr_b16 a[22:23], v105 offset:6464
    v_mfma_f32_16x16x32_bf16 a[252:255], a[36:39], v[4:7], a[252:255]
    ds_read_b64_tr_b16 a[24:25], v105 offset:5216
    ds_read_b64_tr_b16 a[26:27], v105 offset:6496
    s_waitcnt vmcnt(9)
    v_mfma_f32_16x16x32_bf16 a[236:239], a[40:43], v[8:11], a[236:239]
    buffer_load_dwordx4 v[48:51], v252, s[24:27], s62 offen offset:0 sc1
    ds_read_b64_tr_b16 a[28:29], v105 offset:5248
    ds_read_b64_tr_b16 a[30:31], v105 offset:6528
    v_mfma_f32_16x16x32_bf16 a[240:243], a[44:47], v[8:11], a[240:243]
    v_mfma_f32_16x16x32_bf16 a[244:247], a[48:51], v[8:11], a[244:247]
    ds_read_b64_tr_b16 a[32:33], v105 offset:10240
    ds_read_b64_tr_b16 a[34:35], v105 offset:11520
    v_mfma_f32_16x16x32_bf16 a[248:251], a[52:55], v[8:11], a[248:251]
    ds_read_b64_tr_b16 a[36:37], v105 offset:10272
    ds_read_b64_tr_b16 a[38:39], v105 offset:11552
    v_mfma_f32_16x16x32_bf16 a[252:255], a[56:59], v[8:11], a[252:255]
    ds_read_b64_tr_b16 a[40:41], v105 offset:10304
    ds_read_b64_tr_b16 a[42:43], v105 offset:11584
    s_waitcnt vmcnt(9)
    v_mfma_f32_16x16x32_bf16 a[236:239], a[60:63], v[12:15], a[236:239]
    buffer_load_dwordx4 v[52:55], v252, s[24:27], s62 offen offset:1024 sc1
    ds_read_b64_tr_b16 a[44:45], v105 offset:10336
    ds_read_b64_tr_b16 a[46:47], v105 offset:11616
    v_mfma_f32_16x16x32_bf16 a[240:243], a[64:67], v[12:15], a[240:243]
    ds_read_b64_tr_b16 a[48:49], v105 offset:10368
    ds_read_b64_tr_b16 a[50:51], v105 offset:11648
    v_mfma_f32_16x16x32_bf16 a[244:247], a[68:71], v[12:15], a[244:247]
    v_mfma_f32_16x16x32_bf16 a[248:251], a[72:75], v[12:15], a[248:251]
    ds_read_b64_tr_b16 a[52:53], v105 offset:15360
    ds_read_b64_tr_b16 a[54:55], v105 offset:16640
    v_mfma_f32_16x16x32_bf16 a[252:255], a[76:79], v[12:15], a[252:255]
    ds_read_b64_tr_b16 a[56:57], v105 offset:15392
    ds_read_b64_tr_b16 a[58:59], v105 offset:16672
    s_waitcnt vmcnt(9)
    v_mfma_f32_16x16x32_bf16 a[236:239], a[80:83], v[16:19], a[236:239]
    buffer_load_dwordx4 v[56:59], v252, s[24:27], s62 offen offset:2048 sc1
    ds_read_b64_tr_b16 a[60:61], v105 offset:15424
    ds_read_b64_tr_b16 a[62:63], v105 offset:16704
    v_mfma_f32_16x16x32_bf16 a[240:243], a[84:87], v[16:19], a[240:243]
    ds_read_b64_tr_b16 a[64:65], v105 offset:15456
    ds_read_b64_tr_b16 a[66:67], v105 offset:16736
    v_mfma_f32_16x16x32_bf16 a[244:247], a[88:91], v[16:19], a[244:247]
    ds_read_b64_tr_b16 a[68:69], v105 offset:15488
    ds_read_b64_tr_b16 a[70:71], v105 offset:16768
    v_mfma_f32_16x16x32_bf16 a[248:251], a[92:95], v[16:19], a[248:251]
    v_mfma_f32_16x16x32_bf16 a[252:255], a[96:99], v[16:19], a[252:255]
    ds_read_b64_tr_b16 a[72:73], v105 offset:20480
    ds_read_b64_tr_b16 a[74:75], v105 offset:21760
    s_waitcnt vmcnt(9)
    v_mfma_f32_16x16x32_bf16 a[236:239], a[100:103], v[20:23], a[236:239]
    buffer_load_dwordx4 v[60:63], v252, s[24:27], s62 offen offset:3072 sc1
    s_add_u32 s62, s62, 4096
    ds_read_b64_tr_b16 a[76:77], v105 offset:20512
    ds_read_b64_tr_b16 a[78:79], v105 offset:21792
    v_mfma_f32_16x16x32_bf16 a[240:243], a[104:107], v[20:23], a[240:243]
    ds_read_b64_tr_b16 a[80:81], v105 offset:20544
    ds_read_b64_tr_b16 a[82:83], v105 offset:21824
    v_mfma_f32_16x16x32_bf16 a[244:247], a[108:111], v[20:23], a[244:247]
    ds_read_b64_tr_b16 a[84:85], v105 offset:20576
    ds_read_b64_tr_b16 a[86:87], v105 offset:21856
    v_mfma_f32_16x16x32_bf16 a[248:251], a[112:115], v[20:23], a[248:251]
    ds_read_b64_tr_b16 a[88:89], v105 offset:20608
    ds_read_b64_tr_b16 a[90:91], v105 offset:21888
    v_mfma_f32_16x16x32_bf16 a[252:255], a[116:119], v[20:23], a[252:255]
    s_waitcnt vmcnt(9)
    v_mfma_f32_16x16x32_bf16 a[236:239], a[120:123], v[24:27], a[236:239]
    buffer_load_dwordx4 v[64:67], v252, s[24:27], s62 offen offset:0 sc1
    ds_read_b64_tr_b16 a[92:93], v105 offset:25600
    ds_read_b64_tr_b16 a[94:95], v105 offset:26880
    v_mfma_f32_16x16x32_bf16 a[240:243], a[124:127], v[24:27], a[240:243]
    ds_read_b64_tr_b16 a[96:97], v105 offset:25632
    ds_read_b64_tr_b16 a[98:99], v105 offset:26912
    v_mfma_f32_16x16x32_bf16 a[244:247], a[128:131], v[24:27], a[244:247]
    ds_read_b64_tr_b16 a[100:101], v105 offset:25664
    ds_read_b64_tr_b16 a[102:103], v105 offset:26944
    v_mfma_f32_16x16x32_bf16 a[248:251], a[132:135], v[24:27], a[248:251]
    ds_read_b64_tr_b16 a[104:105], v105 offset:25696
    ds_read_b64_tr_b16 a[106:107], v105 offset:26976
    v_mfma_f32_16x16x32_bf16 a[252:255], a[136:139], v[24:27], a[252:255]
    ds_read_b64_tr_b16 a[108:109], v105 offset:25728
    ds_read_b64_tr_b16 a[110:111], v105 offset:27008
    s_waitcnt vmcnt(9)
    v_mfma_f32_16x16x32_bf16 a[236:239], a[140:143], v[28:31], a[236:239]
    buffer_load_dwordx4 v[68:71], v252, s[24:27], s62 offen offset:1024 sc1
    v_mfma_f32_16x16x32_bf16 a[240:243], a[144:147], v[28:31], a[240:243]
    ds_read_b64_tr_b16 a[112:113], v105 offset:30720
    ds_read_b64_tr_b16 a[114:115], v105 offset:32000
    v_mfma_f32_16x16x32_bf16 a[244:247], a[148:151], v[28:31], a[244:247]
    ds_read_b64_tr_b16 a[116:117], v105 offset:30752
    ds_read_b64_tr_b16 a[118:119], v105 offset:32032
    v_mfma_f32_16x16x32_bf16 a[248:251], a[152:155], v[28:31], a[248:251]
    ds_read_b64_tr_b16 a[120:121], v105 offset:30784
    ds_read_b64_tr_b16 a[122:123], v105 offset:32064
    v_mfma_f32_16x16x32_bf16 a[252:255], a[156:159], v[28:31], a[252:255]
    ds_read_b64_tr_b16 a[124:125], v105 offset:30816
    ds_read_b64_tr_b16 a[126:127], v105 offset:32096
    s_waitcnt vmcnt(9)
    v_mfma_f32_16x16x32_bf16 a[236:239], a[160:163], v[32:35], a[236:239]
    buffer_load_dwordx4 v[72:75], v252, s[24:27], s62 offen offset:2048 sc1
    ds_read_b64_tr_b16 a[128:129], v105 offset:30848
    ds_read_b64_tr_b16 a[130:131], v105 offset:32128
    v_mfma_f32_16x16x32_bf16 a[240:243], a[164:167], v[32:35], a[240:243]
    v_mfma_f32_16x16x32_bf16 a[244:247], a[168:171], v[32:35], a[244:247]
    ds_read_b64_tr_b16 a[132:133], v105 offset:35840
    ds_read_b64_tr_b16 a[134:135], v105 offset:37120
    v_mfma_f32_16x16x32_bf16 a[248:251], a[172:175], v[32:35], a[248:251]
    ds_read_b64_tr_b16 a[136:137], v105 offset:35872
    ds_read_b64_tr_b16 a[138:139], v105 offset:37152
    v_mfma_f32_16x16x32_bf16 a[252:255], a[176:179], v[32:35], a[252:255]
    ds_read_b64_tr_b16 a[140:141], v105 offset:35904
    ds_read_b64_tr_b16 a[142:143], v105 offset:37184
    s_waitcnt vmcnt(9)
    v_mfma_f32_16x16x32_bf16 a[236:239], a[180:183], v[36:39], a[236:239]
    buffer_load_dwordx4 v[76:79], v252, s[24:27], s62 offen offset:3072 sc1
    s_add_u32 s62, s62, 4096
    ds_read_b64_tr_b16 a[144:145], v105 offset:35936
    ds_read_b64_tr_b16 a[146:147], v105 offset:37216
    v_mfma_f32_16x16x32_bf16 a[240:243], a[184:187], v[36:39], a[240:243]
    ds_read_b64_tr_b16 a[148:149], v105 offset:35968
    ds_read_b64_tr_b16 a[150:151], v105 offset:37248
    v_mfma_f32_16x16x32_bf16 a[244:247], a[188:191], v[36:39], a[244:247]
    v_mfma_f32_16x16x32_bf16 a[248:251], a[192:195], v[36:39], a[248:251]
    ds_read_b64_tr_b16 a[152:153], v105 offset:40960
    ds_read_b64_tr_b16 a[154:155], v105 offset:42240
    v_mfma_f32_16x16x32_bf16 a[252:255], a[196:199], v[36:39], a[252:255]
    ds_read_b64_tr_b16 a[156:157], v105 offset:40992
    ds_read_b64_tr_b16 a[158:159], v105 offset:42272
    s_waitcnt vmcnt(9) lgkmcnt(15)
    v_mfma_f32_16x16x32_bf16 a[236:239], a[200:203], v[40:43], a[236:239]
    ds_read_b64_tr_b16 a[160:161], v105 offset:41024
    ds_read_b64_tr_b16 a[162:163], v105 offset:42304
    v_mfma_f32_16x16x32_bf16 a[240:243], a[204:207], v[40:43], a[240:243]
    ds_read_b64_tr_b16 a[164:165], v105 offset:41056
    ds_read_b64_tr_b16 a[166:167], v105 offset:42336
    v_mfma_f32_16x16x32_bf16 a[244:247], a[0:3], v[40:43], a[244:247]
    ds_read_b64_tr_b16 a[168:169], v105 offset:41088
    ds_read_b64_tr_b16 a[170:171], v105 offset:42368
    v_mfma_f32_16x16x32_bf16 a[248:251], a[4:7], v[40:43], a[248:251]
    v_mfma_f32_16x16x32_bf16 a[252:255], a[8:11], v[40:43], a[252:255]
    ds_read_b64_tr_b16 a[172:173], v105 offset:46080
    ds_read_b64_tr_b16 a[174:175], v105 offset:47360
    s_waitcnt vmcnt(8) lgkmcnt(15)
    v_mfma_f32_16x16x32_bf16 a[236:239], a[12:15], v[44:47], a[236:239]
    ds_read_b64_tr_b16 a[176:177], v105 offset:46112
    ds_read_b64_tr_b16 a[178:179], v105 offset:47392
    v_mfma_f32_16x16x32_bf16 a[240:243], a[16:19], v[44:47], a[240:243]
    ds_read_b64_tr_b16 a[180:181], v105 offset:46144
    ds_read_b64_tr_b16 a[182:183], v105 offset:47424
    v_mfma_f32_16x16x32_bf16 a[244:247], a[20:23], v[44:47], a[244:247]
    ds_read_b64_tr_b16 a[184:185], v105 offset:46176
    ds_read_b64_tr_b16 a[186:187], v105 offset:47456
    v_mfma_f32_16x16x32_bf16 a[248:251], a[24:27], v[44:47], a[248:251]
    ds_read_b64_tr_b16 a[188:189], v105 offset:46208
    ds_read_b64_tr_b16 a[190:191], v105 offset:47488
    v_mfma_f32_16x16x32_bf16 a[252:255], a[28:31], v[44:47], a[252:255]
    s_waitcnt vmcnt(7) lgkmcnt(15)
    v_mfma_f32_16x16x32_bf16 a[236:239], a[32:35], v[48:51], a[236:239]
    v_mfma_f32_16x16x32_bf16 a[240:243], a[36:39], v[48:51], a[240:243]
    v_mfma_f32_16x16x32_bf16 a[244:247], a[40:43], v[48:51], a[244:247]
    v_mfma_f32_16x16x32_bf16 a[248:251], a[44:47], v[48:51], a[248:251]
    v_mfma_f32_16x16x32_bf16 a[252:255], a[48:51], v[48:51], a[252:255]
    s_waitcnt vmcnt(6) lgkmcnt(15)
    v_mfma_f32_16x16x32_bf16 a[236:239], a[52:55], v[52:55], a[236:239]
    v_mfma_f32_16x16x32_bf16 a[240:243], a[56:59], v[52:55], a[240:243]
    v_mfma_f32_16x16x32_bf16 a[244:247], a[60:63], v[52:55], a[244:247]
    v_mfma_f32_16x16x32_bf16 a[248:251], a[64:67], v[52:55], a[248:251]
    v_mfma_f32_16x16x32_bf16 a[252:255], a[68:71], v[52:55], a[252:255]
    s_waitcnt vmcnt(5) lgkmcnt(0)
    s_barrier
    v_mfma_f32_16x16x32_bf16 a[236:239], a[72:75], v[56:59], a[236:239]
    buffer_load_dwordx4 v111, s[24:27], s71 offen offset:0 sc1 lds
    v_mfma_f32_16x16x32_bf16 a[240:243], a[76:79], v[56:59], a[240:243]
    v_mfma_f32_16x16x32_bf16 a[244:247], a[80:83], v[56:59], a[244:247]
    v_mfma_f32_16x16x32_bf16 a[248:251], a[84:87], v[56:59], a[248:251]
    buffer_load_dwordx4 v111, s[24:27], s71 offen offset:1024 sc1 lds
    v_mfma_f32_16x16x32_bf16 a[252:255], a[88:91], v[56:59], a[252:255]
    s_waitcnt vmcnt(6)
    v_mfma_f32_16x16x32_bf16 a[236:239], a[92:95], v[60:63], a[236:239]
    v_mfma_f32_16x16x32_bf16 a[240:243], a[96:99], v[60:63], a[240:243]
    buffer_load_dwordx4 v111, s[24:27], s71 offen offset:2048 sc1 lds
    v_mfma_f32_16x16x32_bf16 a[244:247], a[100:103], v[60:63], a[244:247]
    v_mfma_f32_16x16x32_bf16 a[248:251], a[104:107], v[60:63], a[248:251]
    v_mfma_f32_16x16x32_bf16 a[252:255], a[108:111], v[60:63], a[252:255]
    buffer_load_dwordx4 v111, s[24:27], s71 offen offset:3072 sc1 lds
    s_add_u32 m0, m0, 4096
    s_add_u32 s71, s71, 4096
    s_waitcnt vmcnt(7)
    v_mfma_f32_16x16x32_bf16 a[236:239], a[112:115], v[64:67], a[236:239]
    v_mfma_f32_16x16x32_bf16 a[240:243], a[116:119], v[64:67], a[240:243]
    v_mfma_f32_16x16x32_bf16 a[244:247], a[120:123], v[64:67], a[244:247]
    buffer_load_dwordx4 v111, s[24:27], s71 offen offset:0 sc1 lds
    v_mfma_f32_16x16x32_bf16 a[248:251], a[124:127], v[64:67], a[248:251]
    v_mfma_f32_16x16x32_bf16 a[252:255], a[128:131], v[64:67], a[252:255]
    s_waitcnt vmcnt(7)
    v_mfma_f32_16x16x32_bf16 a[236:239], a[132:135], v[68:71], a[236:239]
    buffer_load_dwordx4 v111, s[24:27], s71 offen offset:1024 sc1 lds
    v_mfma_f32_16x16x32_bf16 a[240:243], a[136:139], v[68:71], a[240:243]
    v_mfma_f32_16x16x32_bf16 a[244:247], a[140:143], v[68:71], a[244:247]
    v_mfma_f32_16x16x32_bf16 a[248:251], a[144:147], v[68:71], a[248:251]
    buffer_load_dwordx4 v111, s[24:27], s71 offen offset:2048 sc1 lds
    v_mfma_f32_16x16x32_bf16 a[252:255], a[148:151], v[68:71], a[252:255]
    s_waitcnt vmcnt(8)
    v_mfma_f32_16x16x32_bf16 a[236:239], a[152:155], v[72:75], a[236:239]
    v_mfma_f32_16x16x32_bf16 a[240:243], a[156:159], v[72:75], a[240:243]
    buffer_load_dwordx4 v111, s[24:27], s71 offen offset:3072 sc1 lds
    s_add_u32 m0, m0, 4096
    s_add_u32 s71, s71, 4096
    v_mfma_f32_16x16x32_bf16 a[244:247], a[160:163], v[72:75], a[244:247]
    v_mfma_f32_16x16x32_bf16 a[248:251], a[164:167], v[72:75], a[248:251]
    v_mfma_f32_16x16x32_bf16 a[252:255], a[168:171], v[72:75], a[252:255]
    buffer_load_dwordx4 v111, s[24:27], s71 offen offset:0 sc1 lds
    s_waitcnt vmcnt(9)
    v_mfma_f32_16x16x32_bf16 a[236:239], a[172:175], v[76:79], a[236:239]
    v_mfma_f32_16x16x32_bf16 a[240:243], a[176:179], v[76:79], a[240:243]
    v_mfma_f32_16x16x32_bf16 a[244:247], a[180:183], v[76:79], a[244:247]
    buffer_load_dwordx4 v111, s[24:27], s71 offen offset:1024 sc1 lds
    v_mfma_f32_16x16x32_bf16 a[248:251], a[184:187], v[76:79], a[248:251]
    v_mfma_f32_16x16x32_bf16 a[252:255], a[188:191], v[76:79], a[252:255]
    s_nop 2
    v_accvgpr_read_b32 v0, a236
    v_accvgpr_read_b32 v1, a237
    v_accvgpr_read_b32 v2, a238
    v_accvgpr_read_b32 v3, a239
    v_accvgpr_read_b32 v4, a240
    v_accvgpr_read_b32 v5, a241
    v_accvgpr_read_b32 v6, a242
    v_accvgpr_read_b32 v7, a243
    v_accvgpr_read_b32 v8, a244
    v_accvgpr_read_b32 v9, a245
    v_accvgpr_read_b32 v10, a246
    v_accvgpr_read_b32 v11, a247
    v_accvgpr_read_b32 v12, a248
    v_accvgpr_read_b32 v13, a249
    v_accvgpr_read_b32 v14, a250
    v_accvgpr_read_b32 v15, a251
    v_accvgpr_read_b32 v16, a252
    v_accvgpr_read_b32 v17, a253
    v_accvgpr_read_b32 v18, a254
    v_accvgpr_read_b32 v19, a255
    v_cvt_pk_bf16_f32 v80, v0, v1
    v_cvt_pk_bf16_f32 v81, v2, v3
    v_cvt_pk_bf16_f32 v82, v4, v5
    v_cvt_pk_bf16_f32 v83, v6, v7
    v_cvt_pk_bf16_f32 v84, v8, v9
    v_cvt_pk_bf16_f32 v85, v10, v11
    v_cvt_pk_bf16_f32 v86, v12, v13
    v_cvt_pk_bf16_f32 v87, v14, v15
    v_cvt_pk_bf16_f32 v88, v16, v17
    v_cvt_pk_bf16_f32 v89, v18, v19
    s_cmp_eq_u32 s43, 3
    s_cbranch_scc1 LAST
XEPI:
    s_mov_b32 s60, 0x3f803f80
    v_mov_b32 v92, 0
    v_mov_b32 v93, 0
    v_dot2c_f32_bf16 v92, s60, v80
    v_dot2c_f32_bf16 v93, v80, v80
    v_dot2c_f32_bf16 v92, s60, v81
    v_dot2c_f32_bf16 v93, v81, v81
    v_dot2c_f32_bf16 v92, s60, v82
    v_dot2c_f32_bf16 v93, v82, v82
    v_dot2c_f32_bf16 v92, s60, v83
    v_dot2c_f32_bf16 v93, v83, v83
    v_dot2c_f32_bf16 v92, s60, v84
    v_dot2c_f32_bf16 v93, v84, v84
    v_dot2c_f32_bf16 v92, s60, v85
    v_dot2c_f32_bf16 v93, v85, v85
    v_dot2c_f32_bf16 v92, s60, v86
    v_dot2c_f32_bf16 v93, v86, v86
    v_dot2c_f32_bf16 v92, s60, v87
    v_dot2c_f32_bf16 v93, v87, v87
    v_dot2c_f32_bf16 v92, s60, v88
    v_dot2c_f32_bf16 v93, v88, v88
    v_dot2c_f32_bf16 v92, s60, v89
    v_dot2c_f32_bf16 v93, v89, v89
    v_mov_b32 v90, v88
    v_mov_b32 v91, v89
    v_permlane16_swap_b32 v80, v82
    v_permlane16_swap_b32 v81, v83
    v_permlane16_swap_b32 v84, v86
    v_permlane16_swap_b32 v85, v87
    v_permlane16_swap_b32 v88, v90
    v_permlane16_swap_b32 v89, v91
    s_mul_i32 s54, s63, 20480
    s_and_b32 s55, s41, 7
    s_mul_i32 s56, s55, 2560
    s_add_u32 s54, s54, s56
    s_mul_i32 s56, s43, 2621440
    s_add_u32 s54, s54, s56
    s_add_u32 s54, s54, 47185920
    v_lshlrev_b32 v108, 4, v107
    v_lshl_add_u32 v108, v106, 8, v108
    v_lshl_add_u32 v109, v101, 31, v108
    buffer_store_dwordx4 v[80:83], v108, s[24:27], s54 offen sc1
    buffer_store_dwordx4 v[84:87], v108, s[24:27], s54 offen offset:1024 sc1
    buffer_store_dwordx4 v[88:91], v109, s[24:27], s54 offen offset:2048 sc1
    v_permlane32_swap_b32 v92, v93
    s_lshr_b32 s54, s63, 1
    s_lshl_b32 s54, s54, 11
    s_lshl_b32 s55, s55, 8
    s_add_u32 s54, s54, s55
    s_and_b32 s55, s63, 1
    s_lshl_b32 s55, s55, 7
    s_add_u32 s54, s54, s55
    s_mul_i32 s56, s43, 131072
    s_add_u32 s54, s54, s56
    s_add_u32 s54, s54, 20054016
    v_add_f32 v92, v92, v93
    v_mov_b32 v93, v92
    v_lshlrev_b32 v110, 3, v107
    v_lshl_add_u32 v110, v100, 2, v110
    v_permlane16_swap_b32 v92, v93
    v_lshl_add_u32 v110, v101, 31, v110
    v_add_f32 v92, v92, v93
    buffer_store_dword v92, v110, s[24:27], s54 offen sc1
    s_cmp_lt_i32 s43, 0
    s_cbranch_scc1 FIRST
    s_add_u32 s44, s44, 16
    v_mov_b32 v247, 1
    s_waitcnt vmcnt(0)
    s_barrier
    s_cmp_lg_u32 s42, 0
    s_cbranch_scc1 SG_20
    s_mov_b64 exec, 0x3
    buffer_atomic_add v247, v254, s[24:27], s77 offen sc1
    s_mov_b64 exec, -1
SG_20:
    buffer_load_dwordx4 v252, s[24:27], s71 offen offset:2048 sc1 lds
    buffer_load_dwordx4 v252, s[24:27], s71 offen offset:3072 sc1 lds
NEXT:
    s_add_u32 s43, s43, 1
    s_xor_b32 s68, s68, 4194304
    s_xor_b32 s69, s69, 2097152
    s_branch QKV_GEN
FIRST:
    s_cmp_lg_u32 s42, 0
    s_cbranch_scc1 PD_22
    s_mov_b64 exec, 1
PL_21:
    buffer_load_dword v246, v254, s[28:31], 0 offen sc1
    s_sub_u32 s48, s48, 1
    s_cmp_lt_i32 s48, 0
    s_cbranch_scc1 PD_22
    s_waitcnt vmcnt(0)
    v_cmp_gt_u32 vcc, 4, v246
    s_mov_b64 exec, vcc
    s_nop 3
    s_cbranch_vccnz PL_21
PD_22:
    s_mov_b64 exec, -1
    s_waitcnt vmcnt(0)
    s_barrier
    s_add_u32 s45, s45, 16
    v_mov_b32 v247, 1
    s_waitcnt vmcnt(0)
    s_barrier
    s_cmp_lg_u32 s42, 0
    s_cbranch_scc1 SG_23
    s_mov_b64 exec, 0x3
    buffer_atomic_add v247, v254, s[24:27], s47 offen sc1
    s_mov_b64 exec, -1
SG_23:
    s_add_u32 s45, s45, 16
    v_mov_b32 v247, 1
    s_waitcnt vmcnt(1)
    s_cmp_lg_u32 s42, 0
    s_cbranch_scc1 SG_24
    s_mov_b64 exec, 0x3
    buffer_atomic_add v247, v254, s[24:27], s89 offen sc1
    s_mov_b64 exec, -1
SG_24:
    s_add_u32 s44, s44, 16
    v_mov_b32 v247, 1
    s_waitcnt vmcnt(2)
    s_cmp_lg_u32 s42, 0
    s_cbranch_scc1 SG_25
    s_mov_b64 exec, 0x3
    buffer_atomic_add v247, v254, s[24:27], s77 offen sc1
    s_mov_b64 exec, -1
SG_25:
    s_add_u32 s45, s45, 16
    v_mov_b32 v247, 1
    s_waitcnt vmcnt(3)
    s_cmp_lg_u32 s42, 0
    s_cbranch_scc1 SG_26
    s_mov_b64 exec, 0x3
    buffer_atomic_add v247, v254, s[24:27], s90 offen sc1
    s_mov_b64 exec, -1
SG_26:
    s_cmp_lt_u32 s42, 2
    s_cbranch_scc1 Z_27
    s_mov_b32 exec_hi, 0x0fffffff
    s_add_u32 s55, s92, 0
    s_lshr_b32 s54, s55, 2
    s_and_b32 s55, s55, 3
    s_lshl4_add_u32 s54, s54, s55
    s_mul_i32 s54, s54, 3840
    buffer_load_dwordx4 v[32:35], v13, s[12:15], s54 offen nt
    s_add_u32 s55, s92, 1
    s_lshr_b32 s54, s55, 2
    s_and_b32 s55, s55, 3
    s_lshl4_add_u32 s54, s54, s55
    s_mul_i32 s54, s54, 3840
    buffer_load_dwordx4 v[36:39], v13, s[12:15], s54 offen nt
    s_add_u32 s55, s92, 2
    s_lshr_b32 s54, s55, 2
    s_and_b32 s55, s55, 3
    s_lshl4_add_u32 s54, s54, s55
    s_mul_i32 s54, s54, 3840
    buffer_load_dwordx4 v[40:43], v13, s[12:15], s54 offen nt
    s_add_u32 s55, s92, 3
    s_lshr_b32 s54, s55, 2
    s_and_b32 s55, s55, 3
    s_lshl4_add_u32 s54, s54, s55
    s_mul_i32 s54, s54, 3840
    buffer_load_dwordx4 v[44:47], v13, s[12:15], s54 offen nt
    s_add_u32 s55, s92, 4
    s_lshr_b32 s54, s55, 2
    s_and_b32 s55, s55, 3
    s_lshl4_add_u32 s54, s54, s55
    s_mul_i32 s54, s54, 3840
    buffer_load_dwordx4 v[48:51], v13, s[12:15], s54 offen nt
    s_mov_b32 exec_hi, -1
    buffer_load_dwordx4 v[52:55], v14, s[84:87], s95 offen nt
    s_lshl_b32 s54, s91, 6
    s_add_u32 s54, s54, -128
    v_add_u32 v8, s54, v255
    v_mul_u32_u24 v9, 6554, v8
    v_lshrrev_b32 v9, 16, v9
    v_mul_u32_u24 v10, 10, v9
    v_sub_u32 v10, v8, v10
    v_and_b32 v11, 0xfff3, v9
    v_and_b32 v12, 4, v9
    v_lshl_add_u32 v11, v12, 1, v11
    v_and_b32 v12, 8, v9
    v_lshrrev_b32 v12, 1, v12
    v_add_u32 v11, v11, v12
    v_mul_u32_u24 v11, 1280, v11
    v_lshl_add_u32 v15, v10, 4, v11
    buffer_load_dwordx4 v[56:59], v15, s[84:87], s95 offen nt
Z_27:
    s_cmp_gt_u32 s42, 0
    s_cbranch_scc1 PX_30
    s_mov_b64 exec, 1
PL_28:
    v_mov_b32 v246, 0
    buffer_atomic_add v246, off, s[24:27], s51 sc0 sc1
    s_waitcnt vmcnt(0)
    v_cmp_gt_u32 vcc, s45, v246
    s_nop 4
    s_cbranch_vccz PD_29
    s_sub_u32 s48, s48, 1
    s_cmp_gt_i32 s48, 0
    s_cbranch_scc1 PL_28
    s_mov_b64 exec, -1
PX_30:
PD_29:
    s_mov_b64 exec, -1
    s_barrier
    s_mul_i32 s54, s42, 12288
    s_add_u32 m0, s54, 0
    s_add_u32 s71, s54, s68
    buffer_load_dwordx4 v252, s[24:27], s71 offen offset:0 sc1 lds
    buffer_load_dwordx4 v252, s[24:27], s71 offen offset:1024 sc1 lds
    buffer_load_dwordx4 v252, s[24:27], s71 offen offset:2048 sc1 lds
    buffer_load_dwordx4 v252, s[24:27], s71 offen offset:3072 sc1 lds
    s_add_u32 m0, m0, 4096
    s_add_u32 s71, s71, 4096
    buffer_load_dwordx4 v252, s[24:27], s71 offen offset:0 sc1 lds
    buffer_load_dwordx4 v252, s[24:27], s71 offen offset:1024 sc1 lds
    buffer_load_dwordx4 v252, s[24:27], s71 offen offset:2048 sc1 lds
    buffer_load_dwordx4 v252, s[24:27], s71 offen offset:3072 sc1 lds
    s_add_u32 m0, m0, 4096
    s_add_u32 s71, s71, 4096
    buffer_load_dwordx4 v252, s[24:27], s71 offen offset:0 sc1 lds
    buffer_load_dwordx4 v252, s[24:27], s71 offen offset:1024 sc1 lds
    buffer_load_dwordx4 v252, s[24:27], s71 offen offset:2048 sc1 lds
    buffer_load_dwordx4 v252, s[24:27], s71 offen offset:3072 sc1 lds
    s_branch NEXT
LAST:
    v_mov_b32 v90, v88
    v_mov_b32 v91, v89
    v_permlane16_swap_b32 v80, v82
    v_permlane16_swap_b32 v81, v83
    v_permlane16_swap_b32 v84, v86
    v_permlane16_swap_b32 v85, v87
    v_permlane16_swap_b32 v88, v90
    v_permlane16_swap_b32 v89, v91
    s_mul_i32 s54, s63, 20480
    s_and_b32 s55, s41, 7
    s_mul_i32 s55, s55, 160
    s_add_u32 s54, s54, s55
    v_mul_u32_u24 v108, 1280, v107
    v_lshl_add_u32 v108, v106, 4, v108
    v_lshl_add_u32 v109, v101, 31, v108
    buffer_store_dwordx4 v[80:83], v108, s[20:23], s54 offen nt
    buffer_store_dwordx4 v[84:87], v108, s[20:23], s54 offen offset:64 nt
    buffer_store_dwordx4 v[88:91], v109, s[20:23], s54 offen offset:128 nt
    s_waitcnt vmcnt(3)
    s_endpgm
QKV_2:
    s_waitcnt vmcnt(15)
    s_barrier
    buffer_load_dwordx2 v[224:225], v232, s[24:27], s63 offen offset:0 sc1
    buffer_load_dwordx2 v[226:227], v232, s[24:27], s63 offen offset:256 sc1
    buffer_load_dwordx2 v[228:229], v232, s[24:27], s63 offen offset:512 sc1
    buffer_load_dwordx2 v[230:231], v232, s[24:27], s63 offen offset:768 sc1
    buffer_load_dwordx4 v[64:67], v253, s[24:27], s60 offen offset:0 sc1
    buffer_load_dwordx4 v[68:71], v253, s[24:27], s60 offen offset:512 sc1
    buffer_load_dwordx4 v[72:75], v253, s[24:27], s60 offen offset:1024 sc1
    buffer_load_dwordx4 v[76:79], v253, s[24:27], s60 offen offset:1536 sc1
    buffer_load_dwordx4 v[80:83], v253, s[24:27], s60 offen offset:2048 sc1
    s_add_u32 s60, s60, 2560
    buffer_load_dwordx4 v[84:87], v253, s[24:27], s60 offen offset:0 sc1
    buffer_load_dwordx4 v[88:91], v253, s[24:27], s60 offen offset:512 sc1
    buffer_load_dwordx4 v[92:95], v253, s[24:27], s60 offen offset:1024 sc1
    ds_read_b64_tr_b16 a[0:1], v251 offset:0
    ds_read_b64_tr_b16 a[2:3], v251 offset:240
    ds_read_b64_tr_b16 a[4:5], v251 offset:64
    ds_read_b64_tr_b16 a[6:7], v251 offset:304
    ds_read_b64_tr_b16 a[8:9], v251 offset:128
    ds_read_b64_tr_b16 a[10:11], v251 offset:368
    ds_read_b64_tr_b16 a[12:13], v251 offset:176
    ds_read_b64_tr_b16 a[14:15], v251 offset:416
    ds_read_b64_tr_b16 a[16:17], v251 offset:3840
    ds_read_b64_tr_b16 a[18:19], v251 offset:4080
    ds_read_b64_tr_b16 a[20:21], v251 offset:3904
    ds_read_b64_tr_b16 a[22:23], v251 offset:4144
    ds_read_b64_tr_b16 a[24:25], v251 offset:3968
    ds_read_b64_tr_b16 a[26:27], v251 offset:4208
    ds_read_b64_tr_b16 a[28:29], v251 offset:4016
    ds_read_b64_tr_b16 a[30:31], v251 offset:4256
    s_waitcnt vmcnt(7) lgkmcnt(14)
    v_mfma_f32_32x32x16_bf16 v[0:15], a[0:3], v[64:67], 0
    buffer_load_dwordx4 v[96:99], v253, s[24:27], s60 offen offset:1536 sc1
    ds_read_b64_tr_b16 a[32:33], v251 offset:7680
    ds_read_b64_tr_b16 a[34:35], v251 offset:7920
    s_waitcnt lgkmcnt(14)
    v_mfma_f32_32x32x16_bf16 v[16:31], a[4:7], v[64:67], 0
    ds_read_b64_tr_b16 a[36:37], v251 offset:7744
    ds_read_b64_tr_b16 a[38:39], v251 offset:7984
    s_waitcnt lgkmcnt(14)
    v_mfma_f32_32x32x16_bf16 v[32:47], a[8:11], v[64:67], 0
    buffer_load_dwordx4 v[100:103], v253, s[24:27], s60 offen offset:2048 sc1
    ds_read_b64_tr_b16 a[40:41], v251 offset:7808
    ds_read_b64_tr_b16 a[42:43], v251 offset:8048
    s_waitcnt lgkmcnt(14)
    v_mfma_f32_32x32x16_bf16 v[48:63], a[12:15], v[64:67], 0
    ds_read_b64_tr_b16 a[44:45], v251 offset:7856
    ds_read_b64_tr_b16 a[46:47], v251 offset:8096
    s_waitcnt vmcnt(8) lgkmcnt(14)
    v_mfma_f32_32x32x16_bf16 v[0:15], a[16:19], v[68:71], v[0:15]
    s_add_u32 s60, s60, 2560
    buffer_load_dwordx4 v[104:107], v253, s[24:27], s60 offen offset:0 sc1
    ds_read_b64_tr_b16 a[0:1], v251 offset:11520
    ds_read_b64_tr_b16 a[2:3], v251 offset:11760
    s_waitcnt lgkmcnt(14)
    v_mfma_f32_32x32x16_bf16 v[16:31], a[20:23], v[68:71], v[16:31]
    ds_read_b64_tr_b16 a[4:5], v251 offset:11584
    ds_read_b64_tr_b16 a[6:7], v251 offset:11824
    s_waitcnt lgkmcnt(14)
    v_mfma_f32_32x32x16_bf16 v[32:47], a[24:27], v[68:71], v[32:47]
    buffer_load_dwordx4 v[108:111], v253, s[24:27], s60 offen offset:512 sc1
    ds_read_b64_tr_b16 a[8:9], v251 offset:11648
    ds_read_b64_tr_b16 a[10:11], v251 offset:11888
    s_waitcnt lgkmcnt(14)
    v_mfma_f32_32x32x16_bf16 v[48:63], a[28:31], v[68:71], v[48:63]
    ds_read_b64_tr_b16 a[12:13], v251 offset:11696
    ds_read_b64_tr_b16 a[14:15], v251 offset:11936
    s_waitcnt vmcnt(9) lgkmcnt(14)
    v_mfma_f32_32x32x16_bf16 v[0:15], a[32:35], v[72:75], v[0:15]
    buffer_load_dwordx4 v[112:115], v253, s[24:27], s60 offen offset:1024 sc1
    ds_read_b64_tr_b16 a[16:17], v251 offset:15360
    ds_read_b64_tr_b16 a[18:19], v251 offset:15600
    s_waitcnt lgkmcnt(14)
    v_mfma_f32_32x32x16_bf16 v[16:31], a[36:39], v[72:75], v[16:31]
    ds_read_b64_tr_b16 a[20:21], v251 offset:15424
    ds_read_b64_tr_b16 a[22:23], v251 offset:15664
    v_pk_add_f32 v[224:225], v[224:225], v[226:227]
    s_waitcnt lgkmcnt(14)
    v_mfma_f32_32x32x16_bf16 v[32:47], a[40:43], v[72:75], v[32:47]
    buffer_load_dwordx4 v[116:119], v253, s[24:27], s60 offen offset:1536 sc1
    ds_read_b64_tr_b16 a[24:25], v251 offset:15488
    ds_read_b64_tr_b16 a[26:27], v251 offset:15728
    v_pk_add_f32 v[228:229], v[228:229], v[230:231]
    s_waitcnt lgkmcnt(14)
    v_mfma_f32_32x32x16_bf16 v[48:63], a[44:47], v[72:75], v[48:63]
    ds_read_b64_tr_b16 a[28:29], v251 offset:15536
    ds_read_b64_tr_b16 a[30:31], v251 offset:15776
    s_waitcnt vmcnt(10) lgkmcnt(14)
    v_mfma_f32_32x32x16_bf16 v[0:15], a[0:3], v[76:79], v[0:15]
    buffer_load_dwordx4 v[120:123], v253, s[24:27], s60 offen offset:2048 sc1
    ds_read_b64_tr_b16 a[32:33], v251 offset:19200
    ds_read_b64_tr_b16 a[34:35], v251 offset:19440
    s_waitcnt lgkmcnt(14)
    v_mfma_f32_32x32x16_bf16 v[16:31], a[4:7], v[76:79], v[16:31]
    ds_read_b64_tr_b16 a[36:37], v251 offset:19264
    ds_read_b64_tr_b16 a[38:39], v251 offset:19504
    v_pk_add_f32 v[240:241], v[224:225], v[228:229]
    s_waitcnt lgkmcnt(14)
    v_mfma_f32_32x32x16_bf16 v[32:47], a[8:11], v[76:79], v[32:47]
    s_add_u32 s60, s60, 2560
    buffer_load_dwordx4 v[124:127], v253, s[24:27], s60 offen offset:0 sc1
    ds_read_b64_tr_b16 a[40:41], v251 offset:19328
    ds_read_b64_tr_b16 a[42:43], v251 offset:19568
    v_mov_b32 v224, v240
    s_waitcnt lgkmcnt(14)
    v_mfma_f32_32x32x16_bf16 v[48:63], a[12:15], v[76:79], v[48:63]
    ds_read_b64_tr_b16 a[44:45], v251 offset:19376
    ds_read_b64_tr_b16 a[46:47], v251 offset:19616
    s_waitcnt vmcnt(11) lgkmcnt(14)
    v_mfma_f32_32x32x16_bf16 v[0:15], a[16:19], v[80:83], v[0:15]
    buffer_load_dwordx4 v[128:131], v253, s[24:27], s60 offen offset:512 sc1
    ds_read_b64_tr_b16 a[0:1], v251 offset:23040
    ds_read_b64_tr_b16 a[2:3], v251 offset:23280
    s_waitcnt lgkmcnt(14)
    v_mfma_f32_32x32x16_bf16 v[16:31], a[20:23], v[80:83], v[16:31]
    ds_read_b64_tr_b16 a[4:5], v251 offset:23104
    ds_read_b64_tr_b16 a[6:7], v251 offset:23344
    v_mov_b32 v225, v241
    s_waitcnt lgkmcnt(14)
    v_mfma_f32_32x32x16_bf16 v[32:47], a[24:27], v[80:83], v[32:47]
    buffer_load_dwordx4 v[132:135], v253, s[24:27], s60 offen offset:1024 sc1
    ds_read_b64_tr_b16 a[8:9], v251 offset:23168
    ds_read_b64_tr_b16 a[10:11], v251 offset:23408
    v_permlane32_swap_b32 v240, v224
    s_waitcnt lgkmcnt(14)
    v_mfma_f32_32x32x16_bf16 v[48:63], a[28:31], v[80:83], v[48:63]
    ds_read_b64_tr_b16 a[12:13], v251 offset:23216
    ds_read_b64_tr_b16 a[14:15], v251 offset:23456
    s_waitcnt vmcnt(12) lgkmcnt(14)
    v_mfma_f32_32x32x16_bf16 v[0:15], a[32:35], v[84:87], v[0:15]
    buffer_load_dwordx4 v[136:139], v253, s[24:27], s60 offen offset:1536 sc1
    ds_read_b64_tr_b16 a[16:17], v251 offset:26880
    ds_read_b64_tr_b16 a[18:19], v251 offset:27120
    s_waitcnt lgkmcnt(14)
    v_mfma_f32_32x32x16_bf16 v[16:31], a[36:39], v[84:87], v[16:31]
    ds_read_b64_tr_b16 a[20:21], v251 offset:26944
    ds_read_b64_tr_b16 a[22:23], v251 offset:27184
    v_permlane32_swap_b32 v241, v225
    s_waitcnt lgkmcnt(14)
    v_mfma_f32_32x32x16_bf16 v[32:47], a[40:43], v[84:87], v[32:47]
    buffer_load_dwordx4 v[140:143], v253, s[24:27], s60 offen offset:2048 sc1
    ds_read_b64_tr_b16 a[24:25], v251 offset:27008
    ds_read_b64_tr_b16 a[26:27], v251 offset:27248
    v_add_f32 v240, v240, v224
    s_waitcnt lgkmcnt(14)
    v_mfma_f32_32x32x16_bf16 v[48:63], a[44:47], v[84:87], v[48:63]
    ds_read_b64_tr_b16 a[28:29], v251 offset:27056
    ds_read_b64_tr_b16 a[30:31], v251 offset:27296
    s_waitcnt vmcnt(13) lgkmcnt(14)
    v_mfma_f32_32x32x16_bf16 v[0:15], a[0:3], v[88:91], v[0:15]
    s_add_u32 s60, s60, 2560
    buffer_load_dwordx4 v[144:147], v253, s[24:27], s60 offen offset:0 sc1
    ds_read_b64_tr_b16 a[32:33], v251 offset:30720
    ds_read_b64_tr_b16 a[34:35], v251 offset:30960
    s_waitcnt lgkmcnt(14)
    v_mfma_f32_32x32x16_bf16 v[16:31], a[4:7], v[88:91], v[16:31]
    ds_read_b64_tr_b16 a[36:37], v251 offset:30784
    ds_read_b64_tr_b16 a[38:39], v251 offset:31024
    v_add_f32 v241, v241, v225
    s_waitcnt lgkmcnt(14)
    v_mfma_f32_32x32x16_bf16 v[32:47], a[8:11], v[88:91], v[32:47]
    buffer_load_dwordx4 v[148:151], v253, s[24:27], s60 offen offset:512 sc1
    ds_read_b64_tr_b16 a[40:41], v251 offset:30848
    ds_read_b64_tr_b16 a[42:43], v251 offset:31088
    v_mul_f32 v240, 0x3acccccd, v240
    s_waitcnt lgkmcnt(14)
    v_mfma_f32_32x32x16_bf16 v[48:63], a[12:15], v[88:91], v[48:63]
    ds_read_b64_tr_b16 a[44:45], v251 offset:30896
    ds_read_b64_tr_b16 a[46:47], v251 offset:31136
    s_waitcnt vmcnt(14) lgkmcnt(14)
    v_mfma_f32_32x32x16_bf16 v[0:15], a[16:19], v[92:95], v[0:15]
    buffer_load_dwordx4 v[152:155], v253, s[24:27], s60 offen offset:1024 sc1
    ds_read_b64_tr_b16 a[0:1], v251 offset:34560
    ds_read_b64_tr_b16 a[2:3], v251 offset:34800
    s_waitcnt lgkmcnt(14)
    v_mfma_f32_32x32x16_bf16 v[16:31], a[20:23], v[92:95], v[16:31]
    ds_read_b64_tr_b16 a[4:5], v251 offset:34624
    ds_read_b64_tr_b16 a[6:7], v251 offset:34864
    v_mul_f32 v241, 0x3acccccd, v241
    s_waitcnt lgkmcnt(14)
    v_mfma_f32_32x32x16_bf16 v[32:47], a[24:27], v[92:95], v[32:47]
    ds_read_b64_tr_b16 a[8:9], v251 offset:34688
    ds_read_b64_tr_b16 a[10:11], v251 offset:34928
    v_fma_f32 v241, -v240, v240, v241
    s_waitcnt lgkmcnt(14)
    v_mfma_f32_32x32x16_bf16 v[48:63], a[28:31], v[92:95], v[48:63]
    ds_read_b64_tr_b16 a[12:13], v251 offset:34736
    ds_read_b64_tr_b16 a[14:15], v251 offset:34976
    s_waitcnt vmcnt(14) lgkmcnt(14)
    v_mfma_f32_32x32x16_bf16 v[0:15], a[32:35], v[96:99], v[0:15]
    buffer_load_dwordx4 v[156:159], v253, s[24:27], s60 offen offset:1536 sc1
    ds_read_b64_tr_b16 a[16:17], v251 offset:38400
    ds_read_b64_tr_b16 a[18:19], v251 offset:38640
    s_waitcnt lgkmcnt(14)
    v_mfma_f32_32x32x16_bf16 v[16:31], a[36:39], v[96:99], v[16:31]
    ds_read_b64_tr_b16 a[20:21], v251 offset:38464
    ds_read_b64_tr_b16 a[22:23], v251 offset:38704
    v_max_f32 v241, 0, v241
    s_waitcnt lgkmcnt(14)
    v_mfma_f32_32x32x16_bf16 v[32:47], a[40:43], v[96:99], v[32:47]
    ds_read_b64_tr_b16 a[24:25], v251 offset:38528
    ds_read_b64_tr_b16 a[26:27], v251 offset:38768
    v_add_f32 v241, 0x3727c5ac, v241
    s_waitcnt lgkmcnt(14)
    v_mfma_f32_32x32x16_bf16 v[48:63], a[44:47], v[96:99], v[48:63]
    ds_read_b64_tr_b16 a[28:29], v251 offset:38576
    ds_read_b64_tr_b16 a[30:31], v251 offset:38816
    s_waitcnt vmcnt(14) lgkmcnt(14)
    v_mfma_f32_32x32x16_bf16 v[0:15], a[0:3], v[100:103], v[0:15]
    buffer_load_dwordx4 v[160:163], v253, s[24:27], s60 offen offset:2048 sc1
    ds_read_b64_tr_b16 a[32:33], v251 offset:42240
    ds_read_b64_tr_b16 a[34:35], v251 offset:42480
    s_waitcnt lgkmcnt(14)
    v_mfma_f32_32x32x16_bf16 v[16:31], a[4:7], v[100:103], v[16:31]
    ds_read_b64_tr_b16 a[36:37], v251 offset:42304
    ds_read_b64_tr_b16 a[38:39], v251 offset:42544
    v_rsq_f32 v242, v241
    s_waitcnt lgkmcnt(14)
    v_mfma_f32_32x32x16_bf16 v[32:47], a[8:11], v[100:103], v[32:47]
    ds_read_b64_tr_b16 a[40:41], v251 offset:42368
    ds_read_b64_tr_b16 a[42:43], v251 offset:42608
    v_and_b32 v224, 0xffff0000, v240
    s_waitcnt lgkmcnt(14)
    v_mfma_f32_32x32x16_bf16 v[48:63], a[12:15], v[100:103], v[48:63]
    ds_read_b64_tr_b16 a[44:45], v251 offset:42416
    ds_read_b64_tr_b16 a[46:47], v251 offset:42656
    s_barrier
    s_waitcnt vmcnt(14) lgkmcnt(14)
    v_mfma_f32_32x32x16_bf16 v[0:15], a[16:19], v[104:107], v[0:15]
    s_add_u32 s60, s60, 2560
    buffer_load_dwordx4 v[164:167], v253, s[24:27], s60 offen offset:0 sc1
    ds_read_b64_tr_b16 a[0:1], v251 offset:46080
    ds_read_b64_tr_b16 a[2:3], v251 offset:46320
    s_waitcnt lgkmcnt(14)
    v_mfma_f32_32x32x16_bf16 v[16:31], a[20:23], v[104:107], v[16:31]
    ds_read_b64_tr_b16 a[4:5], v251 offset:46144
    ds_read_b64_tr_b16 a[6:7], v251 offset:46384
    v_sub_f32 v225, v224, v240
    s_waitcnt lgkmcnt(14)
    v_mfma_f32_32x32x16_bf16 v[32:47], a[24:27], v[104:107], v[32:47]
    ds_read_b64_tr_b16 a[8:9], v251 offset:46208
    ds_read_b64_tr_b16 a[10:11], v251 offset:46448
    v_cvt_pk_bf16_f32 v244, -v224, -v224
    s_waitcnt lgkmcnt(14)
    v_mfma_f32_32x32x16_bf16 v[48:63], a[28:31], v[104:107], v[48:63]
    ds_read_b64_tr_b16 a[12:13], v251 offset:46256
    ds_read_b64_tr_b16 a[14:15], v251 offset:46496
    s_waitcnt vmcnt(14) lgkmcnt(14)
    v_mfma_f32_32x32x16_bf16 v[0:15], a[32:35], v[108:111], v[0:15]
    buffer_load_dwordx4 v[168:171], v253, s[24:27], s60 offen offset:512 sc1
    ds_read_b64_tr_b16 a[16:17], v251 offset:49920
    ds_read_b64_tr_b16 a[18:19], v251 offset:50160
    s_waitcnt lgkmcnt(14)
    v_mfma_f32_32x32x16_bf16 v[16:31], a[36:39], v[108:111], v[16:31]
    ds_read_b64_tr_b16 a[20:21], v251 offset:49984
    ds_read_b64_tr_b16 a[22:23], v251 offset:50224
    v_cvt_pk_bf16_f32 v245, v225, 0
    s_waitcnt lgkmcnt(14)
    v_mfma_f32_32x32x16_bf16 v[32:47], a[40:43], v[108:111], v[32:47]
    ds_read_b64_tr_b16 a[24:25], v251 offset:50048
    ds_read_b64_tr_b16 a[26:27], v251 offset:50288
    v_cndmask_b32_e64 v244, v244, 0, s[52:53]
    s_waitcnt lgkmcnt(14)
    v_mfma_f32_32x32x16_bf16 v[48:63], a[44:47], v[108:111], v[48:63]
    ds_read_b64_tr_b16 a[28:29], v251 offset:50096
    ds_read_b64_tr_b16 a[30:31], v251 offset:50336
    s_waitcnt vmcnt(14) lgkmcnt(14)
    v_mfma_f32_32x32x16_bf16 v[0:15], a[0:3], v[112:115], v[0:15]
    buffer_load_dwordx4 v[172:175], v253, s[24:27], s60 offen offset:1024 sc1
    ds_read_b64_tr_b16 a[32:33], v251 offset:53760
    ds_read_b64_tr_b16 a[34:35], v251 offset:54000
    s_waitcnt lgkmcnt(14)
    v_mfma_f32_32x32x16_bf16 v[16:31], a[4:7], v[112:115], v[16:31]
    ds_read_b64_tr_b16 a[36:37], v251 offset:53824
    ds_read_b64_tr_b16 a[38:39], v251 offset:54064
    v_cndmask_b32_e64 v245, v245, 0, s[52:53]
    s_waitcnt lgkmcnt(14)
    v_mfma_f32_32x32x16_bf16 v[32:47], a[8:11], v[112:115], v[32:47]
    ds_read_b64_tr_b16 a[40:41], v251 offset:53888
    ds_read_b64_tr_b16 a[42:43], v251 offset:54128
    s_waitcnt lgkmcnt(14)
    v_mfma_f32_32x32x16_bf16 v[48:63], a[12:15], v[112:115], v[48:63]
    ds_read_b64_tr_b16 a[44:45], v251 offset:53936
    ds_read_b64_tr_b16 a[46:47], v251 offset:54176
    s_waitcnt vmcnt(14) lgkmcnt(14)
    v_mfma_f32_32x32x16_bf16 v[0:15], a[16:19], v[116:119], v[0:15]
    buffer_load_dwordx4 v[176:179], v253, s[24:27], s60 offen offset:1536 sc1
    ds_read_b64_tr_b16 a[0:1], v251 offset:57600
    ds_read_b64_tr_b16 a[2:3], v251 offset:57840
    s_waitcnt lgkmcnt(14)
    v_mfma_f32_32x32x16_bf16 v[16:31], a[20:23], v[116:119], v[16:31]
    ds_read_b64_tr_b16 a[4:5], v251 offset:57664
    ds_read_b64_tr_b16 a[6:7], v251 offset:57904
    s_waitcnt lgkmcnt(14)
    v_mfma_f32_32x32x16_bf16 v[32:47], a[24:27], v[116:119], v[32:47]
    ds_read_b64_tr_b16 a[8:9], v251 offset:57728
    ds_read_b64_tr_b16 a[10:11], v251 offset:57968
    s_waitcnt lgkmcnt(14)
    v_mfma_f32_32x32x16_bf16 v[48:63], a[28:31], v[116:119], v[48:63]
    ds_read_b64_tr_b16 a[12:13], v251 offset:57776
    ds_read_b64_tr_b16 a[14:15], v251 offset:58016
    s_waitcnt vmcnt(14) lgkmcnt(14)
    v_mfma_f32_32x32x16_bf16 v[0:15], a[32:35], v[120:123], v[0:15]
    buffer_load_dwordx4 v[180:183], v253, s[24:27], s60 offen offset:2048 sc1
    ds_read_b64_tr_b16 a[16:17], v250 offset:0
    ds_read_b64_tr_b16 a[18:19], v250 offset:240
    s_waitcnt lgkmcnt(14)
    v_mfma_f32_32x32x16_bf16 v[16:31], a[36:39], v[120:123], v[16:31]
    ds_read_b64_tr_b16 a[20:21], v250 offset:64
    ds_read_b64_tr_b16 a[22:23], v250 offset:304
    s_waitcnt lgkmcnt(14)
    v_mfma_f32_32x32x16_bf16 v[32:47], a[40:43], v[120:123], v[32:47]
    ds_read_b64_tr_b16 a[24:25], v250 offset:128
    ds_read_b64_tr_b16 a[26:27], v250 offset:368
    s_waitcnt lgkmcnt(14)
    v_mfma_f32_32x32x16_bf16 v[48:63], a[44:47], v[120:123], v[48:63]
    ds_read_b64_tr_b16 a[28:29], v250 offset:176
    ds_read_b64_tr_b16 a[30:31], v250 offset:416
    s_waitcnt vmcnt(14) lgkmcnt(14)
    v_mfma_f32_32x32x16_bf16 v[0:15], a[0:3], v[124:127], v[0:15]
    s_add_u32 s60, s60, 2560
    buffer_load_dwordx4 v[184:187], v253, s[24:27], s60 offen offset:0 sc1
    ds_read_b64_tr_b16 a[32:33], v250 offset:3840
    ds_read_b64_tr_b16 a[34:35], v250 offset:4080
    s_waitcnt lgkmcnt(14)
    v_mfma_f32_32x32x16_bf16 v[16:31], a[4:7], v[124:127], v[16:31]
    ds_read_b64_tr_b16 a[36:37], v250 offset:3904
    ds_read_b64_tr_b16 a[38:39], v250 offset:4144
    s_waitcnt lgkmcnt(14)
    v_mfma_f32_32x32x16_bf16 v[32:47], a[8:11], v[124:127], v[32:47]
    ds_read_b64_tr_b16 a[40:41], v250 offset:3968
    ds_read_b64_tr_b16 a[42:43], v250 offset:4208
    s_waitcnt lgkmcnt(14)
    v_mfma_f32_32x32x16_bf16 v[48:63], a[12:15], v[124:127], v[48:63]
    ds_read_b64_tr_b16 a[44:45], v250 offset:4016
    ds_read_b64_tr_b16 a[46:47], v250 offset:4256
    s_waitcnt vmcnt(14) lgkmcnt(14)
    v_mfma_f32_32x32x16_bf16 v[0:15], a[16:19], v[128:131], v[0:15]
    buffer_load_dwordx4 v[188:191], v253, s[24:27], s60 offen offset:512 sc1
    ds_read_b64_tr_b16 a[0:1], v250 offset:7680
    ds_read_b64_tr_b16 a[2:3], v250 offset:7920
    s_waitcnt lgkmcnt(14)
    v_mfma_f32_32x32x16_bf16 v[16:31], a[20:23], v[128:131], v[16:31]
    ds_read_b64_tr_b16 a[4:5], v250 offset:7744
    ds_read_b64_tr_b16 a[6:7], v250 offset:7984
    s_waitcnt lgkmcnt(14)
    v_mfma_f32_32x32x16_bf16 v[32:47], a[24:27], v[128:131], v[32:47]
    ds_read_b64_tr_b16 a[8:9], v250 offset:7808
    ds_read_b64_tr_b16 a[10:11], v250 offset:8048
    s_waitcnt lgkmcnt(14)
    v_mfma_f32_32x32x16_bf16 v[48:63], a[28:31], v[128:131], v[48:63]
    ds_read_b64_tr_b16 a[12:13], v250 offset:7856
    ds_read_b64_tr_b16 a[14:15], v250 offset:8096
    s_waitcnt vmcnt(14) lgkmcnt(14)
    v_mfma_f32_32x32x16_bf16 v[0:15], a[32:35], v[132:135], v[0:15]
    buffer_load_dwordx4 v[192:195], v253, s[24:27], s60 offen offset:1024 sc1
    ds_read_b64_tr_b16 a[16:17], v250 offset:11520
    ds_read_b64_tr_b16 a[18:19], v250 offset:11760
    s_waitcnt lgkmcnt(14)
    v_mfma_f32_32x32x16_bf16 v[16:31], a[36:39], v[132:135], v[16:31]
    ds_read_b64_tr_b16 a[20:21], v250 offset:11584
    ds_read_b64_tr_b16 a[22:23], v250 offset:11824
    s_waitcnt lgkmcnt(14)
    v_mfma_f32_32x32x16_bf16 v[32:47], a[40:43], v[132:135], v[32:47]
    ds_read_b64_tr_b16 a[24:25], v250 offset:11648
    ds_read_b64_tr_b16 a[26:27], v250 offset:11888
    s_waitcnt lgkmcnt(14)
    v_mfma_f32_32x32x16_bf16 v[48:63], a[44:47], v[132:135], v[48:63]
    ds_read_b64_tr_b16 a[28:29], v250 offset:11696
    ds_read_b64_tr_b16 a[30:31], v250 offset:11936
    s_waitcnt vmcnt(14) lgkmcnt(14)
    v_mfma_f32_32x32x16_bf16 v[0:15], a[0:3], v[136:139], v[0:15]
    buffer_load_dwordx4 v[196:199], v253, s[24:27], s60 offen offset:1536 sc1
    ds_read_b64_tr_b16 a[32:33], v250 offset:15360
    ds_read_b64_tr_b16 a[34:35], v250 offset:15600
    s_waitcnt lgkmcnt(14)
    v_mfma_f32_32x32x16_bf16 v[16:31], a[4:7], v[136:139], v[16:31]
    ds_read_b64_tr_b16 a[36:37], v250 offset:15424
    ds_read_b64_tr_b16 a[38:39], v250 offset:15664
    s_waitcnt lgkmcnt(14)
    v_mfma_f32_32x32x16_bf16 v[32:47], a[8:11], v[136:139], v[32:47]
    ds_read_b64_tr_b16 a[40:41], v250 offset:15488
    ds_read_b64_tr_b16 a[42:43], v250 offset:15728
    s_waitcnt lgkmcnt(14)
    v_mfma_f32_32x32x16_bf16 v[48:63], a[12:15], v[136:139], v[48:63]
    ds_read_b64_tr_b16 a[44:45], v250 offset:15536
    ds_read_b64_tr_b16 a[46:47], v250 offset:15776
    s_waitcnt vmcnt(14) lgkmcnt(14)
    v_mfma_f32_32x32x16_bf16 v[0:15], a[16:19], v[140:143], v[0:15]
    buffer_load_dwordx4 v[200:203], v253, s[24:27], s60 offen offset:2048 sc1
    ds_read_b64_tr_b16 a[0:1], v250 offset:19200
    ds_read_b64_tr_b16 a[2:3], v250 offset:19440
    s_waitcnt lgkmcnt(14)
    v_mfma_f32_32x32x16_bf16 v[16:31], a[20:23], v[140:143], v[16:31]
    ds_read_b64_tr_b16 a[4:5], v250 offset:19264
    ds_read_b64_tr_b16 a[6:7], v250 offset:19504
    s_waitcnt lgkmcnt(14)
    v_mfma_f32_32x32x16_bf16 v[32:47], a[24:27], v[140:143], v[32:47]
    ds_read_b64_tr_b16 a[8:9], v250 offset:19328
    ds_read_b64_tr_b16 a[10:11], v250 offset:19568
    s_waitcnt lgkmcnt(14)
    v_mfma_f32_32x32x16_bf16 v[48:63], a[28:31], v[140:143], v[48:63]
    ds_read_b64_tr_b16 a[12:13], v250 offset:19376
    ds_read_b64_tr_b16 a[14:15], v250 offset:19616
    s_waitcnt vmcnt(14) lgkmcnt(14)
    v_mfma_f32_32x32x16_bf16 v[0:15], a[32:35], v[144:147], v[0:15]
    s_add_u32 s60, s60, 2560
    buffer_load_dwordx4 v[204:207], v253, s[24:27], s60 offen offset:0 sc1
    ds_read_b64_tr_b16 a[16:17], v250 offset:23040
    ds_read_b64_tr_b16 a[18:19], v250 offset:23280
    s_waitcnt lgkmcnt(14)
    v_mfma_f32_32x32x16_bf16 v[16:31], a[36:39], v[144:147], v[16:31]
    ds_read_b64_tr_b16 a[20:21], v250 offset:23104
    ds_read_b64_tr_b16 a[22:23], v250 offset:23344
    s_waitcnt lgkmcnt(14)
    v_mfma_f32_32x32x16_bf16 v[32:47], a[40:43], v[144:147], v[32:47]
    ds_read_b64_tr_b16 a[24:25], v250 offset:23168
    ds_read_b64_tr_b16 a[26:27], v250 offset:23408
    s_waitcnt lgkmcnt(14)
    v_mfma_f32_32x32x16_bf16 v[48:63], a[44:47], v[144:147], v[48:63]
    ds_read_b64_tr_b16 a[28:29], v250 offset:23216
    ds_read_b64_tr_b16 a[30:31], v250 offset:23456
    s_waitcnt vmcnt(14) lgkmcnt(14)
    v_mfma_f32_32x32x16_bf16 v[0:15], a[0:3], v[148:151], v[0:15]
    buffer_load_dwordx4 v[208:211], v253, s[24:27], s60 offen offset:512 sc1
    ds_read_b64_tr_b16 a[32:33], v250 offset:26880
    ds_read_b64_tr_b16 a[34:35], v250 offset:27120
    s_waitcnt lgkmcnt(14)
    v_mfma_f32_32x32x16_bf16 v[16:31], a[4:7], v[148:151], v[16:31]
    ds_read_b64_tr_b16 a[36:37], v250 offset:26944
    ds_read_b64_tr_b16 a[38:39], v250 offset:27184
    s_waitcnt lgkmcnt(14)
    v_mfma_f32_32x32x16_bf16 v[32:47], a[8:11], v[148:151], v[32:47]
    ds_read_b64_tr_b16 a[40:41], v250 offset:27008
    ds_read_b64_tr_b16 a[42:43], v250 offset:27248
    s_waitcnt lgkmcnt(14)
    v_mfma_f32_32x32x16_bf16 v[48:63], a[12:15], v[148:151], v[48:63]
    ds_read_b64_tr_b16 a[44:45], v250 offset:27056
    ds_read_b64_tr_b16 a[46:47], v250 offset:27296
    s_waitcnt vmcnt(14) lgkmcnt(14)
    v_mfma_f32_32x32x16_bf16 v[0:15], a[16:19], v[152:155], v[0:15]
    buffer_load_dwordx4 v[212:215], v253, s[24:27], s60 offen offset:1024 sc1
    ds_read_b64_tr_b16 a[0:1], v249 offset:0
    ds_read_b64_tr_b16 a[2:3], v249 offset:240
    s_waitcnt lgkmcnt(14)
    v_mfma_f32_32x32x16_bf16 v[16:31], a[20:23], v[152:155], v[16:31]
    ds_read_b64_tr_b16 a[4:5], v249 offset:64
    ds_read_b64_tr_b16 a[6:7], v249 offset:304
    s_waitcnt lgkmcnt(14)
    v_mfma_f32_32x32x16_bf16 v[32:47], a[24:27], v[152:155], v[32:47]
    ds_read_b64_tr_b16 a[8:9], v249 offset:128
    ds_read_b64_tr_b16 a[10:11], v249 offset:368
    s_waitcnt lgkmcnt(14)
    v_mfma_f32_32x32x16_bf16 v[48:63], a[28:31], v[152:155], v[48:63]
    ds_read_b64_tr_b16 a[12:13], v249 offset:176
    ds_read_b64_tr_b16 a[14:15], v249 offset:416
    s_waitcnt vmcnt(14) lgkmcnt(14)
    v_mfma_f32_32x32x16_bf16 v[0:15], a[32:35], v[156:159], v[0:15]
    buffer_load_dwordx4 v[216:219], v253, s[24:27], s60 offen offset:1536 sc1
    ds_read_b64_tr_b16 a[16:17], v249 offset:3840
    ds_read_b64_tr_b16 a[18:19], v249 offset:4080
    s_waitcnt lgkmcnt(14)
    v_mfma_f32_32x32x16_bf16 v[16:31], a[36:39], v[156:159], v[16:31]
    ds_read_b64_tr_b16 a[20:21], v249 offset:3904
    ds_read_b64_tr_b16 a[22:23], v249 offset:4144
    s_waitcnt lgkmcnt(14)
    v_mfma_f32_32x32x16_bf16 v[32:47], a[40:43], v[156:159], v[32:47]
    ds_read_b64_tr_b16 a[24:25], v249 offset:3968
    ds_read_b64_tr_b16 a[26:27], v249 offset:4208
    s_waitcnt lgkmcnt(14)
    v_mfma_f32_32x32x16_bf16 v[48:63], a[44:47], v[156:159], v[48:63]
    ds_read_b64_tr_b16 a[28:29], v249 offset:4016
    ds_read_b64_tr_b16 a[30:31], v249 offset:4256
    s_waitcnt vmcnt(14) lgkmcnt(14)
    v_mfma_f32_32x32x16_bf16 v[0:15], a[0:3], v[160:163], v[0:15]
    buffer_load_dwordx4 v[220:223], v253, s[24:27], s60 offen offset:2048 sc1
    ds_read_b64_tr_b16 a[32:33], v249 offset:7680
    ds_read_b64_tr_b16 a[34:35], v249 offset:7920
    s_waitcnt lgkmcnt(14)
    v_mfma_f32_32x32x16_bf16 v[16:31], a[4:7], v[160:163], v[16:31]
    ds_read_b64_tr_b16 a[36:37], v249 offset:7744
    ds_read_b64_tr_b16 a[38:39], v249 offset:7984
    s_waitcnt lgkmcnt(14)
    v_mfma_f32_32x32x16_bf16 v[32:47], a[8:11], v[160:163], v[32:47]
    ds_read_b64_tr_b16 a[40:41], v249 offset:7808
    ds_read_b64_tr_b16 a[42:43], v249 offset:8048
    s_waitcnt lgkmcnt(14)
    v_mfma_f32_32x32x16_bf16 v[48:63], a[12:15], v[160:163], v[48:63]
    ds_read_b64_tr_b16 a[44:45], v249 offset:7856
    ds_read_b64_tr_b16 a[46:47], v249 offset:8096
    s_barrier
    s_mul_i32 s54, s42, 25600
    s_add_u32 m0, s54, 0
    s_add_u32 s71, s54, s69
    s_waitcnt vmcnt(14) lgkmcnt(14)
    v_mfma_f32_32x32x16_bf16 v[0:15], a[16:19], v[164:167], v[0:15]
    ds_read_b64_tr_b16 a[0:1], v249 offset:11520
    ds_read_b64_tr_b16 a[2:3], v249 offset:11760
    s_waitcnt lgkmcnt(14)
    v_mfma_f32_32x32x16_bf16 v[16:31], a[20:23], v[164:167], v[16:31]
    buffer_load_dwordx4 v252, s[24:27], s71 offen offset:0 sc1 lds
    ds_read_b64_tr_b16 a[4:5], v249 offset:11584
    ds_read_b64_tr_b16 a[6:7], v249 offset:11824
    s_waitcnt lgkmcnt(14)
    v_mfma_f32_32x32x16_bf16 v[32:47], a[24:27], v[164:167], v[32:47]
    buffer_load_dwordx4 v252, s[24:27], s71 offen offset:1024 sc1 lds
    ds_read_b64_tr_b16 a[8:9], v249 offset:11648
    ds_read_b64_tr_b16 a[10:11], v249 offset:11888
    s_waitcnt lgkmcnt(14)
    v_mfma_f32_32x32x16_bf16 v[48:63], a[28:31], v[164:167], v[48:63]
    ds_read_b64_tr_b16 a[12:13], v249 offset:11696
    ds_read_b64_tr_b16 a[14:15], v249 offset:11936
    s_waitcnt vmcnt(15) lgkmcnt(14)
    v_mfma_f32_32x32x16_bf16 v[0:15], a[32:35], v[168:171], v[0:15]
    ds_read_b64_tr_b16 a[16:17], v249 offset:15360
    ds_read_b64_tr_b16 a[18:19], v249 offset:15600
    s_mov_b32 s60, 0x35c1a2a0
    s_mov_b32 s61, 0x3f317218
    s_waitcnt lgkmcnt(14)
    v_mfma_f32_32x32x16_bf16 v[16:31], a[36:39], v[168:171], v[16:31]
    buffer_load_dwordx4 v252, s[24:27], s71 offen offset:2048 sc1 lds
    ds_read_b64_tr_b16 a[20:21], v249 offset:15424
    ds_read_b64_tr_b16 a[22:23], v249 offset:15664
    v_mul_f32 v224, 0x3fb8aa3b, v242
    s_waitcnt lgkmcnt(14)
    v_mfma_f32_32x32x16_bf16 v[32:47], a[40:43], v[168:171], v[32:47]
    buffer_load_dwordx4 v252, s[24:27], s71 offen offset:3072 sc1 lds
    s_add_u32 m0, m0, 4096
    s_add_u32 s71, s71, 4096
    ds_read_b64_tr_b16 a[24:25], v249 offset:15488
    ds_read_b64_tr_b16 a[26:27], v249 offset:15728
    v_and_b32 v225, 31, v255
    s_waitcnt lgkmcnt(14)
    v_mfma_f32_32x32x16_bf16 v[48:63], a[44:47], v[168:171], v[48:63]
    ds_read_b64_tr_b16 a[28:29], v249 offset:15536
    ds_read_b64_tr_b16 a[30:31], v249 offset:15776
    v_lshrrev_b32 v226, 5, v255
    s_lshl_b32 s54, s42, 8
    s_waitcnt vmcnt(16) lgkmcnt(14)
    v_mfma_f32_32x32x16_bf16 v[0:15], a[0:3], v[172:175], v[0:15]
    ds_read_b64_tr_b16 a[32:33], v249 offset:19200
    ds_read_b64_tr_b16 a[34:35], v249 offset:19440
    s_add_u32 s54, s54, 104448
    v_lshl_add_u32 v227, v225, 3, s54
    s_waitcnt lgkmcnt(14)
    v_mfma_f32_32x32x16_bf16 v[16:31], a[4:7], v[172:175], v[16:31]
    buffer_load_dwordx4 v252, s[24:27], s71 offen offset:0 sc1 lds
    ds_read_b64_tr_b16 a[36:37], v249 offset:19264
    ds_read_b64_tr_b16 a[38:39], v249 offset:19504
    v_mul_u32_u24 v228, 1056, v226
    s_waitcnt lgkmcnt(14)
    v_mfma_f32_32x32x16_bf16 v[32:47], a[8:11], v[172:175], v[32:47]
    buffer_load_dwordx4 v252, s[24:27], s71 offen offset:1024 sc1 lds
    ds_read_b64_tr_b16 a[40:41], v249 offset:19328
    ds_read_b64_tr_b16 a[42:43], v249 offset:19568
    v_add_u32 v227, v227, v228
    s_waitcnt lgkmcnt(14)
    v_mfma_f32_32x32x16_bf16 v[48:63], a[12:15], v[172:175], v[48:63]
    ds_read_b64_tr_b16 a[44:45], v249 offset:19376
    ds_read_b64_tr_b16 a[46:47], v249 offset:19616
    v_add_u32 v228, v227, v228
    v_mov_b32 v110, 0x3f80
    s_waitcnt vmcnt(17) lgkmcnt(14)
    v_mfma_f32_32x32x16_bf16 v[0:15], a[16:19], v[176:179], v[0:15]
    ds_read_b64_tr_b16 a[0:1], v249 offset:23040
    ds_read_b64_tr_b16 a[2:3], v249 offset:23280
    v_mov_b32 v111, 0
    v_and_b32 v229, 3, v255
    s_waitcnt lgkmcnt(14)
    v_mfma_f32_32x32x16_bf16 v[16:31], a[20:23], v[176:179], v[16:31]
    buffer_load_dwordx4 v252, s[24:27], s71 offen offset:2048 sc1 lds
    ds_read_b64_tr_b16 a[4:5], v249 offset:23104
    ds_read_b64_tr_b16 a[6:7], v249 offset:23344
    v_bfe_u32 v230, v255, 2, 2
    s_waitcnt lgkmcnt(14)
    v_mfma_f32_32x32x16_bf16 v[32:47], a[24:27], v[176:179], v[32:47]
    buffer_load_dwordx4 v252, s[24:27], s71 offen offset:3072 sc1 lds
    s_add_u32 m0, m0, 4096
    s_add_u32 s71, s71, 4096
    ds_read_b64_tr_b16 a[8:9], v249 offset:23168
    ds_read_b64_tr_b16 a[10:11], v249 offset:23408
    v_lshl_add_u32 v230, v226, 3, v230
    s_waitcnt lgkmcnt(14)
    v_mfma_f32_32x32x16_bf16 v[48:63], a[28:31], v[176:179], v[48:63]
    ds_read_b64_tr_b16 a[12:13], v249 offset:23216
    ds_read_b64_tr_b16 a[14:15], v249 offset:23456
    v_lshlrev_b32 v230, 3, v230
    v_add_u32 v230, 104448, v230
    s_waitcnt vmcnt(18) lgkmcnt(14)
    v_mfma_f32_32x32x16_bf16 v[0:15], a[32:35], v[180:183], v[0:15]
    ds_read_b64_tr_b16 a[16:17], v249 offset:26880
    ds_read_b64_tr_b16 a[18:19], v249 offset:27120
    s_lshl_b32 s54, s42, 2
    v_add_u32 v231, s54, v229
    s_waitcnt lgkmcnt(14)
    v_mfma_f32_32x32x16_bf16 v[16:31], a[36:39], v[180:183], v[16:31]
    buffer_load_dwordx4 v252, s[24:27], s71 offen offset:0 sc1 lds
    ds_read_b64_tr_b16 a[20:21], v249 offset:26944
    ds_read_b64_tr_b16 a[22:23], v249 offset:27184
    v_and_b32 v232, 1, v229
    s_waitcnt lgkmcnt(14)
    v_mfma_f32_32x32x16_bf16 v[32:47], a[40:43], v[180:183], v[32:47]
    buffer_load_dwordx4 v252, s[24:27], s71 offen offset:1024 sc1 lds
    ds_read_b64_tr_b16 a[24:25], v249 offset:27008
    ds_read_b64_tr_b16 a[26:27], v249 offset:27248
    v_add_u32 v232, 8, v232
    s_waitcnt lgkmcnt(14)
    v_mfma_f32_32x32x16_bf16 v[48:63], a[44:47], v[180:183], v[48:63]
    ds_read_b64_tr_b16 a[28:29], v249 offset:27056
    ds_read_b64_tr_b16 a[30:31], v249 offset:27296
    v_cmp_gt_u32 vcc, 16, v225
    s_add_u32 s55, s42, 8
    s_waitcnt vmcnt(19) lgkmcnt(14)
    v_mfma_f32_32x32x16_bf16 v[0:15], a[0:3], v[184:187], v[0:15]
    ds_read_b64_tr_b16 a[32:33], v249 offset:30720
    ds_read_b64_tr_b16 a[34:35], v249 offset:30960
    v_mov_b32 v233, s55
    v_cndmask_b32 v232, v232, v231, vcc
    s_waitcnt lgkmcnt(14)
    v_mfma_f32_32x32x16_bf16 v[16:31], a[4:7], v[184:187], v[16:31]
    buffer_load_dwordx4 v252, s[24:27], s71 offen offset:2048 sc1 lds
    ds_read_b64_tr_b16 a[36:37], v249 offset:30784
    ds_read_b64_tr_b16 a[38:39], v249 offset:31024
    v_cmp_eq_u32 s[56:57], 0, v229
    s_waitcnt lgkmcnt(14)
    v_mfma_f32_32x32x16_bf16 v[32:47], a[8:11], v[184:187], v[32:47]
    buffer_load_dwordx4 v252, s[24:27], s71 offen offset:3072 sc1 lds
    s_add_u32 m0, m0, 4096
    s_add_u32 s71, s71, 4096
    ds_read_b64_tr_b16 a[40:41], v249 offset:30848
    ds_read_b64_tr_b16 a[42:43], v249 offset:31088
    v_mul_u32_u24 v232, 1056, v232
    s_waitcnt lgkmcnt(14)
    v_mfma_f32_32x32x16_bf16 v[48:63], a[12:15], v[184:187], v[48:63]
    ds_read_b64_tr_b16 a[44:45], v249 offset:30896
    ds_read_b64_tr_b16 a[46:47], v249 offset:31136
    v_cndmask_b32_e64 v233, 10, v233, s[56:57]
    v_cndmask_b32 v233, v233, v231, vcc
    s_waitcnt vmcnt(20) lgkmcnt(14)
    v_mfma_f32_32x32x16_bf16 v[0:15], a[16:19], v[188:191], v[0:15]
    ds_read_b64_tr_b16 a[0:1], v249 offset:34560
    ds_read_b64_tr_b16 a[2:3], v249 offset:34800
    v_mul_u32_u24 v233, 1056, v233
    v_add_u32 v232, v232, v230
    s_waitcnt lgkmcnt(14)
    v_mfma_f32_32x32x16_bf16 v[16:31], a[20:23], v[188:191], v[16:31]
    buffer_load_dwordx4 v252, s[24:27], s71 offen offset:0 sc1 lds
    ds_read_b64_tr_b16 a[4:5], v249 offset:34624
    ds_read_b64_tr_b16 a[6:7], v249 offset:34864
    v_add_u32 v233, v233, v230
    s_waitcnt lgkmcnt(14)
    v_mfma_f32_32x32x16_bf16 v[32:47], a[24:27], v[188:191], v[32:47]
    buffer_load_dwordx4 v252, s[24:27], s71 offen offset:1024 sc1 lds
    ds_read_b64_tr_b16 a[8:9], v249 offset:34688
    ds_read_b64_tr_b16 a[10:11], v249 offset:34928
    v_cmp_gt_u32 vcc, 24, v225
    s_waitcnt lgkmcnt(14)
    v_mfma_f32_32x32x16_bf16 v[48:63], a[28:31], v[188:191], v[48:63]
    ds_read_b64_tr_b16 a[12:13], v249 offset:34736
    ds_read_b64_tr_b16 a[14:15], v249 offset:34976
    v_mov_b32 v234, 0x80000000
    v_cndmask_b32 v234, v234, v252, vcc
    s_waitcnt vmcnt(21) lgkmcnt(14)
    v_mfma_f32_32x32x16_bf16 v[0:15], a[32:35], v[192:195], v[0:15]
    ds_read_b64_tr_b16 a[16:17], v249 offset:38400
    ds_read_b64_tr_b16 a[18:19], v249 offset:38640
    s_lshl_b32 s54, s41, 4
    s_lshr_b32 s55, s43, 1
    s_waitcnt lgkmcnt(14)
    v_mfma_f32_32x32x16_bf16 v[16:31], a[36:39], v[192:195], v[16:31]
    buffer_load_dwordx4 v252, s[24:27], s71 offen offset:2048 sc1 lds
    ds_read_b64_tr_b16 a[20:21], v249 offset:38464
    ds_read_b64_tr_b16 a[22:23], v249 offset:38704
    s_mul_i32 s55, s55, 1310720
    s_waitcnt lgkmcnt(14)
    v_mfma_f32_32x32x16_bf16 v[32:47], a[40:43], v[192:195], v[32:47]
    buffer_load_dwordx4 v252, s[24:27], s71 offen offset:3072 sc1 lds
    s_add_u32 m0, m0, 4096
    s_add_u32 s71, s71, 4096
    ds_read_b64_tr_b16 a[24:25], v249 offset:38528
    ds_read_b64_tr_b16 a[26:27], v249 offset:38768
    s_mul_i32 s54, s54, 5120
    s_waitcnt lgkmcnt(14)
    v_mfma_f32_32x32x16_bf16 v[48:63], a[44:47], v[192:195], v[48:63]
    ds_read_b64_tr_b16 a[28:29], v249 offset:38576
    ds_read_b64_tr_b16 a[30:31], v249 offset:38816
    s_add_u32 s54, s54, s55
    s_add_u32 s62, s54, 20971520
    s_waitcnt vmcnt(22) lgkmcnt(14)
    v_mfma_f32_32x32x16_bf16 v[0:15], a[0:3], v[196:199], v[0:15]
    ds_read_b64_tr_b16 a[32:33], v249 offset:42240
    ds_read_b64_tr_b16 a[34:35], v249 offset:42480
    s_lshl_b32 s54, s40, 10
    s_add_u32 s54, s54, s62
    s_waitcnt lgkmcnt(14)
    v_mfma_f32_32x32x16_bf16 v[16:31], a[4:7], v[196:199], v[16:31]
    buffer_load_dwordx4 v252, s[24:27], s71 offen offset:0 sc1 lds
    ds_read_b64_tr_b16 a[36:37], v249 offset:42304
    ds_read_b64_tr_b16 a[38:39], v249 offset:42544
    s_lshl_b32 s55, s42, 15
    s_waitcnt lgkmcnt(14)
    v_mfma_f32_32x32x16_bf16 v[32:47], a[8:11], v[196:199], v[32:47]
    buffer_load_dwordx4 v252, s[24:27], s71 offen offset:1024 sc1 lds
    ds_read_b64_tr_b16 a[40:41], v249 offset:42368
    ds_read_b64_tr_b16 a[42:43], v249 offset:42608
    s_add_u32 s55, s55, s54
    s_waitcnt lgkmcnt(14)
    v_mfma_f32_32x32x16_bf16 v[48:63], a[12:15], v[196:199], v[48:63]
    ds_read_b64_tr_b16 a[44:45], v249 offset:42416
    ds_read_b64_tr_b16 a[46:47], v249 offset:42656
    s_add_u32 s56, s55, 16384
    s_add_u32 s54, s54, 65536
    s_waitcnt vmcnt(23) lgkmcnt(14)
    v_mfma_f32_32x32x16_bf16 v[0:15], a[16:19], v[200:203], v[0:15]
    ds_read_b64_tr_b16 a[0:1], v249 offset:46080
    ds_read_b64_tr_b16 a[2:3], v249 offset:46320
    v_cmp_eq_u32 vcc, s42, v226
    v_mov_b32 v235, 0x80000000
    s_waitcnt lgkmcnt(14)
    v_mfma_f32_32x32x16_bf16 v[16:31], a[20:23], v[200:203], v[16:31]
    buffer_load_dwordx4 v252, s[24:27], s71 offen offset:2048 sc1 lds
    ds_read_b64_tr_b16 a[4:5], v249 offset:46144
    ds_read_b64_tr_b16 a[6:7], v249 offset:46384
    v_cndmask_b32 v235, v235, v234, vcc
    s_waitcnt lgkmcnt(14)
    v_mfma_f32_32x32x16_bf16 v[32:47], a[24:27], v[200:203], v[32:47]
    buffer_load_dwordx4 v252, s[24:27], s71 offen offset:3072 sc1 lds
    s_add_u32 m0, m0, 4096
    s_add_u32 s71, s71, 4096
    ds_read_b64_tr_b16 a[8:9], v249 offset:46208
    ds_read_b64_tr_b16 a[10:11], v249 offset:46448
    s_waitcnt lgkmcnt(14)
    v_mfma_f32_32x32x16_bf16 v[48:63], a[28:31], v[200:203], v[48:63]
    ds_read_b64_tr_b16 a[12:13], v249 offset:46256
    ds_read_b64_tr_b16 a[14:15], v249 offset:46496
    s_waitcnt vmcnt(24) lgkmcnt(14)
    v_mfma_f32_32x32x16_bf16 v[0:15], a[32:35], v[204:207], v[0:15]
    ds_read_b64_tr_b16 a[16:17], v249 offset:49920
    ds_read_b64_tr_b16 a[18:19], v249 offset:50160
    s_waitcnt lgkmcnt(14)
    v_mfma_f32_32x32x16_bf16 v[16:31], a[36:39], v[204:207], v[16:31]
    buffer_load_dwordx4 v252, s[24:27], s71 offen offset:0 sc1 lds
    ds_read_b64_tr_b16 a[20:21], v249 offset:49984
    ds_read_b64_tr_b16 a[22:23], v249 offset:50224
    s_waitcnt lgkmcnt(14)
    v_mfma_f32_32x32x16_bf16 v[32:47], a[40:43], v[204:207], v[32:47]
    buffer_load_dwordx4 v252, s[24:27], s71 offen offset:1024 sc1 lds
    ds_read_b64_tr_b16 a[24:25], v249 offset:50048
    ds_read_b64_tr_b16 a[26:27], v249 offset:50288
    s_waitcnt lgkmcnt(14)
    v_mfma_f32_32x32x16_bf16 v[48:63], a[44:47], v[204:207], v[48:63]
    ds_read_b64_tr_b16 a[28:29], v249 offset:50096
    ds_read_b64_tr_b16 a[30:31], v249 offset:50336
    s_waitcnt vmcnt(25) lgkmcnt(14)
    v_mfma_f32_32x32x16_bf16 v[0:15], a[0:3], v[208:211], v[0:15]
    ds_read_b64_tr_b16 a[32:33], v249 offset:53760
    ds_read_b64_tr_b16 a[34:35], v249 offset:54000
    s_waitcnt lgkmcnt(14)
    v_mfma_f32_32x32x16_bf16 v[16:31], a[4:7], v[208:211], v[16:31]
    buffer_load_dwordx4 v252, s[24:27], s71 offen offset:2048 sc1 lds
    ds_read_b64_tr_b16 a[36:37], v249 offset:53824
    ds_read_b64_tr_b16 a[38:39], v249 offset:54064
    s_waitcnt lgkmcnt(14)
    v_mfma_f32_32x32x16_bf16 v[32:47], a[8:11], v[208:211], v[32:47]
    buffer_load_dwordx4 v252, s[24:27], s71 offen offset:3072 sc1 lds
    s_add_u32 m0, m0, 4096
    s_add_u32 s71, s71, 4096
    ds_read_b64_tr_b16 a[40:41], v249 offset:53888
    ds_read_b64_tr_b16 a[42:43], v249 offset:54128
    s_waitcnt lgkmcnt(14)
    v_mfma_f32_32x32x16_bf16 v[48:63], a[12:15], v[208:211], v[48:63]
    ds_read_b64_tr_b16 a[44:45], v249 offset:53936
    ds_read_b64_tr_b16 a[46:47], v249 offset:54176
    s_waitcnt vmcnt(26) lgkmcnt(14)
    v_mfma_f32_32x32x16_bf16 v[0:15], a[16:19], v[212:215], v[0:15]
    ds_read_b64_tr_b16 a[0:1], v249 offset:57600
    ds_read_b64_tr_b16 a[2:3], v249 offset:57840
    s_waitcnt lgkmcnt(14)
    v_mfma_f32_32x32x16_bf16 v[16:31], a[20:23], v[212:215], v[16:31]
    buffer_load_dwordx4 v252, s[24:27], s71 offen offset:0 sc1 lds
    ds_read_b64_tr_b16 a[4:5], v249 offset:57664
    ds_read_b64_tr_b16 a[6:7], v249 offset:57904
    s_waitcnt lgkmcnt(14)
    v_mfma_f32_32x32x16_bf16 v[32:47], a[24:27], v[212:215], v[32:47]
    ds_read_b64_tr_b16 a[8:9], v249 offset:57728
    ds_read_b64_tr_b16 a[10:11], v249 offset:57968
    s_waitcnt lgkmcnt(14)
    v_mfma_f32_32x32x16_bf16 v[48:63], a[28:31], v[212:215], v[48:63]
    ds_read_b64_tr_b16 a[12:13], v249 offset:57776
    ds_read_b64_tr_b16 a[14:15], v249 offset:58016
    s_waitcnt vmcnt(26) lgkmcnt(14)
    v_mfma_f32_32x32x16_bf16 v[0:15], a[32:35], v[216:219], v[0:15]
    s_waitcnt lgkmcnt(12)
    v_mfma_f32_32x32x16_bf16 v[16:31], a[36:39], v[216:219], v[16:31]
    s_waitcnt lgkmcnt(10)
    v_mfma_f32_32x32x16_bf16 v[32:47], a[40:43], v[216:219], v[32:47]
    s_waitcnt lgkmcnt(8)
    v_mfma_f32_32x32x16_bf16 v[48:63], a[44:47], v[216:219], v[48:63]
    s_waitcnt vmcnt(25) lgkmcnt(6)
    v_mfma_f32_32x32x16_bf16 v[0:15], a[0:3], v[220:223], v[0:15]
    s_waitcnt lgkmcnt(4)
    v_mfma_f32_32x32x16_bf16 v[16:31], a[4:7], v[220:223], v[16:31]
    s_waitcnt lgkmcnt(2)
    v_mfma_f32_32x32x16_bf16 v[32:47], a[8:11], v[220:223], v[32:47]
    s_waitcnt lgkmcnt(0)
    v_mfma_f32_32x32x16_bf16 v[48:63], a[12:15], v[220:223], v[48:63]
    v_mfma_f32_32x32x8_bf16 v[16:31], a[222:223], v[244:245], v[16:31]
    v_mfma_f32_32x32x8_bf16 v[48:63], a[226:227], v[244:245], v[48:63]
    v_mfma_f32_32x32x8_bf16 v[32:47], a[224:225], v[244:245], v[32:47]
    v_mfma_f32_32x32x8_bf16 v[0:15], a[220:221], v[244:245], v[0:15]
    s_barrier
    s_branch EPI_A
QKV_3:
    s_waitcnt vmcnt(15)
    s_barrier
    buffer_load_dwordx2 v[224:225], v232, s[24:27], s63 offen offset:0 sc1
    buffer_load_dwordx2 v[226:227], v232, s[24:27], s63 offen offset:256 sc1
    buffer_load_dwordx2 v[228:229], v232, s[24:27], s63 offen offset:512 sc1
    buffer_load_dwordx2 v[230:231], v232, s[24:27], s63 offen offset:768 sc1
    buffer_load_dwordx4 v[64:67], v253, s[24:27], s60 offen offset:0 sc1
    buffer_load_dwordx4 v[68:71], v253, s[24:27], s60 offen offset:512 sc1
    buffer_load_dwordx4 v[72:75], v253, s[24:27], s60 offen offset:1024 sc1
    buffer_load_dwordx4 v[76:79], v253, s[24:27], s60 offen offset:1536 sc1
    buffer_load_dwordx4 v[80:83], v253, s[24:27], s60 offen offset:2048 sc1
    s_add_u32 s60, s60, 2560
    buffer_load_dwordx4 v[84:87], v253, s[24:27], s60 offen offset:0 sc1
    buffer_load_dwordx4 v[88:91], v253, s[24:27], s60 offen offset:512 sc1
    buffer_load_dwordx4 v[92:95], v253, s[24:27], s60 offen offset:1024 sc1
    ds_read_b64_tr_b16 a[0:1], v251 offset:0
    ds_read_b64_tr_b16 a[2:3], v251 offset:240
    ds_read_b64_tr_b16 a[4:5], v251 offset:64
    ds_read_b64_tr_b16 a[6:7], v251 offset:304
    ds_read_b64_tr_b16 a[8:9], v251 offset:128
    ds_read_b64_tr_b16 a[10:11], v251 offset:368
    ds_read_b64_tr_b16 a[12:13], v251 offset:176
    ds_read_b64_tr_b16 a[14:15], v251 offset:416
    ds_read_b64_tr_b16 a[16:17], v251 offset:3840
    ds_read_b64_tr_b16 a[18:19], v251 offset:4080
    ds_read_b64_tr_b16 a[20:21], v251 offset:3904
    ds_read_b64_tr_b16 a[22:23], v251 offset:4144
    ds_read_b64_tr_b16 a[24:25], v251 offset:3968
    ds_read_b64_tr_b16 a[26:27], v251 offset:4208
    ds_read_b64_tr_b16 a[28:29], v251 offset:4016
    ds_read_b64_tr_b16 a[30:31], v251 offset:4256
    s_waitcnt vmcnt(7) lgkmcnt(14)
    v_mfma_f32_32x32x16_bf16 v[0:15], a[0:3], v[64:67], 0
    buffer_load_dwordx4 v[96:99], v253, s[24:27], s60 offen offset:1536 sc1
    ds_read_b64_tr_b16 a[32:33], v251 offset:7680
    ds_read_b64_tr_b16 a[34:35], v251 offset:7920
    s_waitcnt lgkmcnt(14)
    v_mfma_f32_32x32x16_bf16 v[16:31], a[4:7], v[64:67], 0
    ds_read_b64_tr_b16 a[36:37], v251 offset:7744
    ds_read_b64_tr_b16 a[38:39], v251 offset:7984
    s_waitcnt lgkmcnt(14)
    v_mfma_f32_32x32x16_bf16 v[32:47], a[8:11], v[64:67], 0
    buffer_load_dwordx4 v[100:103], v253, s[24:27], s60 offen offset:2048 sc1
    ds_read_b64_tr_b16 a[40:41], v251 offset:7808
    ds_read_b64_tr_b16 a[42:43], v251 offset:8048
    s_waitcnt lgkmcnt(14)
    v_mfma_f32_32x32x16_bf16 v[48:63], a[12:15], v[64:67], 0
    ds_read_b64_tr_b16 a[44:45], v251 offset:7856
    ds_read_b64_tr_b16 a[46:47], v251 offset:8096
    s_waitcnt vmcnt(8) lgkmcnt(14)
    v_mfma_f32_32x32x16_bf16 v[0:15], a[16:19], v[68:71], v[0:15]
    s_add_u32 s60, s60, 2560
    buffer_load_dwordx4 v[104:107], v253, s[24:27], s60 offen offset:0 sc1
    ds_read_b64_tr_b16 a[0:1], v251 offset:11520
    ds_read_b64_tr_b16 a[2:3], v251 offset:11760
    s_waitcnt lgkmcnt(14)
    v_mfma_f32_32x32x16_bf16 v[16:31], a[20:23], v[68:71], v[16:31]
    ds_read_b64_tr_b16 a[4:5], v251 offset:11584
    ds_read_b64_tr_b16 a[6:7], v251 offset:11824
    s_waitcnt lgkmcnt(14)
    v_mfma_f32_32x32x16_bf16 v[32:47], a[24:27], v[68:71], v[32:47]
    buffer_load_dwordx4 v[108:111], v253, s[24:27], s60 offen offset:512 sc1
    ds_read_b64_tr_b16 a[8:9], v251 offset:11648
    ds_read_b64_tr_b16 a[10:11], v251 offset:11888
    s_waitcnt lgkmcnt(14)
    v_mfma_f32_32x32x16_bf16 v[48:63], a[28:31], v[68:71], v[48:63]
    ds_read_b64_tr_b16 a[12:13], v251 offset:11696
    ds_read_b64_tr_b16 a[14:15], v251 offset:11936
    s_waitcnt vmcnt(9) lgkmcnt(14)
    v_mfma_f32_32x32x16_bf16 v[0:15], a[32:35], v[72:75], v[0:15]
    buffer_load_dwordx4 v[112:115], v253, s[24:27], s60 offen offset:1024 sc1
    ds_read_b64_tr_b16 a[16:17], v251 offset:15360
    ds_read_b64_tr_b16 a[18:19], v251 offset:15600
    s_waitcnt lgkmcnt(14)
    v_mfma_f32_32x32x16_bf16 v[16:31], a[36:39], v[72:75], v[16:31]
    ds_read_b64_tr_b16 a[20:21], v251 offset:15424
    ds_read_b64_tr_b16 a[22:23], v251 offset:15664
    v_pk_add_f32 v[224:225], v[224:225], v[226:227]
    s_waitcnt lgkmcnt(14)
    v_mfma_f32_32x32x16_bf16 v[32:47], a[40:43], v[72:75], v[32:47]
    buffer_load_dwordx4 v[116:119], v253, s[24:27], s60 offen offset:1536 sc1
    ds_read_b64_tr_b16 a[24:25], v251 offset:15488
    ds_read_b64_tr_b16 a[26:27], v251 offset:15728
    v_pk_add_f32 v[228:229], v[228:229], v[230:231]
    s_waitcnt lgkmcnt(14)
    v_mfma_f32_32x32x16_bf16 v[48:63], a[44:47], v[72:75], v[48:63]
    ds_read_b64_tr_b16 a[28:29], v251 offset:15536
    ds_read_b64_tr_b16 a[30:31], v251 offset:15776
    s_waitcnt vmcnt(10) lgkmcnt(14)
    v_mfma_f32_32x32x16_bf16 v[0:15], a[0:3], v[76:79], v[0:15]
    buffer_load_dwordx4 v[120:123], v253, s[24:27], s60 offen offset:2048 sc1
    ds_read_b64_tr_b16 a[32:33], v251 offset:19200
    ds_read_b64_tr_b16 a[34:35], v251 offset:19440
    s_waitcnt lgkmcnt(14)
    v_mfma_f32_32x32x16_bf16 v[16:31], a[4:7], v[76:79], v[16:31]
    ds_read_b64_tr_b16 a[36:37], v251 offset:19264
    ds_read_b64_tr_b16 a[38:39], v251 offset:19504
    v_pk_add_f32 v[240:241], v[224:225], v[228:229]
    s_waitcnt lgkmcnt(14)
    v_mfma_f32_32x32x16_bf16 v[32:47], a[8:11], v[76:79], v[32:47]
    s_add_u32 s60, s60, 2560
    buffer_load_dwordx4 v[124:127], v253, s[24:27], s60 offen offset:0 sc1
    ds_read_b64_tr_b16 a[40:41], v251 offset:19328
    ds_read_b64_tr_b16 a[42:43], v251 offset:19568
    v_mov_b32 v224, v240
    s_waitcnt lgkmcnt(14)
    v_mfma_f32_32x32x16_bf16 v[48:63], a[12:15], v[76:79], v[48:63]
    ds_read_b64_tr_b16 a[44:45], v251 offset:19376
    ds_read_b64_tr_b16 a[46:47], v251 offset:19616
    s_waitcnt vmcnt(11) lgkmcnt(14)
    v_mfma_f32_32x32x16_bf16 v[0:15], a[16:19], v[80:83], v[0:15]
    buffer_load_dwordx4 v[128:131], v253, s[24:27], s60 offen offset:512 sc1
    ds_read_b64_tr_b16 a[0:1], v251 offset:23040
    ds_read_b64_tr_b16 a[2:3], v251 offset:23280
    s_waitcnt lgkmcnt(14)
    v_mfma_f32_32x32x16_bf16 v[16:31], a[20:23], v[80:83], v[16:31]
    ds_read_b64_tr_b16 a[4:5], v251 offset:23104
    ds_read_b64_tr_b16 a[6:7], v251 offset:23344
    v_mov_b32 v225, v241
    s_waitcnt lgkmcnt(14)
    v_mfma_f32_32x32x16_bf16 v[32:47], a[24:27], v[80:83], v[32:47]
    buffer_load_dwordx4 v[132:135], v253, s[24:27], s60 offen offset:1024 sc1
    ds_read_b64_tr_b16 a[8:9], v251 offset:23168
    ds_read_b64_tr_b16 a[10:11], v251 offset:23408
    v_permlane32_swap_b32 v240, v224
    s_waitcnt lgkmcnt(14)
    v_mfma_f32_32x32x16_bf16 v[48:63], a[28:31], v[80:83], v[48:63]
    ds_read_b64_tr_b16 a[12:13], v251 offset:23216
    ds_read_b64_tr_b16 a[14:15], v251 offset:23456
    s_waitcnt vmcnt(12) lgkmcnt(14)
    v_mfma_f32_32x32x16_bf16 v[0:15], a[32:35], v[84:87], v[0:15]
    buffer_load_dwordx4 v[136:139], v253, s[24:27], s60 offen offset:1536 sc1
    ds_read_b64_tr_b16 a[16:17], v251 offset:26880
    ds_read_b64_tr_b16 a[18:19], v251 offset:27120
    s_waitcnt lgkmcnt(14)
    v_mfma_f32_32x32x16_bf16 v[16:31], a[36:39], v[84:87], v[16:31]
    ds_read_b64_tr_b16 a[20:21], v251 offset:26944
    ds_read_b64_tr_b16 a[22:23], v251 offset:27184
    v_permlane32_swap_b32 v241, v225
    s_waitcnt lgkmcnt(14)
    v_mfma_f32_32x32x16_bf16 v[32:47], a[40:43], v[84:87], v[32:47]
    buffer_load_dwordx4 v[140:143], v253, s[24:27], s60 offen offset:2048 sc1
    ds_read_b64_tr_b16 a[24:25], v251 offset:27008
    ds_read_b64_tr_b16 a[26:27], v251 offset:27248
    v_add_f32 v240, v240, v224
    s_waitcnt lgkmcnt(14)
    v_mfma_f32_32x32x16_bf16 v[48:63], a[44:47], v[84:87], v[48:63]
    ds_read_b64_tr_b16 a[28:29], v251 offset:27056
    ds_read_b64_tr_b16 a[30:31], v251 offset:27296
    s_waitcnt vmcnt(13) lgkmcnt(14)
    v_mfma_f32_32x32x16_bf16 v[0:15], a[0:3], v[88:91], v[0:15]
    s_add_u32 s60, s60, 2560
    buffer_load_dwordx4 v[144:147], v253, s[24:27], s60 offen offset:0 sc1
    ds_read_b64_tr_b16 a[32:33], v251 offset:30720
    ds_read_b64_tr_b16 a[34:35], v251 offset:30960
    s_waitcnt lgkmcnt(14)
    v_mfma_f32_32x32x16_bf16 v[16:31], a[4:7], v[88:91], v[16:31]
    ds_read_b64_tr_b16 a[36:37], v251 offset:30784
    ds_read_b64_tr_b16 a[38:39], v251 offset:31024
    v_add_f32 v241, v241, v225
    s_waitcnt lgkmcnt(14)
    v_mfma_f32_32x32x16_bf16 v[32:47], a[8:11], v[88:91], v[32:47]
    buffer_load_dwordx4 v[148:151], v253, s[24:27], s60 offen offset:512 sc1
    ds_read_b64_tr_b16 a[40:41], v251 offset:30848
    ds_read_b64_tr_b16 a[42:43], v251 offset:31088
    v_mul_f32 v240, 0x3acccccd, v240
    s_waitcnt lgkmcnt(14)
    v_mfma_f32_32x32x16_bf16 v[48:63], a[12:15], v[88:91], v[48:63]
    ds_read_b64_tr_b16 a[44:45], v251 offset:30896
    ds_read_b64_tr_b16 a[46:47], v251 offset:31136
    s_waitcnt vmcnt(14) lgkmcnt(14)
    v_mfma_f32_32x32x16_bf16 v[0:15], a[16:19], v[92:95], v[0:15]
    buffer_load_dwordx4 v[152:155], v253, s[24:27], s60 offen offset:1024 sc1
    ds_read_b64_tr_b16 a[0:1], v251 offset:34560
    ds_read_b64_tr_b16 a[2:3], v251 offset:34800
    s_waitcnt lgkmcnt(14)
    v_mfma_f32_32x32x16_bf16 v[16:31], a[20:23], v[92:95], v[16:31]
    ds_read_b64_tr_b16 a[4:5], v251 offset:34624
    ds_read_b64_tr_b16 a[6:7], v251 offset:34864
    v_mul_f32 v241, 0x3acccccd, v241
    s_waitcnt lgkmcnt(14)
    v_mfma_f32_32x32x16_bf16 v[32:47], a[24:27], v[92:95], v[32:47]
    ds_read_b64_tr_b16 a[8:9], v251 offset:34688
    ds_read_b64_tr_b16 a[10:11], v251 offset:34928
    v_fma_f32 v241, -v240, v240, v241
    s_waitcnt lgkmcnt(14)
    v_mfma_f32_32x32x16_bf16 v[48:63], a[28:31], v[92:95], v[48:63]
    ds_read_b64_tr_b16 a[12:13], v251 offset:34736
    ds_read_b64_tr_b16 a[14:15], v251 offset:34976
    s_waitcnt vmcnt(14) lgkmcnt(14)
    v_mfma_f32_32x32x16_bf16 v[0:15], a[32:35], v[96:99], v[0:15]
    buffer_load_dwordx4 v[156:159], v253, s[24:27], s60 offen offset:1536 sc1
    ds_read_b64_tr_b16 a[16:17], v251 offset:38400
    ds_read_b64_tr_b16 a[18:19], v251 offset:38640
    s_waitcnt lgkmcnt(14)
    v_mfma_f32_32x32x16_bf16 v[16:31], a[36:39], v[96:99], v[16:31]
    ds_read_b64_tr_b16 a[20:21], v251 offset:38464
    ds_read_b64_tr_b16 a[22:23], v251 offset:38704
    v_max_f32 v241, 0, v241
    s_waitcnt lgkmcnt(14)
    v_mfma_f32_32x32x16_bf16 v[32:47], a[40:43], v[96:99], v[32:47]
    ds_read_b64_tr_b16 a[24:25], v251 offset:38528
    ds_read_b64_tr_b16 a[26:27], v251 offset:38768
    v_add_f32 v241, 0x3727c5ac, v241
    s_waitcnt lgkmcnt(14)
    v_mfma_f32_32x32x16_bf16 v[48:63], a[44:47], v[96:99], v[48:63]
    ds_read_b64_tr_b16 a[28:29], v251 offset:38576
    ds_read_b64_tr_b16 a[30:31], v251 offset:38816
    s_waitcnt vmcnt(14) lgkmcnt(14)
    v_mfma_f32_32x32x16_bf16 v[0:15], a[0:3], v[100:103], v[0:15]
    buffer_load_dwordx4 v[160:163], v253, s[24:27], s60 offen offset:2048 sc1
    ds_read_b64_tr_b16 a[32:33], v251 offset:42240
    ds_read_b64_tr_b16 a[34:35], v251 offset:42480
    s_waitcnt lgkmcnt(14)
    v_mfma_f32_32x32x16_bf16 v[16:31], a[4:7], v[100:103], v[16:31]
    ds_read_b64_tr_b16 a[36:37], v251 offset:42304
    ds_read_b64_tr_b16 a[38:39], v251 offset:42544
    v_rsq_f32 v242, v241
    s_waitcnt lgkmcnt(14)
    v_mfma_f32_32x32x16_bf16 v[32:47], a[8:11], v[100:103], v[32:47]
    ds_read_b64_tr_b16 a[40:41], v251 offset:42368
    ds_read_b64_tr_b16 a[42:43], v251 offset:42608
    v_and_b32 v224, 0xffff0000, v240
    s_waitcnt lgkmcnt(14)
    v_mfma_f32_32x32x16_bf16 v[48:63], a[12:15], v[100:103], v[48:63]
    ds_read_b64_tr_b16 a[44:45], v251 offset:42416
    ds_read_b64_tr_b16 a[46:47], v251 offset:42656
    s_barrier
    s_waitcnt vmcnt(14) lgkmcnt(14)
    v_mfma_f32_32x32x16_bf16 v[0:15], a[16:19], v[104:107], v[0:15]
    s_add_u32 s60, s60, 2560
    buffer_load_dwordx4 v[164:167], v253, s[24:27], s60 offen offset:0 sc1
    ds_read_b64_tr_b16 a[0:1], v251 offset:46080
    ds_read_b64_tr_b16 a[2:3], v251 offset:46320
    s_waitcnt lgkmcnt(14)
    v_mfma_f32_32x32x16_bf16 v[16:31], a[20:23], v[104:107], v[16:31]
    ds_read_b64_tr_b16 a[4:5], v251 offset:46144
    ds_read_b64_tr_b16 a[6:7], v251 offset:46384
    v_sub_f32 v225, v224, v240
    s_waitcnt lgkmcnt(14)
    v_mfma_f32_32x32x16_bf16 v[32:47], a[24:27], v[104:107], v[32:47]
    ds_read_b64_tr_b16 a[8:9], v251 offset:46208
    ds_read_b64_tr_b16 a[10:11], v251 offset:46448
    v_cvt_pk_bf16_f32 v244, -v224, -v224
    s_waitcnt lgkmcnt(14)
    v_mfma_f32_32x32x16_bf16 v[48:63], a[28:31], v[104:107], v[48:63]
    ds_read_b64_tr_b16 a[12:13], v251 offset:46256
    ds_read_b64_tr_b16 a[14:15], v251 offset:46496
    s_waitcnt vmcnt(14) lgkmcnt(14)
    v_mfma_f32_32x32x16_bf16 v[0:15], a[32:35], v[108:111], v[0:15]
    buffer_load_dwordx4 v[168:171], v253, s[24:27], s60 offen offset:512 sc1
    ds_read_b64_tr_b16 a[16:17], v251 offset:49920
    ds_read_b64_tr_b16 a[18:19], v251 offset:50160
    s_waitcnt lgkmcnt(14)
    v_mfma_f32_32x32x16_bf16 v[16:31], a[36:39], v[108:111], v[16:31]
    ds_read_b64_tr_b16 a[20:21], v251 offset:49984
    ds_read_b64_tr_b16 a[22:23], v251 offset:50224
    v_cvt_pk_bf16_f32 v245, v225, 0
    s_waitcnt lgkmcnt(14)
    v_mfma_f32_32x32x16_bf16 v[32:47], a[40:43], v[108:111], v[32:47]
    ds_read_b64_tr_b16 a[24:25], v251 offset:50048
    ds_read_b64_tr_b16 a[26:27], v251 offset:50288
    v_cndmask_b32_e64 v244, v244, 0, s[52:53]
    s_waitcnt lgkmcnt(14)
    v_mfma_f32_32x32x16_bf16 v[48:63], a[44:47], v[108:111], v[48:63]
    ds_read_b64_tr_b16 a[28:29], v251 offset:50096
    ds_read_b64_tr_b16 a[30:31], v251 offset:50336
    s_waitcnt vmcnt(14) lgkmcnt(14)
    v_mfma_f32_32x32x16_bf16 v[0:15], a[0:3], v[112:115], v[0:15]
    buffer_load_dwordx4 v[172:175], v253, s[24:27], s60 offen offset:1024 sc1
    ds_read_b64_tr_b16 a[32:33], v251 offset:53760
    ds_read_b64_tr_b16 a[34:35], v251 offset:54000
    s_waitcnt lgkmcnt(14)
    v_mfma_f32_32x32x16_bf16 v[16:31], a[4:7], v[112:115], v[16:31]
    ds_read_b64_tr_b16 a[36:37], v251 offset:53824
    ds_read_b64_tr_b16 a[38:39], v251 offset:54064
    v_cndmask_b32_e64 v245, v245, 0, s[52:53]
    s_waitcnt lgkmcnt(14)
    v_mfma_f32_32x32x16_bf16 v[32:47], a[8:11], v[112:115], v[32:47]
    ds_read_b64_tr_b16 a[40:41], v251 offset:53888
    ds_read_b64_tr_b16 a[42:43], v251 offset:54128
    s_waitcnt lgkmcnt(14)
    v_mfma_f32_32x32x16_bf16 v[48:63], a[12:15], v[112:115], v[48:63]
    ds_read_b64_tr_b16 a[44:45], v251 offset:53936
    ds_read_b64_tr_b16 a[46:47], v251 offset:54176
    s_waitcnt vmcnt(14) lgkmcnt(14)
    v_mfma_f32_32x32x16_bf16 v[0:15], a[16:19], v[116:119], v[0:15]
    buffer_load_dwordx4 v[176:179], v253, s[24:27], s60 offen offset:1536 sc1
    ds_read_b64_tr_b16 a[0:1], v251 offset:57600
    ds_read_b64_tr_b16 a[2:3], v251 offset:57840
    s_waitcnt lgkmcnt(14)
    v_mfma_f32_32x32x16_bf16 v[16:31], a[20:23], v[116:119], v[16:31]
    ds_read_b64_tr_b16 a[4:5], v251 offset:57664
    ds_read_b64_tr_b16 a[6:7], v251 offset:57904
    s_waitcnt lgkmcnt(14)
    v_mfma_f32_32x32x16_bf16 v[32:47], a[24:27], v[116:119], v[32:47]
    ds_read_b64_tr_b16 a[8:9], v251 offset:57728
    ds_read_b64_tr_b16 a[10:11], v251 offset:57968
    s_waitcnt lgkmcnt(14)
    v_mfma_f32_32x32x16_bf16 v[48:63], a[28:31], v[116:119], v[48:63]
    ds_read_b64_tr_b16 a[12:13], v251 offset:57776
    ds_read_b64_tr_b16 a[14:15], v251 offset:58016
    s_waitcnt vmcnt(14) lgkmcnt(14)
    v_mfma_f32_32x32x16_bf16 v[0:15], a[32:35], v[120:123], v[0:15]
    buffer_load_dwordx4 v[180:183], v253, s[24:27], s60 offen offset:2048 sc1
    ds_read_b64_tr_b16 a[16:17], v250 offset:0
    ds_read_b64_tr_b16 a[18:19], v250 offset:240
    s_waitcnt lgkmcnt(14)
    v_mfma_f32_32x32x16_bf16 v[16:31], a[36:39], v[120:123], v[16:31]
    ds_read_b64_tr_b16 a[20:21], v250 offset:64
    ds_read_b64_tr_b16 a[22:23], v250 offset:304
    s_waitcnt lgkmcnt(14)
    v_mfma_f32_32x32x16_bf16 v[32:47], a[40:43], v[120:123], v[32:47]
    ds_read_b64_tr_b16 a[24:25], v250 offset:128
    ds_read_b64_tr_b16 a[26:27], v250 offset:368
    s_waitcnt lgkmcnt(14)
    v_mfma_f32_32x32x16_bf16 v[48:63], a[44:47], v[120:123], v[48:63]
    ds_read_b64_tr_b16 a[28:29], v250 offset:176
    ds_read_b64_tr_b16 a[30:31], v250 offset:416
    s_waitcnt vmcnt(14) lgkmcnt(14)
    v_mfma_f32_32x32x16_bf16 v[0:15], a[0:3], v[124:127], v[0:15]
    s_add_u32 s60, s60, 2560
    buffer_load_dwordx4 v[184:187], v253, s[24:27], s60 offen offset:0 sc1
    ds_read_b64_tr_b16 a[32:33], v250 offset:3840
    ds_read_b64_tr_b16 a[34:35], v250 offset:4080
    s_waitcnt lgkmcnt(14)
    v_mfma_f32_32x32x16_bf16 v[16:31], a[4:7], v[124:127], v[16:31]
    ds_read_b64_tr_b16 a[36:37], v250 offset:3904
    ds_read_b64_tr_b16 a[38:39], v250 offset:4144
    s_waitcnt lgkmcnt(14)
    v_mfma_f32_32x32x16_bf16 v[32:47], a[8:11], v[124:127], v[32:47]
    ds_read_b64_tr_b16 a[40:41], v250 offset:3968
    ds_read_b64_tr_b16 a[42:43], v250 offset:4208
    s_waitcnt lgkmcnt(14)
    v_mfma_f32_32x32x16_bf16 v[48:63], a[12:15], v[124:127], v[48:63]
    ds_read_b64_tr_b16 a[44:45], v250 offset:4016
    ds_read_b64_tr_b16 a[46:47], v250 offset:4256
    s_waitcnt vmcnt(14) lgkmcnt(14)
    v_mfma_f32_32x32x16_bf16 v[0:15], a[16:19], v[128:131], v[0:15]
    buffer_load_dwordx4 v[188:191], v253, s[24:27], s60 offen offset:512 sc1
    ds_read_b64_tr_b16 a[0:1], v250 offset:7680
    ds_read_b64_tr_b16 a[2:3], v250 offset:7920
    s_waitcnt lgkmcnt(14)
    v_mfma_f32_32x32x16_bf16 v[16:31], a[20:23], v[128:131], v[16:31]
    ds_read_b64_tr_b16 a[4:5], v250 offset:7744
    ds_read_b64_tr_b16 a[6:7], v250 offset:7984
    s_waitcnt lgkmcnt(14)
    v_mfma_f32_32x32x16_bf16 v[32:47], a[24:27], v[128:131], v[32:47]
    ds_read_b64_tr_b16 a[8:9], v250 offset:7808
    ds_read_b64_tr_b16 a[10:11], v250 offset:8048
    s_waitcnt lgkmcnt(14)
    v_mfma_f32_32x32x16_bf16 v[48:63], a[28:31], v[128:131], v[48:63]
    ds_read_b64_tr_b16 a[12:13], v250 offset:7856
    ds_read_b64_tr_b16 a[14:15], v250 offset:8096
    s_waitcnt vmcnt(14) lgkmcnt(14)
    v_mfma_f32_32x32x16_bf16 v[0:15], a[32:35], v[132:135], v[0:15]
    buffer_load_dwordx4 v[192:195], v253, s[24:27], s60 offen offset:1024 sc1
    ds_read_b64_tr_b16 a[16:17], v250 offset:11520
    ds_read_b64_tr_b16 a[18:19], v250 offset:11760
    s_waitcnt lgkmcnt(14)
    v_mfma_f32_32x32x16_bf16 v[16:31], a[36:39], v[132:135], v[16:31]
    ds_read_b64_tr_b16 a[20:21], v250 offset:11584
    ds_read_b64_tr_b16 a[22:23], v250 offset:11824
    s_waitcnt lgkmcnt(14)
    v_mfma_f32_32x32x16_bf16 v[32:47], a[40:43], v[132:135], v[32:47]
    ds_read_b64_tr_b16 a[24:25], v250 offset:11648
    ds_read_b64_tr_b16 a[26:27], v250 offset:11888
    s_waitcnt lgkmcnt(14)
    v_mfma_f32_32x32x16_bf16 v[48:63], a[44:47], v[132:135], v[48:63]
    ds_read_b64_tr_b16 a[28:29], v250 offset:11696
    ds_read_b64_tr_b16 a[30:31], v250 offset:11936
    s_waitcnt vmcnt(14) lgkmcnt(14)
    v_mfma_f32_32x32x16_bf16 v[0:15], a[0:3], v[136:139], v[0:15]
    buffer_load_dwordx4 v[196:199], v253, s[24:27], s60 offen offset:1536 sc1
    ds_read_b64_tr_b16 a[32:33], v250 offset:15360
    ds_read_b64_tr_b16 a[34:35], v250 offset:15600
    s_waitcnt lgkmcnt(14)
    v_mfma_f32_32x32x16_bf16 v[16:31], a[4:7], v[136:139], v[16:31]
    ds_read_b64_tr_b16 a[36:37], v250 offset:15424
    ds_read_b64_tr_b16 a[38:39], v250 offset:15664
    s_waitcnt lgkmcnt(14)
    v_mfma_f32_32x32x16_bf16 v[32:47], a[8:11], v[136:139], v[32:47]
    ds_read_b64_tr_b16 a[40:41], v250 offset:15488
    ds_read_b64_tr_b16 a[42:43], v250 offset:15728
    s_waitcnt lgkmcnt(14)
    v_mfma_f32_32x32x16_bf16 v[48:63], a[12:15], v[136:139], v[48:63]
    ds_read_b64_tr_b16 a[44:45], v250 offset:15536
    ds_read_b64_tr_b16 a[46:47], v250 offset:15776
    s_waitcnt vmcnt(14) lgkmcnt(14)
    v_mfma_f32_32x32x16_bf16 v[0:15], a[16:19], v[140:143], v[0:15]
    buffer_load_dwordx4 v[200:203], v253, s[24:27], s60 offen offset:2048 sc1
    ds_read_b64_tr_b16 a[0:1], v250 offset:19200
    ds_read_b64_tr_b16 a[2:3], v250 offset:19440
    s_waitcnt lgkmcnt(14)
    v_mfma_f32_32x32x16_bf16 v[16:31], a[20:23], v[140:143], v[16:31]
    ds_read_b64_tr_b16 a[4:5], v250 offset:19264
    ds_read_b64_tr_b16 a[6:7], v250 offset:19504
    s_waitcnt lgkmcnt(14)
    v_mfma_f32_32x32x16_bf16 v[32:47], a[24:27], v[140:143], v[32:47]
    ds_read_b64_tr_b16 a[8:9], v250 offset:19328
    ds_read_b64_tr_b16 a[10:11], v250 offset:19568
    s_waitcnt lgkmcnt(14)
    v_mfma_f32_32x32x16_bf16 v[48:63], a[28:31], v[140:143], v[48:63]
    ds_read_b64_tr_b16 a[12:13], v250 offset:19376
    ds_read_b64_tr_b16 a[14:15], v250 offset:19616
    s_waitcnt vmcnt(14) lgkmcnt(14)
    v_mfma_f32_32x32x16_bf16 v[0:15], a[32:35], v[144:147], v[0:15]
    s_add_u32 s60, s60, 2560
    buffer_load_dwordx4 v[204:207], v253, s[24:27], s60 offen offset:0 sc1
    ds_read_b64_tr_b16 a[16:17], v250 offset:23040
    ds_read_b64_tr_b16 a[18:19], v250 offset:23280
    s_waitcnt lgkmcnt(14)
    v_mfma_f32_32x32x16_bf16 v[16:31], a[36:39], v[144:147], v[16:31]
    ds_read_b64_tr_b16 a[20:21], v250 offset:23104
    ds_read_b64_tr_b16 a[22:23], v250 offset:23344
    s_waitcnt lgkmcnt(14)
    v_mfma_f32_32x32x16_bf16 v[32:47], a[40:43], v[144:147], v[32:47]
    ds_read_b64_tr_b16 a[24:25], v250 offset:23168
    ds_read_b64_tr_b16 a[26:27], v250 offset:23408
    s_waitcnt lgkmcnt(14)
    v_mfma_f32_32x32x16_bf16 v[48:63], a[44:47], v[144:147], v[48:63]
    ds_read_b64_tr_b16 a[28:29], v250 offset:23216
    ds_read_b64_tr_b16 a[30:31], v250 offset:23456
    s_waitcnt vmcnt(14) lgkmcnt(14)
    v_mfma_f32_32x32x16_bf16 v[0:15], a[0:3], v[148:151], v[0:15]
    buffer_load_dwordx4 v[208:211], v253, s[24:27], s60 offen offset:512 sc1
    ds_read_b64_tr_b16 a[32:33], v250 offset:26880
    ds_read_b64_tr_b16 a[34:35], v250 offset:27120
    s_waitcnt lgkmcnt(14)
    v_mfma_f32_32x32x16_bf16 v[16:31], a[4:7], v[148:151], v[16:31]
    ds_read_b64_tr_b16 a[36:37], v250 offset:26944
    ds_read_b64_tr_b16 a[38:39], v250 offset:27184
    s_waitcnt lgkmcnt(14)
    v_mfma_f32_32x32x16_bf16 v[32:47], a[8:11], v[148:151], v[32:47]
    ds_read_b64_tr_b16 a[40:41], v250 offset:27008
    ds_read_b64_tr_b16 a[42:43], v250 offset:27248
    s_waitcnt lgkmcnt(14)
    v_mfma_f32_32x32x16_bf16 v[48:63], a[12:15], v[148:151], v[48:63]
    ds_read_b64_tr_b16 a[44:45], v250 offset:27056
    ds_read_b64_tr_b16 a[46:47], v250 offset:27296
    s_waitcnt vmcnt(14) lgkmcnt(14)
    v_mfma_f32_32x32x16_bf16 v[0:15], a[16:19], v[152:155], v[0:15]
    buffer_load_dwordx4 v[212:215], v253, s[24:27], s60 offen offset:1024 sc1
    ds_read_b64_tr_b16 a[0:1], v249 offset:0
    ds_read_b64_tr_b16 a[2:3], v249 offset:240
    s_waitcnt lgkmcnt(14)
    v_mfma_f32_32x32x16_bf16 v[16:31], a[20:23], v[152:155], v[16:31]
    ds_read_b64_tr_b16 a[4:5], v249 offset:64
    ds_read_b64_tr_b16 a[6:7], v249 offset:304
    s_waitcnt lgkmcnt(14)
    v_mfma_f32_32x32x16_bf16 v[32:47], a[24:27], v[152:155], v[32:47]
    ds_read_b64_tr_b16 a[8:9], v249 offset:128
    ds_read_b64_tr_b16 a[10:11], v249 offset:368
    s_waitcnt lgkmcnt(14)
    v_mfma_f32_32x32x16_bf16 v[48:63], a[28:31], v[152:155], v[48:63]
    ds_read_b64_tr_b16 a[12:13], v249 offset:176
    ds_read_b64_tr_b16 a[14:15], v249 offset:416
    s_waitcnt vmcnt(14) lgkmcnt(14)
    v_mfma_f32_32x32x16_bf16 v[0:15], a[32:35], v[156:159], v[0:15]
    buffer_load_dwordx4 v[216:219], v253, s[24:27], s60 offen offset:1536 sc1
    ds_read_b64_tr_b16 a[16:17], v249 offset:3840
    ds_read_b64_tr_b16 a[18:19], v249 offset:4080
    s_waitcnt lgkmcnt(14)
    v_mfma_f32_32x32x16_bf16 v[16:31], a[36:39], v[156:159], v[16:31]
    ds_read_b64_tr_b16 a[20:21], v249 offset:3904
    ds_read_b64_tr_b16 a[22:23], v249 offset:4144
    s_waitcnt lgkmcnt(14)
    v_mfma_f32_32x32x16_bf16 v[32:47], a[40:43], v[156:159], v[32:47]
    ds_read_b64_tr_b16 a[24:25], v249 offset:3968
    ds_read_b64_tr_b16 a[26:27], v249 offset:4208
    s_waitcnt lgkmcnt(14)
    v_mfma_f32_32x32x16_bf16 v[48:63], a[44:47], v[156:159], v[48:63]
    ds_read_b64_tr_b16 a[28:29], v249 offset:4016
    ds_read_b64_tr_b16 a[30:31], v249 offset:4256
    s_waitcnt vmcnt(14) lgkmcnt(14)
    v_mfma_f32_32x32x16_bf16 v[0:15], a[0:3], v[160:163], v[0:15]
    buffer_load_dwordx4 v[220:223], v253, s[24:27], s60 offen offset:2048 sc1
    ds_read_b64_tr_b16 a[32:33], v249 offset:7680
    ds_read_b64_tr_b16 a[34:35], v249 offset:7920
    s_waitcnt lgkmcnt(14)
    v_mfma_f32_32x32x16_bf16 v[16:31], a[4:7], v[160:163], v[16:31]
    ds_read_b64_tr_b16 a[36:37], v249 offset:7744
    ds_read_b64_tr_b16 a[38:39], v249 offset:7984
    s_waitcnt lgkmcnt(14)
    v_mfma_f32_32x32x16_bf16 v[32:47], a[8:11], v[160:163], v[32:47]
    ds_read_b64_tr_b16 a[40:41], v249 offset:7808
    ds_read_b64_tr_b16 a[42:43], v249 offset:8048
    s_waitcnt lgkmcnt(14)
    v_mfma_f32_32x32x16_bf16 v[48:63], a[12:15], v[160:163], v[48:63]
    ds_read_b64_tr_b16 a[44:45], v249 offset:7856
    ds_read_b64_tr_b16 a[46:47], v249 offset:8096
    s_barrier
    s_mul_i32 s54, s42, 25600
    s_add_u32 m0, s54, 0
    s_add_u32 s71, s54, s69
    s_waitcnt vmcnt(14) lgkmcnt(14)
    v_mfma_f32_32x32x16_bf16 v[0:15], a[16:19], v[164:167], v[0:15]
    ds_read_b64_tr_b16 a[0:1], v249 offset:11520
    ds_read_b64_tr_b16 a[2:3], v249 offset:11760
    s_waitcnt lgkmcnt(14)
    v_mfma_f32_32x32x16_bf16 v[16:31], a[20:23], v[164:167], v[16:31]
    buffer_load_dwordx4 v252, s[24:27], s71 offen offset:0 sc1 lds
    ds_read_b64_tr_b16 a[4:5], v249 offset:11584
    ds_read_b64_tr_b16 a[6:7], v249 offset:11824
    s_waitcnt lgkmcnt(14)
    v_mfma_f32_32x32x16_bf16 v[32:47], a[24:27], v[164:167], v[32:47]
    buffer_load_dwordx4 v252, s[24:27], s71 offen offset:1024 sc1 lds
    ds_read_b64_tr_b16 a[8:9], v249 offset:11648
    ds_read_b64_tr_b16 a[10:11], v249 offset:11888
    s_waitcnt lgkmcnt(14)
    v_mfma_f32_32x32x16_bf16 v[48:63], a[28:31], v[164:167], v[48:63]
    ds_read_b64_tr_b16 a[12:13], v249 offset:11696
    ds_read_b64_tr_b16 a[14:15], v249 offset:11936
    s_waitcnt vmcnt(15) lgkmcnt(14)
    v_mfma_f32_32x32x16_bf16 v[0:15], a[32:35], v[168:171], v[0:15]
    ds_read_b64_tr_b16 a[16:17], v249 offset:15360
    ds_read_b64_tr_b16 a[18:19], v249 offset:15600
    v_and_b32 v225, 31, v255
    v_lshrrev_b32 v226, 5, v255
    s_waitcnt lgkmcnt(14)
    v_mfma_f32_32x32x16_bf16 v[16:31], a[36:39], v[168:171], v[16:31]
    buffer_load_dwordx4 v252, s[24:27], s71 offen offset:2048 sc1 lds
    ds_read_b64_tr_b16 a[20:21], v249 offset:15424
    ds_read_b64_tr_b16 a[22:23], v249 offset:15664
    s_mul_i32 s54, s42, 3456
    s_waitcnt lgkmcnt(14)
    v_mfma_f32_32x32x16_bf16 v[32:47], a[40:43], v[168:171], v[32:47]
    buffer_load_dwordx4 v252, s[24:27], s71 offen offset:3072 sc1 lds
    s_add_u32 m0, m0, 4096
    s_add_u32 s71, s71, 4096
    ds_read_b64_tr_b16 a[24:25], v249 offset:15488
    ds_read_b64_tr_b16 a[26:27], v249 offset:15728
    s_add_u32 s54, s54, 104448
    s_waitcnt lgkmcnt(14)
    v_mfma_f32_32x32x16_bf16 v[48:63], a[44:47], v[168:171], v[48:63]
    ds_read_b64_tr_b16 a[28:29], v249 offset:15536
    ds_read_b64_tr_b16 a[30:31], v249 offset:15776
    v_lshl_add_u32 v227, v225, 3, s54
    v_mul_u32_u24 v228, 288, v226
    s_waitcnt vmcnt(16) lgkmcnt(14)
    v_mfma_f32_32x32x16_bf16 v[0:15], a[0:3], v[172:175], v[0:15]
    ds_read_b64_tr_b16 a[32:33], v249 offset:19200
    ds_read_b64_tr_b16 a[34:35], v249 offset:19440
    v_add_u32 v227, v227, v228
    v_add_u32 v228, v227, v228
    s_waitcnt lgkmcnt(14)
    v_mfma_f32_32x32x16_bf16 v[16:31], a[4:7], v[172:175], v[16:31]
    buffer_load_dwordx4 v252, s[24:27], s71 offen offset:0 sc1 lds
    ds_read_b64_tr_b16 a[36:37], v249 offset:19264
    ds_read_b64_tr_b16 a[38:39], v249 offset:19504
    v_mov_b32 v110, 0x3f80
    s_waitcnt lgkmcnt(14)
    v_mfma_f32_32x32x16_bf16 v[32:47], a[8:11], v[172:175], v[32:47]
    buffer_load_dwordx4 v252, s[24:27], s71 offen offset:1024 sc1 lds
    ds_read_b64_tr_b16 a[40:41], v249 offset:19328
    ds_read_b64_tr_b16 a[42:43], v249 offset:19568
    v_mov_b32 v111, 0
    s_waitcnt lgkmcnt(14)
    v_mfma_f32_32x32x16_bf16 v[48:63], a[12:15], v[172:175], v[48:63]
    ds_read_b64_tr_b16 a[44:45], v249 offset:19376
    ds_read_b64_tr_b16 a[46:47], v249 offset:19616
    s_lshr_b32 s55, s43, 1
    s_mul_i32 s55, s55, 6291456
    s_waitcnt vmcnt(17) lgkmcnt(14)
    v_mfma_f32_32x32x16_bf16 v[0:15], a[16:19], v[176:179], v[0:15]
    ds_read_b64_tr_b16 a[0:1], v249 offset:23040
    ds_read_b64_tr_b16 a[2:3], v249 offset:23280
    s_mul_i32 s56, s41, 393216
    s_add_u32 s55, s55, s56
    s_waitcnt lgkmcnt(14)
    v_mfma_f32_32x32x16_bf16 v[16:31], a[20:23], v[176:179], v[16:31]
    buffer_load_dwordx4 v252, s[24:27], s71 offen offset:2048 sc1 lds
    ds_read_b64_tr_b16 a[4:5], v249 offset:23104
    ds_read_b64_tr_b16 a[6:7], v249 offset:23344
    s_add_u32 s62, s55, 24117248
    s_waitcnt lgkmcnt(14)
    v_mfma_f32_32x32x16_bf16 v[32:47], a[24:27], v[176:179], v[32:47]
    buffer_load_dwordx4 v252, s[24:27], s71 offen offset:3072 sc1 lds
    s_add_u32 m0, m0, 4096
    s_add_u32 s71, s71, 4096
    ds_read_b64_tr_b16 a[8:9], v249 offset:23168
    ds_read_b64_tr_b16 a[10:11], v249 offset:23408
    s_lshl_b32 s55, s40, 2
    s_waitcnt lgkmcnt(14)
    v_mfma_f32_32x32x16_bf16 v[48:63], a[28:31], v[176:179], v[48:63]
    ds_read_b64_tr_b16 a[12:13], v249 offset:23216
    ds_read_b64_tr_b16 a[14:15], v249 offset:23456
    s_add_u32 s55, s55, s42
    s_mul_i32 s55, s55, 3072
    s_waitcnt vmcnt(18) lgkmcnt(14)
    v_mfma_f32_32x32x16_bf16 v[0:15], a[32:35], v[180:183], v[0:15]
    ds_read_b64_tr_b16 a[16:17], v249 offset:26880
    ds_read_b64_tr_b16 a[18:19], v249 offset:27120
    s_add_u32 s60, s62, s55
    s_add_u32 s61, s60, 196608
    s_waitcnt lgkmcnt(14)
    v_mfma_f32_32x32x16_bf16 v[16:31], a[36:39], v[180:183], v[16:31]
    buffer_load_dwordx4 v252, s[24:27], s71 offen offset:0 sc1 lds
    ds_read_b64_tr_b16 a[20:21], v249 offset:26944
    ds_read_b64_tr_b16 a[22:23], v249 offset:27184
    v_mul_u32_u24 v229, 196608, v226
    s_waitcnt lgkmcnt(14)
    v_mfma_f32_32x32x16_bf16 v[32:47], a[40:43], v[180:183], v[32:47]
    buffer_load_dwordx4 v252, s[24:27], s71 offen offset:1024 sc1 lds
    ds_read_b64_tr_b16 a[24:25], v249 offset:27008
    ds_read_b64_tr_b16 a[26:27], v249 offset:27248
    v_lshl_add_u32 v229, v225, 4, v229
    s_waitcnt lgkmcnt(14)
    v_mfma_f32_32x32x16_bf16 v[48:63], a[44:47], v[180:183], v[48:63]
    ds_read_b64_tr_b16 a[28:29], v249 offset:27056
    ds_read_b64_tr_b16 a[30:31], v249 offset:27296
    v_and_b32 v230, 3, v255
    v_bfe_u32 v231, v255, 2, 2
    s_waitcnt vmcnt(19) lgkmcnt(14)
    v_mfma_f32_32x32x16_bf16 v[0:15], a[0:3], v[184:187], v[0:15]
    ds_read_b64_tr_b16 a[32:33], v249 offset:30720
    ds_read_b64_tr_b16 a[34:35], v249 offset:30960
    v_lshl_add_u32 v231, v226, 3, v231
    v_lshl_add_u32 v231, v231, 3, s54
    s_waitcnt lgkmcnt(14)
    v_mfma_f32_32x32x16_bf16 v[16:31], a[4:7], v[184:187], v[16:31]
    buffer_load_dwordx4 v252, s[24:27], s71 offen offset:2048 sc1 lds
    ds_read_b64_tr_b16 a[36:37], v249 offset:30784
    ds_read_b64_tr_b16 a[38:39], v249 offset:31024
    v_cmp_gt_u32 vcc, 16, v225
    s_waitcnt lgkmcnt(14)
    v_mfma_f32_32x32x16_bf16 v[32:47], a[8:11], v[184:187], v[32:47]
    buffer_load_dwordx4 v252, s[24:27], s71 offen offset:3072 sc1 lds
    s_add_u32 m0, m0, 4096
    s_add_u32 s71, s71, 4096
    ds_read_b64_tr_b16 a[40:41], v249 offset:30848
    ds_read_b64_tr_b16 a[42:43], v249 offset:31088
    v_cmp_eq_u32 s[56:57], 0, v230
    s_waitcnt lgkmcnt(14)
    v_mfma_f32_32x32x16_bf16 v[48:63], a[12:15], v[184:187], v[48:63]
    ds_read_b64_tr_b16 a[44:45], v249 offset:30896
    ds_read_b64_tr_b16 a[46:47], v249 offset:31136
    v_add_u32 v234, 4, v230
    v_cndmask_b32_e64 v232, 10, 8, s[56:57]
    s_waitcnt vmcnt(20) lgkmcnt(14)
    v_mfma_f32_32x32x16_bf16 v[0:15], a[16:19], v[188:191], v[0:15]
    ds_read_b64_tr_b16 a[0:1], v249 offset:34560
    ds_read_b64_tr_b16 a[2:3], v249 offset:34800
    v_cndmask_b32_e64 v233, 10, 9, s[56:57]
    v_cndmask_b32 v232, v232, v230, vcc
    s_waitcnt lgkmcnt(14)
    v_mfma_f32_32x32x16_bf16 v[16:31], a[20:23], v[188:191], v[16:31]
    buffer_load_dwordx4 v252, s[24:27], s71 offen offset:0 sc1 lds
    ds_read_b64_tr_b16 a[4:5], v249 offset:34624
    ds_read_b64_tr_b16 a[6:7], v249 offset:34864
    v_cndmask_b32 v233, v233, v234, vcc
    s_waitcnt lgkmcnt(14)
    v_mfma_f32_32x32x16_bf16 v[32:47], a[24:27], v[188:191], v[32:47]
    buffer_load_dwordx4 v252, s[24:27], s71 offen offset:1024 sc1 lds
    ds_read_b64_tr_b16 a[8:9], v249 offset:34688
    ds_read_b64_tr_b16 a[10:11], v249 offset:34928
    v_mul_u32_u24 v232, 288, v232
    s_waitcnt lgkmcnt(14)
    v_mfma_f32_32x32x16_bf16 v[48:63], a[28:31], v[188:191], v[48:63]
    ds_read_b64_tr_b16 a[12:13], v249 offset:34736
    ds_read_b64_tr_b16 a[14:15], v249 offset:34976
    v_mul_u32_u24 v233, 288, v233
    v_add_u32 v232, v232, v231
    s_waitcnt vmcnt(21) lgkmcnt(14)
    v_mfma_f32_32x32x16_bf16 v[0:15], a[32:35], v[192:195], v[0:15]
    ds_read_b64_tr_b16 a[16:17], v249 offset:38400
    ds_read_b64_tr_b16 a[18:19], v249 offset:38640
    v_add_u32 v233, v233, v231
    v_lshl_add_u32 v153, v225, 1, v226
    s_waitcnt lgkmcnt(14)
    v_mfma_f32_32x32x16_bf16 v[16:31], a[36:39], v[192:195], v[16:31]
    buffer_load_dwordx4 v252, s[24:27], s71 offen offset:2048 sc1 lds
    ds_read_b64_tr_b16 a[20:21], v249 offset:38464
    ds_read_b64_tr_b16 a[22:23], v249 offset:38704
    v_lshlrev_b32 v152, 3, v153
    s_waitcnt lgkmcnt(14)
    v_mfma_f32_32x32x16_bf16 v[32:47], a[40:43], v[192:195], v[32:47]
    buffer_load_dwordx4 v252, s[24:27], s71 offen offset:3072 sc1 lds
    s_add_u32 m0, m0, 4096
    s_add_u32 s71, s71, 4096
    ds_read_b64_tr_b16 a[24:25], v249 offset:38528
    ds_read_b64_tr_b16 a[26:27], v249 offset:38768
    v_lshlrev_b32 v153, 4, v153
    s_waitcnt lgkmcnt(14)
    v_mfma_f32_32x32x16_bf16 v[48:63], a[44:47], v[192:195], v[48:63]
    ds_read_b64_tr_b16 a[28:29], v249 offset:38576
    ds_read_b64_tr_b16 a[30:31], v249 offset:38816
    v_cmp_gt_u32 vcc, 24, v225
    v_mov_b32 v234, 0x80000000
    s_waitcnt vmcnt(22) lgkmcnt(14)
    v_mfma_f32_32x32x16_bf16 v[0:15], a[0:3], v[196:199], v[0:15]
    ds_read_b64_tr_b16 a[32:33], v249 offset:42240
    ds_read_b64_tr_b16 a[34:35], v249 offset:42480
    v_cndmask_b32 v153, v234, v153, vcc
    v_mov_b32 v98, 0x3f803f80
    s_waitcnt lgkmcnt(14)
    v_mfma_f32_32x32x16_bf16 v[16:31], a[4:7], v[196:199], v[16:31]
    buffer_load_dwordx4 v252, s[24:27], s71 offen offset:0 sc1 lds
    ds_read_b64_tr_b16 a[36:37], v249 offset:42304
    ds_read_b64_tr_b16 a[38:39], v249 offset:42544
    v_mov_b32 v99, 0x3f80
    s_waitcnt lgkmcnt(14)
    v_mfma_f32_32x32x16_bf16 v[32:47], a[8:11], v[196:199], v[32:47]
    buffer_load_dwordx4 v252, s[24:27], s71 offen offset:1024 sc1 lds
    ds_read_b64_tr_b16 a[40:41], v249 offset:42368
    ds_read_b64_tr_b16 a[42:43], v249 offset:42608
    s_waitcnt lgkmcnt(14)
    v_mfma_f32_32x32x16_bf16 v[48:63], a[12:15], v[196:199], v[48:63]
    ds_read_b64_tr_b16 a[44:45], v249 offset:42416
    ds_read_b64_tr_b16 a[46:47], v249 offset:42656
    s_waitcnt vmcnt(23) lgkmcnt(14)
    v_mfma_f32_32x32x16_bf16 v[0:15], a[16:19], v[200:203], v[0:15]
    ds_read_b64_tr_b16 a[0:1], v249 offset:46080
    ds_read_b64_tr_b16 a[2:3], v249 offset:46320
    s_waitcnt lgkmcnt(14)
    v_mfma_f32_32x32x16_bf16 v[16:31], a[20:23], v[200:203], v[16:31]
    buffer_load_dwordx4 v252, s[24:27], s71 offen offset:2048 sc1 lds
    ds_read_b64_tr_b16 a[4:5], v249 offset:46144
    ds_read_b64_tr_b16 a[6:7], v249 offset:46384
    s_waitcnt lgkmcnt(14)
    v_mfma_f32_32x32x16_bf16 v[32:47], a[24:27], v[200:203], v[32:47]
    buffer_load_dwordx4 v252, s[24:27], s71 offen offset:3072 sc1 lds
    s_add_u32 m0, m0, 4096
    s_add_u32 s71, s71, 4096
    ds_read_b64_tr_b16 a[8:9], v249 offset:46208
    ds_read_b64_tr_b16 a[10:11], v249 offset:46448
    s_waitcnt lgkmcnt(14)
    v_mfma_f32_32x32x16_bf16 v[48:63], a[28:31], v[200:203], v[48:63]
    ds_read_b64_tr_b16 a[12:13], v249 offset:46256
    ds_read_b64_tr_b16 a[14:15], v249 offset:46496
    s_waitcnt vmcnt(24) lgkmcnt(14)
    v_mfma_f32_32x32x16_bf16 v[0:15], a[32:35], v[204:207], v[0:15]
    ds_read_b64_tr_b16 a[16:17], v249 offset:49920
    ds_read_b64_tr_b16 a[18:19], v249 offset:50160
    s_waitcnt lgkmcnt(14)
    v_mfma_f32_32x32x16_bf16 v[16:31], a[36:39], v[204:207], v[16:31]
    buffer_load_dwordx4 v252, s[24:27], s71 offen offset:0 sc1 lds
    ds_read_b64_tr_b16 a[20:21], v249 offset:49984
    ds_read_b64_tr_b16 a[22:23], v249 offset:50224
    s_waitcnt lgkmcnt(14)
    v_mfma_f32_32x32x16_bf16 v[32:47], a[40:43], v[204:207], v[32:47]
    buffer_load_dwordx4 v252, s[24:27], s71 offen offset:1024 sc1 lds
    ds_read_b64_tr_b16 a[24:25], v249 offset:50048
    ds_read_b64_tr_b16 a[26:27], v249 offset:50288
    s_waitcnt lgkmcnt(14)
    v_mfma_f32_32x32x16_bf16 v[48:63], a[44:47], v[204:207], v[48:63]
    ds_read_b64_tr_b16 a[28:29], v249 offset:50096
    ds_read_b64_tr_b16 a[30:31], v249 offset:50336
    s_waitcnt vmcnt(25) lgkmcnt(14)
    v_mfma_f32_32x32x16_bf16 v[0:15], a[0:3], v[208:211], v[0:15]
    ds_read_b64_tr_b16 a[32:33], v249 offset:53760
    ds_read_b64_tr_b16 a[34:35], v249 offset:54000
    s_waitcnt lgkmcnt(14)
    v_mfma_f32_32x32x16_bf16 v[16:31], a[4:7], v[208:211], v[16:31]
    buffer_load_dwordx4 v252, s[24:27], s71 offen offset:2048 sc1 lds
    ds_read_b64_tr_b16 a[36:37], v249 offset:53824
    ds_read_b64_tr_b16 a[38:39], v249 offset:54064
    s_waitcnt lgkmcnt(14)
    v_mfma_f32_32x32x16_bf16 v[32:47], a[8:11], v[208:211], v[32:47]
    buffer_load_dwordx4 v252, s[24:27], s71 offen offset:3072 sc1 lds
    s_add_u32 m0, m0, 4096
    s_add_u32 s71, s71, 4096
    ds_read_b64_tr_b16 a[40:41], v249 offset:53888
    ds_read_b64_tr_b16 a[42:43], v249 offset:54128
    s_waitcnt lgkmcnt(14)
    v_mfma_f32_32x32x16_bf16 v[48:63], a[12:15], v[208:211], v[48:63]
    ds_read_b64_tr_b16 a[44:45], v249 offset:53936
    ds_read_b64_tr_b16 a[46:47], v249 offset:54176
    s_waitcnt vmcnt(26) lgkmcnt(14)
    v_mfma_f32_32x32x16_bf16 v[0:15], a[16:19], v[212:215], v[0:15]
    ds_read_b64_tr_b16 a[0:1], v249 offset:57600
    ds_read_b64_tr_b16 a[2:3], v249 offset:57840
    s_waitcnt lgkmcnt(14)
    v_mfma_f32_32x32x16_bf16 v[16:31], a[20:23], v[212:215], v[16:31]
    buffer_load_dwordx4 v252, s[24:27], s71 offen offset:0 sc1 lds
    ds_read_b64_tr_b16 a[4:5], v249 offset:57664
    ds_read_b64_tr_b16 a[6:7], v249 offset:57904
    s_waitcnt lgkmcnt(14)
    v_mfma_f32_32x32x16_bf16 v[32:47], a[24:27], v[212:215], v[32:47]
    ds_read_b64_tr_b16 a[8:9], v249 offset:57728
    ds_read_b64_tr_b16 a[10:11], v249 offset:57968
    s_waitcnt lgkmcnt(14)
    v_mfma_f32_32x32x16_bf16 v[48:63], a[28:31], v[212:215], v[48:63]
    ds_read_b64_tr_b16 a[12:13], v249 offset:57776
    ds_read_b64_tr_b16 a[14:15], v249 offset:58016
    s_waitcnt vmcnt(26) lgkmcnt(14)
    v_mfma_f32_32x32x16_bf16 v[0:15], a[32:35], v[216:219], v[0:15]
    s_waitcnt lgkmcnt(12)
    v_mfma_f32_32x32x16_bf16 v[16:31], a[36:39], v[216:219], v[16:31]
    s_waitcnt lgkmcnt(10)
    v_mfma_f32_32x32x16_bf16 v[32:47], a[40:43], v[216:219], v[32:47]
    s_waitcnt lgkmcnt(8)
    v_mfma_f32_32x32x16_bf16 v[48:63], a[44:47], v[216:219], v[48:63]
    s_waitcnt vmcnt(25) lgkmcnt(6)
    v_mfma_f32_32x32x16_bf16 v[0:15], a[0:3], v[220:223], v[0:15]
    s_waitcnt lgkmcnt(4)
    v_mfma_f32_32x32x16_bf16 v[16:31], a[4:7], v[220:223], v[16:31]
    s_waitcnt lgkmcnt(2)
    v_mfma_f32_32x32x16_bf16 v[32:47], a[8:11], v[220:223], v[32:47]
    s_waitcnt lgkmcnt(0)
    v_mfma_f32_32x32x16_bf16 v[48:63], a[12:15], v[220:223], v[48:63]
    v_mfma_f32_32x32x8_bf16 v[16:31], a[230:231], v[244:245], v[16:31]
    v_mfma_f32_32x32x8_bf16 v[48:63], a[234:235], v[244:245], v[48:63]
    v_mfma_f32_32x32x8_bf16 v[32:47], a[232:233], v[244:245], v[32:47]
    v_mfma_f32_32x32x8_bf16 v[0:15], a[228:229], v[244:245], v[0:15]
    s_barrier
    s_branch EPI_B
QKV_1:
    s_mul_i32 s54, s42, 3840
    v_add_u32 v236, s54, v251
    v_add_u32 v237, s54, v249
    v_add_u32 v239, s54, v250
    s_lshl_b32 s54, s42, 9
    s_add_u32 s54, s54, 65536
    v_add_u32 v238, s54, v252
    s_waitcnt vmcnt(15)
    s_barrier
    buffer_load_dwordx2 v[224:225], v232, s[24:27], s63 offen offset:0 sc1
    buffer_load_dwordx2 v[226:227], v232, s[24:27], s63 offen offset:256 sc1
    buffer_load_dwordx2 v[228:229], v232, s[24:27], s63 offen offset:512 sc1
    buffer_load_dwordx2 v[230:231], v232, s[24:27], s63 offen offset:768 sc1
    buffer_load_dwordx4 v[64:67], v253, s[24:27], s60 offen offset:0 sc1
    buffer_load_dwordx4 v[68:71], v253, s[24:27], s60 offen offset:512 sc1
    buffer_load_dwordx4 v[72:75], v253, s[24:27], s60 offen offset:1024 sc1
    buffer_load_dwordx4 v[76:79], v253, s[24:27], s60 offen offset:1536 sc1
    buffer_load_dwordx4 v[80:83], v253, s[24:27], s60 offen offset:2048 sc1
    s_add_u32 s60, s60, 2560
    buffer_load_dwordx4 v[84:87], v253, s[24:27], s60 offen offset:0 sc1
    buffer_load_dwordx4 v[88:91], v253, s[24:27], s60 offen offset:512 sc1
    buffer_load_dwordx4 v[92:95], v253, s[24:27], s60 offen offset:1024 sc1
    ds_read_b64_tr_b16 a[64:65], v236 offset:0
    ds_read_b64_tr_b16 a[66:67], v236 offset:240
    ds_read_b64_tr_b16 a[68:69], v236 offset:64
    ds_read_b64_tr_b16 a[70:71], v236 offset:304
    ds_read_b64_tr_b16 a[72:73], v236 offset:128
    ds_read_b64_tr_b16 a[74:75], v236 offset:368
    ds_read_b64_tr_b16 a[76:77], v236 offset:176
    ds_read_b64_tr_b16 a[78:79], v236 offset:416
    ds_read_b64_tr_b16 a[80:81], v236 offset:15360
    ds_read_b64_tr_b16 a[82:83], v236 offset:15600
    ds_read_b64_tr_b16 a[84:85], v236 offset:15424
    ds_read_b64_tr_b16 a[86:87], v236 offset:15664
    ds_read_b64_tr_b16 a[88:89], v236 offset:15488
    ds_read_b64_tr_b16 a[90:91], v236 offset:15728
    s_waitcnt lgkmcnt(12)
    v_mfma_f32_16x16x32_bf16 a[48:51], a[208:211], a[64:67], 0
    ds_read_b64_tr_b16 a[92:93], v236 offset:15536
    ds_read_b64_tr_b16 a[94:95], v236 offset:15776
    s_waitcnt lgkmcnt(12)
    v_mfma_f32_16x16x32_bf16 a[52:55], a[208:211], a[68:71], 0
    ds_read_b64_tr_b16 a[64:65], v236 offset:30720
    ds_read_b64_tr_b16 a[66:67], v236 offset:30960
    s_waitcnt lgkmcnt(12)
    v_mfma_f32_16x16x32_bf16 a[56:59], a[208:211], a[72:75], 0
    ds_read_b64_tr_b16 a[68:69], v236 offset:30784
    ds_read_b64_tr_b16 a[70:71], v236 offset:31024
    s_waitcnt lgkmcnt(12)
    v_mfma_f32_16x16x32_bf16 a[60:63], a[208:211], a[76:79], 0
    ds_read_b64_tr_b16 a[72:73], v236 offset:30848
    ds_read_b64_tr_b16 a[74:75], v236 offset:31088
    s_waitcnt lgkmcnt(12)
    v_mfma_f32_16x16x32_bf16 a[48:51], a[208:211], a[80:83], a[48:51]
    ds_read_b64_tr_b16 a[76:77], v236 offset:30896
    ds_read_b64_tr_b16 a[78:79], v236 offset:31136
    s_waitcnt lgkmcnt(12)
    v_mfma_f32_16x16x32_bf16 a[52:55], a[208:211], a[84:87], a[52:55]
    ds_read_b64_tr_b16 a[80:81], v237 offset:0
    ds_read_b64_tr_b16 a[82:83], v237 offset:240
    s_waitcnt lgkmcnt(12)
    v_mfma_f32_16x16x32_bf16 a[56:59], a[208:211], a[88:91], a[56:59]
    ds_read_b64_tr_b16 a[84:85], v237 offset:64
    ds_read_b64_tr_b16 a[86:87], v237 offset:304
    s_waitcnt lgkmcnt(12)
    v_mfma_f32_16x16x32_bf16 a[60:63], a[208:211], a[92:95], a[60:63]
    ds_read_b64_tr_b16 a[88:89], v237 offset:128
    ds_read_b64_tr_b16 a[90:91], v237 offset:368
    s_waitcnt lgkmcnt(12)
    v_mfma_f32_16x16x32_bf16 a[48:51], a[208:211], a[64:67], a[48:51]
    ds_read_b64_tr_b16 a[92:93], v237 offset:176
    ds_read_b64_tr_b16 a[94:95], v237 offset:416
    s_waitcnt lgkmcnt(12)
    v_mfma_f32_16x16x32_bf16 a[52:55], a[208:211], a[68:71], a[52:55]
    ds_read_b64_tr_b16 a[64:65], v237 offset:15360
    ds_read_b64_tr_b16 a[66:67], v237 offset:15600
    s_waitcnt lgkmcnt(12)
    v_mfma_f32_16x16x32_bf16 a[56:59], a[208:211], a[72:75], a[56:59]
    ds_read_b64_tr_b16 a[68:69], v237 offset:15424
    ds_read_b64_tr_b16 a[70:71], v237 offset:15664
    s_waitcnt lgkmcnt(12)
    v_mfma_f32_16x16x32_bf16 a[60:63], a[208:211], a[76:79], a[60:63]
    ds_read_b64_tr_b16 a[72:73], v237 offset:15488
    ds_read_b64_tr_b16 a[74:75], v237 offset:15728
    s_waitcnt lgkmcnt(12)
    v_mfma_f32_16x16x32_bf16 a[48:51], a[208:211], a[80:83], a[48:51]
    ds_read_b64_tr_b16 a[76:77], v237 offset:15536
    ds_read_b64_tr_b16 a[78:79], v237 offset:15776
    s_waitcnt lgkmcnt(12)
    v_mfma_f32_16x16x32_bf16 a[52:55], a[208:211], a[84:87], a[52:55]
    ds_read_b64_tr_b16 a[80:81], v237 offset:30720
    ds_read_b64_tr_b16 a[82:83], v237 offset:30960
    s_waitcnt lgkmcnt(12)
    v_mfma_f32_16x16x32_bf16 a[56:59], a[208:211], a[88:91], a[56:59]
    ds_read_b64_tr_b16 a[84:85], v237 offset:30784
    ds_read_b64_tr_b16 a[86:87], v237 offset:31024
    s_waitcnt lgkmcnt(12)
    v_mfma_f32_16x16x32_bf16 a[60:63], a[208:211], a[92:95], a[60:63]
    ds_read_b64_tr_b16 a[88:89], v237 offset:30848
    ds_read_b64_tr_b16 a[90:91], v237 offset:31088
    s_waitcnt lgkmcnt(12)
    v_mfma_f32_16x16x32_bf16 a[48:51], a[208:211], a[64:67], a[48:51]
    ds_read_b64_tr_b16 a[92:93], v237 offset:30896
    ds_read_b64_tr_b16 a[94:95], v237 offset:31136
    s_waitcnt lgkmcnt(12)
    v_mfma_f32_16x16x32_bf16 a[52:55], a[208:211], a[68:71], a[52:55]
    ds_read_b64_tr_b16 a[64:65], v237 offset:46080
    ds_read_b64_tr_b16 a[66:67], v237 offset:46320
    s_waitcnt lgkmcnt(12)
    v_mfma_f32_16x16x32_bf16 a[56:59], a[208:211], a[72:75], a[56:59]
    ds_read_b64_tr_b16 a[68:69], v237 offset:46144
    ds_read_b64_tr_b16 a[70:71], v237 offset:46384
    s_waitcnt lgkmcnt(12)
    v_mfma_f32_16x16x32_bf16 a[60:63], a[208:211], a[76:79], a[60:63]
    ds_read_b64_tr_b16 a[72:73], v237 offset:46208
    ds_read_b64_tr_b16 a[74:75], v237 offset:46448
    s_waitcnt lgkmcnt(12)
    v_mfma_f32_16x16x32_bf16 a[48:51], a[208:211], a[80:83], a[48:51]
    ds_read_b64_tr_b16 a[76:77], v237 offset:46256
    ds_read_b64_tr_b16 a[78:79], v237 offset:46496
    s_waitcnt lgkmcnt(12)
    v_mfma_f32_16x16x32_bf16 a[52:55], a[208:211], a[84:87], a[52:55]
    s_waitcnt lgkmcnt(10)
    v_mfma_f32_16x16x32_bf16 a[56:59], a[208:211], a[88:91], a[56:59]
    s_waitcnt lgkmcnt(8)
    v_mfma_f32_16x16x32_bf16 a[60:63], a[208:211], a[92:95], a[60:63]
    s_waitcnt lgkmcnt(6)
    v_mfma_f32_16x16x32_bf16 a[48:51], a[208:211], a[64:67], a[48:51]
    s_waitcnt lgkmcnt(4)
    v_mfma_f32_16x16x32_bf16 a[52:55], a[208:211], a[68:71], a[52:55]
    s_waitcnt lgkmcnt(2)
    v_mfma_f32_16x16x32_bf16 a[56:59], a[208:211], a[72:75], a[56:59]
    s_waitcnt lgkmcnt(0)
    v_mfma_f32_16x16x32_bf16 a[60:63], a[208:211], a[76:79], a[60:63]
    ds_read_b64_tr_b16 a[0:1], v251 offset:0
    ds_read_b64_tr_b16 a[2:3], v251 offset:240
    ds_read_b64_tr_b16 a[4:5], v251 offset:64
    ds_read_b64_tr_b16 a[6:7], v251 offset:304
    ds_read_b64_tr_b16 a[8:9], v251 offset:128
    ds_read_b64_tr_b16 a[10:11], v251 offset:368
    ds_read_b64_tr_b16 a[12:13], v251 offset:176
    ds_read_b64_tr_b16 a[14:15], v251 offset:416
    ds_read_b64_tr_b16 a[16:17], v251 offset:3840
    ds_read_b64_tr_b16 a[18:19], v251 offset:4080
    ds_read_b64_tr_b16 a[20:21], v251 offset:3904
    ds_read_b64_tr_b16 a[22:23], v251 offset:4144
    ds_read_b64_tr_b16 a[24:25], v251 offset:3968
    ds_read_b64_tr_b16 a[26:27], v251 offset:4208
    ds_read_b64_tr_b16 a[28:29], v251 offset:4016
    ds_read_b64_tr_b16 a[30:31], v251 offset:4256
    s_waitcnt vmcnt(7) lgkmcnt(14)
    v_mfma_f32_32x32x16_bf16 v[0:15], a[0:3], v[64:67], 0
    buffer_load_dwordx4 v[96:99], v253, s[24:27], s60 offen offset:1536 sc1
    ds_read_b64_tr_b16 a[32:33], v251 offset:7680
    ds_read_b64_tr_b16 a[34:35], v251 offset:7920
    s_waitcnt lgkmcnt(14)
    v_mfma_f32_32x32x16_bf16 v[16:31], a[4:7], v[64:67], 0
    ds_read_b64_tr_b16 a[36:37], v251 offset:7744
    ds_read_b64_tr_b16 a[38:39], v251 offset:7984
    s_waitcnt lgkmcnt(14)
    v_mfma_f32_32x32x16_bf16 v[32:47], a[8:11], v[64:67], 0
    buffer_load_dwordx4 v[100:103], v253, s[24:27], s60 offen offset:2048 sc1
    ds_read_b64_tr_b16 a[40:41], v251 offset:7808
    ds_read_b64_tr_b16 a[42:43], v251 offset:8048
    s_waitcnt lgkmcnt(14)
    v_mfma_f32_32x32x16_bf16 v[48:63], a[12:15], v[64:67], 0
    ds_read_b64_tr_b16 a[44:45], v251 offset:7856
    ds_read_b64_tr_b16 a[46:47], v251 offset:8096
    s_waitcnt vmcnt(8) lgkmcnt(14)
    v_mfma_f32_32x32x16_bf16 v[0:15], a[16:19], v[68:71], v[0:15]
    s_add_u32 s60, s60, 2560
    buffer_load_dwordx4 v[104:107], v253, s[24:27], s60 offen offset:0 sc1
    ds_read_b64_tr_b16 a[0:1], v251 offset:11520
    ds_read_b64_tr_b16 a[2:3], v251 offset:11760
    s_waitcnt lgkmcnt(14)
    v_mfma_f32_32x32x16_bf16 v[16:31], a[20:23], v[68:71], v[16:31]
    ds_read_b64_tr_b16 a[4:5], v251 offset:11584
    ds_read_b64_tr_b16 a[6:7], v251 offset:11824
    s_waitcnt lgkmcnt(14)
    v_mfma_f32_32x32x16_bf16 v[32:47], a[24:27], v[68:71], v[32:47]
    buffer_load_dwordx4 v[108:111], v253, s[24:27], s60 offen offset:512 sc1
    ds_read_b64_tr_b16 a[8:9], v251 offset:11648
    ds_read_b64_tr_b16 a[10:11], v251 offset:11888
    s_waitcnt lgkmcnt(14)
    v_mfma_f32_32x32x16_bf16 v[48:63], a[28:31], v[68:71], v[48:63]
    ds_read_b64_tr_b16 a[12:13], v251 offset:11696
    ds_read_b64_tr_b16 a[14:15], v251 offset:11936
    s_waitcnt vmcnt(9) lgkmcnt(14)
    v_mfma_f32_32x32x16_bf16 v[0:15], a[32:35], v[72:75], v[0:15]
    buffer_load_dwordx4 v[112:115], v253, s[24:27], s60 offen offset:1024 sc1
    ds_read_b64_tr_b16 a[16:17], v251 offset:15360
    ds_read_b64_tr_b16 a[18:19], v251 offset:15600
    s_waitcnt lgkmcnt(14)
    v_mfma_f32_32x32x16_bf16 v[16:31], a[36:39], v[72:75], v[16:31]
    ds_read_b64_tr_b16 a[20:21], v251 offset:15424
    ds_read_b64_tr_b16 a[22:23], v251 offset:15664
    v_pk_add_f32 v[224:225], v[224:225], v[226:227]
    s_waitcnt lgkmcnt(14)
    v_mfma_f32_32x32x16_bf16 v[32:47], a[40:43], v[72:75], v[32:47]
    buffer_load_dwordx4 v[116:119], v253, s[24:27], s60 offen offset:1536 sc1
    ds_read_b64_tr_b16 a[24:25], v251 offset:15488
    ds_read_b64_tr_b16 a[26:27], v251 offset:15728
    v_pk_add_f32 v[228:229], v[228:229], v[230:231]
    s_waitcnt lgkmcnt(14)
    v_mfma_f32_32x32x16_bf16 v[48:63], a[44:47], v[72:75], v[48:63]
    ds_read_b64_tr_b16 a[28:29], v251 offset:15536
    ds_read_b64_tr_b16 a[30:31], v251 offset:15776
    s_waitcnt vmcnt(10) lgkmcnt(14)
    v_mfma_f32_32x32x16_bf16 v[0:15], a[0:3], v[76:79], v[0:15]
    buffer_load_dwordx4 v[120:123], v253, s[24:27], s60 offen offset:2048 sc1
    ds_read_b64_tr_b16 a[32:33], v251 offset:19200
    ds_read_b64_tr_b16 a[34:35], v251 offset:19440
    s_waitcnt lgkmcnt(14)
    v_mfma_f32_32x32x16_bf16 v[16:31], a[4:7], v[76:79], v[16:31]
    ds_read_b64_tr_b16 a[36:37], v251 offset:19264
    ds_read_b64_tr_b16 a[38:39], v251 offset:19504
    v_pk_add_f32 v[240:241], v[224:225], v[228:229]
    s_waitcnt lgkmcnt(14)
    v_mfma_f32_32x32x16_bf16 v[32:47], a[8:11], v[76:79], v[32:47]
    s_add_u32 s60, s60, 2560
    buffer_load_dwordx4 v[124:127], v253, s[24:27], s60 offen offset:0 sc1
    ds_read_b64_tr_b16 a[40:41], v251 offset:19328
    ds_read_b64_tr_b16 a[42:43], v251 offset:19568
    v_mov_b32 v224, v240
    s_waitcnt lgkmcnt(14)
    v_mfma_f32_32x32x16_bf16 v[48:63], a[12:15], v[76:79], v[48:63]
    ds_read_b64_tr_b16 a[44:45], v251 offset:19376
    ds_read_b64_tr_b16 a[46:47], v251 offset:19616
    s_waitcnt vmcnt(11) lgkmcnt(14)
    v_mfma_f32_32x32x16_bf16 v[0:15], a[16:19], v[80:83], v[0:15]
    buffer_load_dwordx4 v[128:131], v253, s[24:27], s60 offen offset:512 sc1
    ds_read_b64_tr_b16 a[0:1], v251 offset:23040
    ds_read_b64_tr_b16 a[2:3], v251 offset:23280
    s_waitcnt lgkmcnt(14)
    v_mfma_f32_32x32x16_bf16 v[16:31], a[20:23], v[80:83], v[16:31]
    ds_read_b64_tr_b16 a[4:5], v251 offset:23104
    ds_read_b64_tr_b16 a[6:7], v251 offset:23344
    v_mov_b32 v225, v241
    s_waitcnt lgkmcnt(14)
    v_mfma_f32_32x32x16_bf16 v[32:47], a[24:27], v[80:83], v[32:47]
    buffer_load_dwordx4 v[132:135], v253, s[24:27], s60 offen offset:1024 sc1
    ds_read_b64_tr_b16 a[8:9], v251 offset:23168
    ds_read_b64_tr_b16 a[10:11], v251 offset:23408
    v_permlane32_swap_b32 v240, v224
    s_waitcnt lgkmcnt(14)
    v_mfma_f32_32x32x16_bf16 v[48:63], a[28:31], v[80:83], v[48:63]
    ds_read_b64_tr_b16 a[12:13], v251 offset:23216
    ds_read_b64_tr_b16 a[14:15], v251 offset:23456
    s_waitcnt vmcnt(12) lgkmcnt(14)
    v_mfma_f32_32x32x16_bf16 v[0:15], a[32:35], v[84:87], v[0:15]
    buffer_load_dwordx4 v[136:139], v253, s[24:27], s60 offen offset:1536 sc1
    ds_read_b64_tr_b16 a[16:17], v251 offset:26880
    ds_read_b64_tr_b16 a[18:19], v251 offset:27120
    s_waitcnt lgkmcnt(14)
    v_mfma_f32_32x32x16_bf16 v[16:31], a[36:39], v[84:87], v[16:31]
    ds_read_b64_tr_b16 a[20:21], v251 offset:26944
    ds_read_b64_tr_b16 a[22:23], v251 offset:27184
    v_permlane32_swap_b32 v241, v225
    s_waitcnt lgkmcnt(14)
    v_mfma_f32_32x32x16_bf16 v[32:47], a[40:43], v[84:87], v[32:47]
    buffer_load_dwordx4 v[140:143], v253, s[24:27], s60 offen offset:2048 sc1
    ds_read_b64_tr_b16 a[24:25], v251 offset:27008
    ds_read_b64_tr_b16 a[26:27], v251 offset:27248
    v_add_f32 v240, v240, v224
    s_waitcnt lgkmcnt(14)
    v_mfma_f32_32x32x16_bf16 v[48:63], a[44:47], v[84:87], v[48:63]
    ds_read_b64_tr_b16 a[28:29], v251 offset:27056
    ds_read_b64_tr_b16 a[30:31], v251 offset:27296
    s_waitcnt vmcnt(13) lgkmcnt(14)
    v_mfma_f32_32x32x16_bf16 v[0:15], a[0:3], v[88:91], v[0:15]
    s_add_u32 s60, s60, 2560
    buffer_load_dwordx4 v[144:147], v253, s[24:27], s60 offen offset:0 sc1
    ds_read_b64_tr_b16 a[32:33], v251 offset:30720
    ds_read_b64_tr_b16 a[34:35], v251 offset:30960
    s_waitcnt lgkmcnt(14)
    v_mfma_f32_32x32x16_bf16 v[16:31], a[4:7], v[88:91], v[16:31]
    ds_read_b64_tr_b16 a[36:37], v251 offset:30784
    ds_read_b64_tr_b16 a[38:39], v251 offset:31024
    v_add_f32 v241, v241, v225
    s_waitcnt lgkmcnt(14)
    v_mfma_f32_32x32x16_bf16 v[32:47], a[8:11], v[88:91], v[32:47]
    buffer_load_dwordx4 v[148:151], v253, s[24:27], s60 offen offset:512 sc1
    ds_read_b64_tr_b16 a[40:41], v251 offset:30848
    ds_read_b64_tr_b16 a[42:43], v251 offset:31088
    v_mul_f32 v240, 0x3acccccd, v240
    s_waitcnt lgkmcnt(14)
    v_mfma_f32_32x32x16_bf16 v[48:63], a[12:15], v[88:91], v[48:63]
    ds_read_b64_tr_b16 a[44:45], v251 offset:30896
    ds_read_b64_tr_b16 a[46:47], v251 offset:31136
    s_waitcnt vmcnt(14) lgkmcnt(14)
    v_mfma_f32_32x32x16_bf16 v[0:15], a[16:19], v[92:95], v[0:15]
    buffer_load_dwordx4 v[152:155], v253, s[24:27], s60 offen offset:1024 sc1
    ds_read_b64_tr_b16 a[0:1], v251 offset:34560
    ds_read_b64_tr_b16 a[2:3], v251 offset:34800
    s_waitcnt lgkmcnt(14)
    v_mfma_f32_32x32x16_bf16 v[16:31], a[20:23], v[92:95], v[16:31]
    ds_read_b64_tr_b16 a[4:5], v251 offset:34624
    ds_read_b64_tr_b16 a[6:7], v251 offset:34864
    v_mul_f32 v241, 0x3acccccd, v241
    s_waitcnt lgkmcnt(14)
    v_mfma_f32_32x32x16_bf16 v[32:47], a[24:27], v[92:95], v[32:47]
    ds_read_b64_tr_b16 a[8:9], v251 offset:34688
    ds_read_b64_tr_b16 a[10:11], v251 offset:34928
    v_fma_f32 v241, -v240, v240, v241
    s_waitcnt lgkmcnt(14)
    v_mfma_f32_32x32x16_bf16 v[48:63], a[28:31], v[92:95], v[48:63]
    ds_read_b64_tr_b16 a[12:13], v251 offset:34736
    ds_read_b64_tr_b16 a[14:15], v251 offset:34976
    s_waitcnt vmcnt(14) lgkmcnt(14)
    v_mfma_f32_32x32x16_bf16 v[0:15], a[32:35], v[96:99], v[0:15]
    buffer_load_dwordx4 v[156:159], v253, s[24:27], s60 offen offset:1536 sc1
    ds_read_b64_tr_b16 a[16:17], v251 offset:38400
    ds_read_b64_tr_b16 a[18:19], v251 offset:38640
    s_waitcnt lgkmcnt(14)
    v_mfma_f32_32x32x16_bf16 v[16:31], a[36:39], v[96:99], v[16:31]
    ds_read_b64_tr_b16 a[20:21], v251 offset:38464
    ds_read_b64_tr_b16 a[22:23], v251 offset:38704
    v_max_f32 v241, 0, v241
    s_waitcnt lgkmcnt(14)
    v_mfma_f32_32x32x16_bf16 v[32:47], a[40:43], v[96:99], v[32:47]
    ds_read_b64_tr_b16 a[24:25], v251 offset:38528
    ds_read_b64_tr_b16 a[26:27], v251 offset:38768
    v_add_f32 v241, 0x3727c5ac, v241
    s_waitcnt lgkmcnt(14)
    v_mfma_f32_32x32x16_bf16 v[48:63], a[44:47], v[96:99], v[48:63]
    ds_read_b64_tr_b16 a[28:29], v251 offset:38576
    ds_read_b64_tr_b16 a[30:31], v251 offset:38816
    s_waitcnt vmcnt(14) lgkmcnt(14)
    v_mfma_f32_32x32x16_bf16 v[0:15], a[0:3], v[100:103], v[0:15]
    buffer_load_dwordx4 v[160:163], v253, s[24:27], s60 offen offset:2048 sc1
    ds_read_b64_tr_b16 a[32:33], v251 offset:42240
    ds_read_b64_tr_b16 a[34:35], v251 offset:42480
    s_waitcnt lgkmcnt(14)
    v_mfma_f32_32x32x16_bf16 v[16:31], a[4:7], v[100:103], v[16:31]
    ds_read_b64_tr_b16 a[36:37], v251 offset:42304
    ds_read_b64_tr_b16 a[38:39], v251 offset:42544
    v_rsq_f32 v242, v241
    s_waitcnt lgkmcnt(14)
    v_mfma_f32_32x32x16_bf16 v[32:47], a[8:11], v[100:103], v[32:47]
    ds_read_b64_tr_b16 a[40:41], v251 offset:42368
    ds_read_b64_tr_b16 a[42:43], v251 offset:42608
    v_and_b32 v224, 0xffff0000, v240
    s_waitcnt lgkmcnt(14)
    v_mfma_f32_32x32x16_bf16 v[48:63], a[12:15], v[100:103], v[48:63]
    ds_read_b64_tr_b16 a[44:45], v251 offset:42416
    ds_read_b64_tr_b16 a[46:47], v251 offset:42656
    s_barrier
    s_waitcnt vmcnt(14) lgkmcnt(14)
    v_mfma_f32_32x32x16_bf16 v[0:15], a[16:19], v[104:107], v[0:15]
    s_add_u32 s60, s60, 2560
    buffer_load_dwordx4 v[164:167], v253, s[24:27], s60 offen offset:0 sc1
    ds_read_b64_tr_b16 a[0:1], v251 offset:46080
    ds_read_b64_tr_b16 a[2:3], v251 offset:46320
    s_waitcnt lgkmcnt(14)
    v_mfma_f32_32x32x16_bf16 v[16:31], a[20:23], v[104:107], v[16:31]
    ds_read_b64_tr_b16 a[4:5], v251 offset:46144
    ds_read_b64_tr_b16 a[6:7], v251 offset:46384
    ds_read_b64_tr_b16 a[80:81], v236 offset:46080
    ds_read_b64_tr_b16 a[82:83], v236 offset:46320
    v_sub_f32 v225, v224, v240
    s_waitcnt lgkmcnt(14)
    v_mfma_f32_32x32x16_bf16 v[32:47], a[24:27], v[104:107], v[32:47]
    ds_read_b64_tr_b16 a[8:9], v251 offset:46208
    ds_read_b64_tr_b16 a[10:11], v251 offset:46448
    v_cvt_pk_bf16_f32 v244, -v224, -v224
    s_waitcnt lgkmcnt(14)
    v_mfma_f32_32x32x16_bf16 v[48:63], a[28:31], v[104:107], v[48:63]
    ds_read_b64_tr_b16 a[12:13], v251 offset:46256
    ds_read_b64_tr_b16 a[14:15], v251 offset:46496
    s_waitcnt vmcnt(14) lgkmcnt(14)
    v_mfma_f32_32x32x16_bf16 v[0:15], a[32:35], v[108:111], v[0:15]
    buffer_load_dwordx4 v[168:171], v253, s[24:27], s60 offen offset:512 sc1
    ds_read_b64_tr_b16 a[16:17], v251 offset:49920
    ds_read_b64_tr_b16 a[18:19], v251 offset:50160
    s_waitcnt lgkmcnt(14)
    v_mfma_f32_32x32x16_bf16 v[16:31], a[36:39], v[108:111], v[16:31]
    ds_read_b64_tr_b16 a[20:21], v251 offset:49984
    ds_read_b64_tr_b16 a[22:23], v251 offset:50224
    ds_read_b64_tr_b16 a[84:85], v236 offset:46144
    ds_read_b64_tr_b16 a[86:87], v236 offset:46384
    v_cvt_pk_bf16_f32 v245, v225, 0
    s_waitcnt lgkmcnt(14)
    v_mfma_f32_32x32x16_bf16 v[32:47], a[40:43], v[108:111], v[32:47]
    ds_read_b64_tr_b16 a[24:25], v251 offset:50048
    ds_read_b64_tr_b16 a[26:27], v251 offset:50288
    v_cndmask_b32_e64 v244, v244, 0, s[52:53]
    s_waitcnt lgkmcnt(14)
    v_mfma_f32_32x32x16_bf16 v[48:63], a[44:47], v[108:111], v[48:63]
    ds_read_b64_tr_b16 a[28:29], v251 offset:50096
    ds_read_b64_tr_b16 a[30:31], v251 offset:50336
    s_waitcnt vmcnt(14) lgkmcnt(14)
    v_mfma_f32_32x32x16_bf16 v[0:15], a[0:3], v[112:115], v[0:15]
    buffer_load_dwordx4 v[172:175], v253, s[24:27], s60 offen offset:1024 sc1
    ds_read_b64_tr_b16 a[32:33], v251 offset:53760
    ds_read_b64_tr_b16 a[34:35], v251 offset:54000
    s_waitcnt lgkmcnt(14)
    v_mfma_f32_32x32x16_bf16 v[16:31], a[4:7], v[112:115], v[16:31]
    ds_read_b64_tr_b16 a[36:37], v251 offset:53824
    ds_read_b64_tr_b16 a[38:39], v251 offset:54064
    v_mfma_f32_16x16x32_bf16 a[48:51], a[208:211], a[80:83], a[48:51]
    ds_read_b64_tr_b16 a[88:89], v236 offset:46208
    ds_read_b64_tr_b16 a[90:91], v236 offset:46448
    v_cndmask_b32_e64 v245, v245, 0, s[52:53]
    s_waitcnt lgkmcnt(14)
    v_mfma_f32_32x32x16_bf16 v[32:47], a[8:11], v[112:115], v[32:47]
    ds_read_b64_tr_b16 a[40:41], v251 offset:53888
    ds_read_b64_tr_b16 a[42:43], v251 offset:54128
    s_waitcnt lgkmcnt(14)
    v_mfma_f32_32x32x16_bf16 v[48:63], a[12:15], v[112:115], v[48:63]
    ds_read_b64_tr_b16 a[44:45], v251 offset:53936
    ds_read_b64_tr_b16 a[46:47], v251 offset:54176
    s_waitcnt vmcnt(14) lgkmcnt(14)
    v_mfma_f32_32x32x16_bf16 v[0:15], a[16:19], v[116:119], v[0:15]
    buffer_load_dwordx4 v[176:179], v253, s[24:27], s60 offen offset:1536 sc1
    ds_read_b64_tr_b16 a[0:1], v251 offset:57600
    ds_read_b64_tr_b16 a[2:3], v251 offset:57840
    s_waitcnt lgkmcnt(14)
    v_mfma_f32_32x32x16_bf16 v[16:31], a[20:23], v[116:119], v[16:31]
    ds_read_b64_tr_b16 a[4:5], v251 offset:57664
    ds_read_b64_tr_b16 a[6:7], v251 offset:57904
    v_mfma_f32_16x16x32_bf16 a[52:55], a[208:211], a[84:87], a[52:55]
    ds_read_b64_tr_b16 a[92:93], v236 offset:46256
    ds_read_b64_tr_b16 a[94:95], v236 offset:46496
    s_waitcnt lgkmcnt(14)
    v_mfma_f32_32x32x16_bf16 v[32:47], a[24:27], v[116:119], v[32:47]
    ds_read_b64_tr_b16 a[8:9], v251 offset:57728
    ds_read_b64_tr_b16 a[10:11], v251 offset:57968
    s_waitcnt lgkmcnt(14)
    v_mfma_f32_32x32x16_bf16 v[48:63], a[28:31], v[116:119], v[48:63]
    ds_read_b64_tr_b16 a[12:13], v251 offset:57776
    ds_read_b64_tr_b16 a[14:15], v251 offset:58016
    s_waitcnt vmcnt(14) lgkmcnt(14)
    v_mfma_f32_32x32x16_bf16 v[0:15], a[32:35], v[120:123], v[0:15]
    buffer_load_dwordx4 v[180:183], v253, s[24:27], s60 offen offset:2048 sc1
    ds_read_b64_tr_b16 a[16:17], v250 offset:0
    ds_read_b64_tr_b16 a[18:19], v250 offset:240
    s_waitcnt lgkmcnt(14)
    v_mfma_f32_32x32x16_bf16 v[16:31], a[36:39], v[120:123], v[16:31]
    ds_read_b64_tr_b16 a[20:21], v250 offset:64
    ds_read_b64_tr_b16 a[22:23], v250 offset:304
    v_mfma_f32_16x16x32_bf16 a[56:59], a[208:211], a[88:91], a[56:59]
    ds_read_b64_tr_b16 a[64:65], v239 offset:0
    ds_read_b64_tr_b16 a[66:67], v239 offset:240
    s_waitcnt lgkmcnt(14)
    v_mfma_f32_32x32x16_bf16 v[32:47], a[40:43], v[120:123], v[32:47]
    ds_read_b64_tr_b16 a[24:25], v250 offset:128
    ds_read_b64_tr_b16 a[26:27], v250 offset:368
    s_waitcnt lgkmcnt(14)
    v_mfma_f32_32x32x16_bf16 v[48:63], a[44:47], v[120:123], v[48:63]
    ds_read_b64_tr_b16 a[28:29], v250 offset:176
    ds_read_b64_tr_b16 a[30:31], v250 offset:416
    s_waitcnt vmcnt(14) lgkmcnt(14)
    v_mfma_f32_32x32x16_bf16 v[0:15], a[0:3], v[124:127], v[0:15]
    s_add_u32 s60, s60, 2560
    buffer_load_dwordx4 v[184:187], v253, s[24:27], s60 offen offset:0 sc1
    ds_read_b64_tr_b16 a[32:33], v250 offset:3840
    ds_read_b64_tr_b16 a[34:35], v250 offset:4080
    s_waitcnt lgkmcnt(14)
    v_mfma_f32_32x32x16_bf16 v[16:31], a[4:7], v[124:127], v[16:31]
    ds_read_b64_tr_b16 a[36:37], v250 offset:3904
    ds_read_b64_tr_b16 a[38:39], v250 offset:4144
    v_mfma_f32_16x16x32_bf16 a[60:63], a[208:211], a[92:95], a[60:63]
    ds_read_b64_tr_b16 a[68:69], v239 offset:64
    ds_read_b64_tr_b16 a[70:71], v239 offset:304
    s_waitcnt lgkmcnt(14)
    v_mfma_f32_32x32x16_bf16 v[32:47], a[8:11], v[124:127], v[32:47]
    ds_read_b64_tr_b16 a[40:41], v250 offset:3968
    ds_read_b64_tr_b16 a[42:43], v250 offset:4208
    s_waitcnt lgkmcnt(14)
    v_mfma_f32_32x32x16_bf16 v[48:63], a[12:15], v[124:127], v[48:63]
    ds_read_b64_tr_b16 a[44:45], v250 offset:4016
    ds_read_b64_tr_b16 a[46:47], v250 offset:4256
    s_waitcnt vmcnt(14) lgkmcnt(14)
    v_mfma_f32_32x32x16_bf16 v[0:15], a[16:19], v[128:131], v[0:15]
    buffer_load_dwordx4 v[188:191], v253, s[24:27], s60 offen offset:512 sc1
    ds_read_b64_tr_b16 a[0:1], v250 offset:7680
    ds_read_b64_tr_b16 a[2:3], v250 offset:7920
    s_waitcnt lgkmcnt(14)
    v_mfma_f32_32x32x16_bf16 v[16:31], a[20:23], v[128:131], v[16:31]
    ds_read_b64_tr_b16 a[4:5], v250 offset:7744
    ds_read_b64_tr_b16 a[6:7], v250 offset:7984
    v_mfma_f32_16x16x32_bf16 a[48:51], a[208:211], a[64:67], a[48:51]
    ds_read_b64_tr_b16 a[72:73], v239 offset:128
    ds_read_b64_tr_b16 a[74:75], v239 offset:368
    s_waitcnt lgkmcnt(14)
    v_mfma_f32_32x32x16_bf16 v[32:47], a[24:27], v[128:131], v[32:47]
    ds_read_b64_tr_b16 a[8:9], v250 offset:7808
    ds_read_b64_tr_b16 a[10:11], v250 offset:8048
    s_waitcnt lgkmcnt(14)
    v_mfma_f32_32x32x16_bf16 v[48:63], a[28:31], v[128:131], v[48:63]
    ds_read_b64_tr_b16 a[12:13], v250 offset:7856
    ds_read_b64_tr_b16 a[14:15], v250 offset:8096
    s_waitcnt vmcnt(14) lgkmcnt(14)
    v_mfma_f32_32x32x16_bf16 v[0:15], a[32:35], v[132:135], v[0:15]
    buffer_load_dwordx4 v[192:195], v253, s[24:27], s60 offen offset:1024 sc1
    ds_read_b64_tr_b16 a[16:17], v250 offset:11520
    ds_read_b64_tr_b16 a[18:19], v250 offset:11760
    s_waitcnt lgkmcnt(14)
    v_mfma_f32_32x32x16_bf16 v[16:31], a[36:39], v[132:135], v[16:31]
    ds_read_b64_tr_b16 a[20:21], v250 offset:11584
    ds_read_b64_tr_b16 a[22:23], v250 offset:11824
    v_mfma_f32_16x16x32_bf16 a[52:55], a[208:211], a[68:71], a[52:55]
    ds_read_b64_tr_b16 a[76:77], v239 offset:176
    ds_read_b64_tr_b16 a[78:79], v239 offset:416
    s_waitcnt lgkmcnt(14)
    v_mfma_f32_32x32x16_bf16 v[32:47], a[40:43], v[132:135], v[32:47]
    ds_read_b64_tr_b16 a[24:25], v250 offset:11648
    ds_read_b64_tr_b16 a[26:27], v250 offset:11888
    s_waitcnt lgkmcnt(14)
    v_mfma_f32_32x32x16_bf16 v[48:63], a[44:47], v[132:135], v[48:63]
    ds_read_b64_tr_b16 a[28:29], v250 offset:11696
    ds_read_b64_tr_b16 a[30:31], v250 offset:11936
    s_waitcnt vmcnt(14) lgkmcnt(14)
    v_mfma_f32_32x32x16_bf16 v[0:15], a[0:3], v[136:139], v[0:15]
    buffer_load_dwordx4 v[196:199], v253, s[24:27], s60 offen offset:1536 sc1
    ds_read_b64_tr_b16 a[32:33], v250 offset:15360
    ds_read_b64_tr_b16 a[34:35], v250 offset:15600
    s_waitcnt lgkmcnt(14)
    v_mfma_f32_32x32x16_bf16 v[16:31], a[4:7], v[136:139], v[16:31]
    ds_read_b64_tr_b16 a[36:37], v250 offset:15424
    ds_read_b64_tr_b16 a[38:39], v250 offset:15664
    v_mfma_f32_16x16x32_bf16 a[56:59], a[208:211], a[72:75], a[56:59]
    ds_read_b64_tr_b16 a[80:81], v239 offset:15360
    ds_read_b64_tr_b16 a[82:83], v239 offset:15600
    s_waitcnt lgkmcnt(14)
    v_mfma_f32_32x32x16_bf16 v[32:47], a[8:11], v[136:139], v[32:47]
    ds_read_b64_tr_b16 a[40:41], v250 offset:15488
    ds_read_b64_tr_b16 a[42:43], v250 offset:15728
    s_waitcnt lgkmcnt(14)
    v_mfma_f32_32x32x16_bf16 v[48:63], a[12:15], v[136:139], v[48:63]
    ds_read_b64_tr_b16 a[44:45], v250 offset:15536
    ds_read_b64_tr_b16 a[46:47], v250 offset:15776
    s_waitcnt vmcnt(14) lgkmcnt(14)
    v_mfma_f32_32x32x16_bf16 v[0:15], a[16:19], v[140:143], v[0:15]
    buffer_load_dwordx4 v[200:203], v253, s[24:27], s60 offen offset:2048 sc1
    ds_read_b64_tr_b16 a[0:1], v250 offset:19200
    ds_read_b64_tr_b16 a[2:3], v250 offset:19440
    s_waitcnt lgkmcnt(14)
    v_mfma_f32_32x32x16_bf16 v[16:31], a[20:23], v[140:143], v[16:31]
    ds_read_b64_tr_b16 a[4:5], v250 offset:19264
    ds_read_b64_tr_b16 a[6:7], v250 offset:19504
    v_mfma_f32_16x16x32_bf16 a[60:63], a[208:211], a[76:79], a[60:63]
    ds_read_b64_tr_b16 a[84:85], v239 offset:15424
    ds_read_b64_tr_b16 a[86:87], v239 offset:15664
    s_waitcnt lgkmcnt(14)
    v_mfma_f32_32x32x16_bf16 v[32:47], a[24:27], v[140:143], v[32:47]
    ds_read_b64_tr_b16 a[8:9], v250 offset:19328
    ds_read_b64_tr_b16 a[10:11], v250 offset:19568
    s_waitcnt lgkmcnt(14)
    v_mfma_f32_32x32x16_bf16 v[48:63], a[28:31], v[140:143], v[48:63]
    ds_read_b64_tr_b16 a[12:13], v250 offset:19376
    ds_read_b64_tr_b16 a[14:15], v250 offset:19616
    s_waitcnt vmcnt(14) lgkmcnt(14)
    v_mfma_f32_32x32x16_bf16 v[0:15], a[32:35], v[144:147], v[0:15]
    s_add_u32 s60, s60, 2560
    buffer_load_dwordx4 v[204:207], v253, s[24:27], s60 offen offset:0 sc1
    ds_read_b64_tr_b16 a[16:17], v250 offset:23040
    ds_read_b64_tr_b16 a[18:19], v250 offset:23280
    s_waitcnt lgkmcnt(14)
    v_mfma_f32_32x32x16_bf16 v[16:31], a[36:39], v[144:147], v[16:31]
    ds_read_b64_tr_b16 a[20:21], v250 offset:23104
    ds_read_b64_tr_b16 a[22:23], v250 offset:23344
    v_mfma_f32_16x16x32_bf16 a[48:51], a[208:211], a[80:83], a[48:51]
    ds_read_b64_tr_b16 a[88:89], v239 offset:15488
    ds_read_b64_tr_b16 a[90:91], v239 offset:15728
    s_waitcnt lgkmcnt(14)
    v_mfma_f32_32x32x16_bf16 v[32:47], a[40:43], v[144:147], v[32:47]
    ds_read_b64_tr_b16 a[24:25], v250 offset:23168
    ds_read_b64_tr_b16 a[26:27], v250 offset:23408
    s_waitcnt lgkmcnt(14)
    v_mfma_f32_32x32x16_bf16 v[48:63], a[44:47], v[144:147], v[48:63]
    ds_read_b64_tr_b16 a[28:29], v250 offset:23216
    ds_read_b64_tr_b16 a[30:31], v250 offset:23456
    s_waitcnt vmcnt(14) lgkmcnt(14)
    v_mfma_f32_32x32x16_bf16 v[0:15], a[0:3], v[148:151], v[0:15]
    buffer_load_dwordx4 v[208:211], v253, s[24:27], s60 offen offset:512 sc1
    ds_read_b64_tr_b16 a[32:33], v250 offset:26880
    ds_read_b64_tr_b16 a[34:35], v250 offset:27120
    s_waitcnt lgkmcnt(14)
    v_mfma_f32_32x32x16_bf16 v[16:31], a[4:7], v[148:151], v[16:31]
    ds_read_b64_tr_b16 a[36:37], v250 offset:26944
    ds_read_b64_tr_b16 a[38:39], v250 offset:27184
    v_mfma_f32_16x16x32_bf16 a[52:55], a[208:211], a[84:87], a[52:55]
    ds_read_b64_tr_b16 a[92:93], v239 offset:15536
    ds_read_b64_tr_b16 a[94:95], v239 offset:15776
    s_waitcnt lgkmcnt(14)
    v_mfma_f32_32x32x16_bf16 v[32:47], a[8:11], v[148:151], v[32:47]
    ds_read_b64_tr_b16 a[40:41], v250 offset:27008
    ds_read_b64_tr_b16 a[42:43], v250 offset:27248
    s_waitcnt lgkmcnt(14)
    v_mfma_f32_32x32x16_bf16 v[48:63], a[12:15], v[148:151], v[48:63]
    ds_read_b64_tr_b16 a[44:45], v250 offset:27056
    ds_read_b64_tr_b16 a[46:47], v250 offset:27296
    s_waitcnt vmcnt(14) lgkmcnt(14)
    v_mfma_f32_32x32x16_bf16 v[0:15], a[16:19], v[152:155], v[0:15]
    buffer_load_dwordx4 v[212:215], v253, s[24:27], s60 offen offset:1024 sc1
    ds_read_b64_tr_b16 a[0:1], v249 offset:0
    ds_read_b64_tr_b16 a[2:3], v249 offset:240
    s_waitcnt lgkmcnt(14)
    v_mfma_f32_32x32x16_bf16 v[16:31], a[20:23], v[152:155], v[16:31]
    ds_read_b64_tr_b16 a[4:5], v249 offset:64
    ds_read_b64_tr_b16 a[6:7], v249 offset:304
    v_mfma_f32_16x16x32_bf16 a[56:59], a[208:211], a[88:91], a[56:59]
    s_waitcnt lgkmcnt(14)
    v_mfma_f32_32x32x16_bf16 v[32:47], a[24:27], v[152:155], v[32:47]
    ds_read_b64_tr_b16 a[8:9], v249 offset:128
    ds_read_b64_tr_b16 a[10:11], v249 offset:368
    s_waitcnt lgkmcnt(14)
    v_mfma_f32_32x32x16_bf16 v[48:63], a[28:31], v[152:155], v[48:63]
    ds_read_b64_tr_b16 a[12:13], v249 offset:176
    ds_read_b64_tr_b16 a[14:15], v249 offset:416
    s_waitcnt vmcnt(14) lgkmcnt(14)
    v_mfma_f32_32x32x16_bf16 v[0:15], a[32:35], v[156:159], v[0:15]
    buffer_load_dwordx4 v[216:219], v253, s[24:27], s60 offen offset:1536 sc1
    ds_read_b64_tr_b16 a[16:17], v249 offset:3840
    ds_read_b64_tr_b16 a[18:19], v249 offset:4080
    s_waitcnt lgkmcnt(14)
    v_mfma_f32_32x32x16_bf16 v[16:31], a[36:39], v[156:159], v[16:31]
    ds_read_b64_tr_b16 a[20:21], v249 offset:3904
    ds_read_b64_tr_b16 a[22:23], v249 offset:4144
    v_mfma_f32_16x16x32_bf16 a[60:63], a[208:211], a[92:95], a[60:63]
    s_waitcnt lgkmcnt(14)
    v_mfma_f32_32x32x16_bf16 v[32:47], a[40:43], v[156:159], v[32:47]
    ds_read_b64_tr_b16 a[24:25], v249 offset:3968
    ds_read_b64_tr_b16 a[26:27], v249 offset:4208
    s_waitcnt lgkmcnt(14)
    v_mfma_f32_32x32x16_bf16 v[48:63], a[44:47], v[156:159], v[48:63]
    ds_read_b64_tr_b16 a[28:29], v249 offset:4016
    ds_read_b64_tr_b16 a[30:31], v249 offset:4256
    s_waitcnt vmcnt(14) lgkmcnt(14)
    v_mfma_f32_32x32x16_bf16 v[0:15], a[0:3], v[160:163], v[0:15]
    buffer_load_dwordx4 v[220:223], v253, s[24:27], s60 offen offset:2048 sc1
    ds_read_b64_tr_b16 a[32:33], v249 offset:7680
    ds_read_b64_tr_b16 a[34:35], v249 offset:7920
    s_waitcnt lgkmcnt(14)
    v_mfma_f32_32x32x16_bf16 v[16:31], a[4:7], v[160:163], v[16:31]
    ds_read_b64_tr_b16 a[36:37], v249 offset:7744
    ds_read_b64_tr_b16 a[38:39], v249 offset:7984
    s_waitcnt lgkmcnt(14)
    v_mfma_f32_32x32x16_bf16 v[32:47], a[8:11], v[160:163], v[32:47]
    ds_read_b64_tr_b16 a[40:41], v249 offset:7808
    ds_read_b64_tr_b16 a[42:43], v249 offset:8048
    s_waitcnt lgkmcnt(14)
    v_mfma_f32_32x32x16_bf16 v[48:63], a[12:15], v[160:163], v[48:63]
    ds_read_b64_tr_b16 a[44:45], v249 offset:7856
    ds_read_b64_tr_b16 a[46:47], v249 offset:8096
    s_barrier
    s_mul_i32 s54, s42, 25600
    s_add_u32 m0, s54, 0
    s_add_u32 s71, s54, s69
    s_waitcnt vmcnt(14) lgkmcnt(14)
    v_mfma_f32_32x32x16_bf16 v[0:15], a[16:19], v[164:167], v[0:15]
    ds_read_b64_tr_b16 a[0:1], v249 offset:11520
    ds_read_b64_tr_b16 a[2:3], v249 offset:11760
    s_waitcnt lgkmcnt(14)
    v_mfma_f32_32x32x16_bf16 v[16:31], a[20:23], v[164:167], v[16:31]
    buffer_load_dwordx4 v252, s[24:27], s71 offen offset:0 sc1 lds
    ds_read_b64_tr_b16 a[4:5], v249 offset:11584
    ds_read_b64_tr_b16 a[6:7], v249 offset:11824
    s_waitcnt lgkmcnt(14)
    v_mfma_f32_32x32x16_bf16 v[32:47], a[24:27], v[164:167], v[32:47]
    buffer_load_dwordx4 v252, s[24:27], s71 offen offset:1024 sc1 lds
    ds_read_b64_tr_b16 a[8:9], v249 offset:11648
    ds_read_b64_tr_b16 a[10:11], v249 offset:11888
    s_waitcnt lgkmcnt(14)
    v_mfma_f32_32x32x16_bf16 v[48:63], a[28:31], v[164:167], v[48:63]
    ds_read_b64_tr_b16 a[12:13], v249 offset:11696
    ds_read_b64_tr_b16 a[14:15], v249 offset:11936
    s_mov_b32 exec_hi, 0
    ds_write_b32 v238, a48 offset:36864
    ds_write_b32 v238, a52 offset:36868
    ds_write_b32 v238, a56 offset:36872
    ds_write_b32 v238, a60 offset:36876
    s_mov_b32 exec_hi, -1
    s_waitcnt vmcnt(15) lgkmcnt(14)
    v_mfma_f32_32x32x16_bf16 v[0:15], a[32:35], v[168:171], v[0:15]
    ds_read_b64_tr_b16 a[16:17], v249 offset:15360
    ds_read_b64_tr_b16 a[18:19], v249 offset:15600
    v_and_b32 v225, 31, v255
    v_lshrrev_b32 v226, 5, v255
    s_waitcnt lgkmcnt(14)
    v_mfma_f32_32x32x16_bf16 v[16:31], a[36:39], v[168:171], v[16:31]
    buffer_load_dwordx4 v252, s[24:27], s71 offen offset:2048 sc1 lds
    ds_read_b64_tr_b16 a[20:21], v249 offset:15424
    ds_read_b64_tr_b16 a[22:23], v249 offset:15664
    s_mul_i32 s54, s42, 3456
    s_waitcnt lgkmcnt(14)
    v_mfma_f32_32x32x16_bf16 v[32:47], a[40:43], v[168:171], v[32:47]
    buffer_load_dwordx4 v252, s[24:27], s71 offen offset:3072 sc1 lds
    s_add_u32 m0, m0, 4096
    s_add_u32 s71, s71, 4096
    ds_read_b64_tr_b16 a[24:25], v249 offset:15488
    ds_read_b64_tr_b16 a[26:27], v249 offset:15728
    s_add_u32 s54, s54, 104448
    s_waitcnt lgkmcnt(14)
    v_mfma_f32_32x32x16_bf16 v[48:63], a[44:47], v[168:171], v[48:63]
    ds_read_b64_tr_b16 a[28:29], v249 offset:15536
    ds_read_b64_tr_b16 a[30:31], v249 offset:15776
    v_lshl_add_u32 v227, v225, 3, s54
    v_mul_u32_u24 v228, 288, v226
    s_waitcnt vmcnt(16) lgkmcnt(14)
    v_mfma_f32_32x32x16_bf16 v[0:15], a[0:3], v[172:175], v[0:15]
    ds_read_b64_tr_b16 a[32:33], v249 offset:19200
    ds_read_b64_tr_b16 a[34:35], v249 offset:19440
    v_add_u32 v227, v227, v228
    v_add_u32 v228, v227, v228
    s_waitcnt lgkmcnt(14)
    v_mfma_f32_32x32x16_bf16 v[16:31], a[4:7], v[172:175], v[16:31]
    buffer_load_dwordx4 v252, s[24:27], s71 offen offset:0 sc1 lds
    ds_read_b64_tr_b16 a[36:37], v249 offset:19264
    ds_read_b64_tr_b16 a[38:39], v249 offset:19504
    v_mov_b32 v110, 0x3f80
    s_waitcnt lgkmcnt(14)
    v_mfma_f32_32x32x16_bf16 v[32:47], a[8:11], v[172:175], v[32:47]
    buffer_load_dwordx4 v252, s[24:27], s71 offen offset:1024 sc1 lds
    ds_read_b64_tr_b16 a[40:41], v249 offset:19328
    ds_read_b64_tr_b16 a[42:43], v249 offset:19568
    v_mov_b32 v111, 0
    s_waitcnt lgkmcnt(14)
    v_mfma_f32_32x32x16_bf16 v[48:63], a[12:15], v[172:175], v[48:63]
    ds_read_b64_tr_b16 a[44:45], v249 offset:19376
    ds_read_b64_tr_b16 a[46:47], v249 offset:19616
    s_lshr_b32 s55, s43, 1
    s_mul_i32 s55, s55, 6291456
    s_waitcnt vmcnt(17) lgkmcnt(14)
    v_mfma_f32_32x32x16_bf16 v[0:15], a[16:19], v[176:179], v[0:15]
    ds_read_b64_tr_b16 a[0:1], v249 offset:23040
    ds_read_b64_tr_b16 a[2:3], v249 offset:23280
    s_mul_i32 s56, s41, 393216
    s_add_u32 s55, s55, s56
    s_waitcnt lgkmcnt(14)
    v_mfma_f32_32x32x16_bf16 v[16:31], a[20:23], v[176:179], v[16:31]
    buffer_load_dwordx4 v252, s[24:27], s71 offen offset:2048 sc1 lds
    ds_read_b64_tr_b16 a[4:5], v249 offset:23104
    ds_read_b64_tr_b16 a[6:7], v249 offset:23344
    s_add_u32 s62, s55, 24117248
    s_waitcnt lgkmcnt(14)
    v_mfma_f32_32x32x16_bf16 v[32:47], a[24:27], v[176:179], v[32:47]
    buffer_load_dwordx4 v252, s[24:27], s71 offen offset:3072 sc1 lds
    s_add_u32 m0, m0, 4096
    s_add_u32 s71, s71, 4096
    ds_read_b64_tr_b16 a[8:9], v249 offset:23168
    ds_read_b64_tr_b16 a[10:11], v249 offset:23408
    s_lshl_b32 s55, s40, 2
    s_waitcnt lgkmcnt(14)
    v_mfma_f32_32x32x16_bf16 v[48:63], a[28:31], v[176:179], v[48:63]
    ds_read_b64_tr_b16 a[12:13], v249 offset:23216
    ds_read_b64_tr_b16 a[14:15], v249 offset:23456
    s_add_u32 s55, s55, s42
    s_mul_i32 s55, s55, 3072
    s_waitcnt vmcnt(18) lgkmcnt(14)
    v_mfma_f32_32x32x16_bf16 v[0:15], a[32:35], v[180:183], v[0:15]
    ds_read_b64_tr_b16 a[16:17], v249 offset:26880
    ds_read_b64_tr_b16 a[18:19], v249 offset:27120
    s_add_u32 s60, s62, s55
    s_add_u32 s61, s60, 196608
    s_waitcnt lgkmcnt(14)
    v_mfma_f32_32x32x16_bf16 v[16:31], a[36:39], v[180:183], v[16:31]
    buffer_load_dwordx4 v252, s[24:27], s71 offen offset:0 sc1 lds
    ds_read_b64_tr_b16 a[20:21], v249 offset:26944
    ds_read_b64_tr_b16 a[22:23], v249 offset:27184
    v_mul_u32_u24 v229, 196608, v226
    s_waitcnt lgkmcnt(14)
    v_mfma_f32_32x32x16_bf16 v[32:47], a[40:43], v[180:183], v[32:47]
    buffer_load_dwordx4 v252, s[24:27], s71 offen offset:1024 sc1 lds
    ds_read_b64_tr_b16 a[24:25], v249 offset:27008
    ds_read_b64_tr_b16 a[26:27], v249 offset:27248
    v_lshl_add_u32 v229, v225, 4, v229
    s_waitcnt lgkmcnt(14)
    v_mfma_f32_32x32x16_bf16 v[48:63], a[44:47], v[180:183], v[48:63]
    ds_read_b64_tr_b16 a[28:29], v249 offset:27056
    ds_read_b64_tr_b16 a[30:31], v249 offset:27296
    v_and_b32 v230, 3, v255
    v_bfe_u32 v231, v255, 2, 2
    s_waitcnt vmcnt(19) lgkmcnt(14)
    v_mfma_f32_32x32x16_bf16 v[0:15], a[0:3], v[184:187], v[0:15]
    ds_read_b64_tr_b16 a[32:33], v249 offset:30720
    ds_read_b64_tr_b16 a[34:35], v249 offset:30960
    v_lshl_add_u32 v231, v226, 3, v231
    v_lshl_add_u32 v231, v231, 3, s54
    s_waitcnt lgkmcnt(14)
    v_mfma_f32_32x32x16_bf16 v[16:31], a[4:7], v[184:187], v[16:31]
    buffer_load_dwordx4 v252, s[24:27], s71 offen offset:2048 sc1 lds
    ds_read_b64_tr_b16 a[36:37], v249 offset:30784
    ds_read_b64_tr_b16 a[38:39], v249 offset:31024
    v_cmp_gt_u32 vcc, 16, v225
    s_waitcnt lgkmcnt(14)
    v_mfma_f32_32x32x16_bf16 v[32:47], a[8:11], v[184:187], v[32:47]
    buffer_load_dwordx4 v252, s[24:27], s71 offen offset:3072 sc1 lds
    s_add_u32 m0, m0, 4096
    s_add_u32 s71, s71, 4096
    ds_read_b64_tr_b16 a[40:41], v249 offset:30848
    ds_read_b64_tr_b16 a[42:43], v249 offset:31088
    v_cmp_eq_u32 s[56:57], 0, v230
    s_waitcnt lgkmcnt(14)
    v_mfma_f32_32x32x16_bf16 v[48:63], a[12:15], v[184:187], v[48:63]
    ds_read_b64_tr_b16 a[44:45], v249 offset:30896
    ds_read_b64_tr_b16 a[46:47], v249 offset:31136
    v_add_u32 v234, 4, v230
    v_cndmask_b32_e64 v232, 10, 8, s[56:57]
    s_waitcnt vmcnt(20) lgkmcnt(14)
    v_mfma_f32_32x32x16_bf16 v[0:15], a[16:19], v[188:191], v[0:15]
    ds_read_b64_tr_b16 a[0:1], v249 offset:34560
    ds_read_b64_tr_b16 a[2:3], v249 offset:34800
    v_cndmask_b32_e64 v233, 10, 9, s[56:57]
    v_cndmask_b32 v232, v232, v230, vcc
    s_waitcnt lgkmcnt(14)
    v_mfma_f32_32x32x16_bf16 v[16:31], a[20:23], v[188:191], v[16:31]
    buffer_load_dwordx4 v252, s[24:27], s71 offen offset:0 sc1 lds
    ds_read_b64_tr_b16 a[4:5], v249 offset:34624
    ds_read_b64_tr_b16 a[6:7], v249 offset:34864
    v_cndmask_b32 v233, v233, v234, vcc
    s_waitcnt lgkmcnt(14)
    v_mfma_f32_32x32x16_bf16 v[32:47], a[24:27], v[188:191], v[32:47]
    buffer_load_dwordx4 v252, s[24:27], s71 offen offset:1024 sc1 lds
    ds_read_b64_tr_b16 a[8:9], v249 offset:34688
    ds_read_b64_tr_b16 a[10:11], v249 offset:34928
    v_mul_u32_u24 v232, 288, v232
    s_waitcnt lgkmcnt(14)
    v_mfma_f32_32x32x16_bf16 v[48:63], a[28:31], v[188:191], v[48:63]
    ds_read_b64_tr_b16 a[12:13], v249 offset:34736
    ds_read_b64_tr_b16 a[14:15], v249 offset:34976
    v_mul_u32_u24 v233, 288, v233
    v_add_u32 v232, v232, v231
    s_waitcnt vmcnt(21) lgkmcnt(14)
    v_mfma_f32_32x32x16_bf16 v[0:15], a[32:35], v[192:195], v[0:15]
    ds_read_b64_tr_b16 a[16:17], v249 offset:38400
    ds_read_b64_tr_b16 a[18:19], v249 offset:38640
    v_add_u32 v233, v233, v231
    v_lshl_add_u32 v153, v225, 1, v226
    s_waitcnt lgkmcnt(14)
    v_mfma_f32_32x32x16_bf16 v[16:31], a[36:39], v[192:195], v[16:31]
    buffer_load_dwordx4 v252, s[24:27], s71 offen offset:2048 sc1 lds
    ds_read_b64_tr_b16 a[20:21], v249 offset:38464
    ds_read_b64_tr_b16 a[22:23], v249 offset:38704
    v_lshlrev_b32 v152, 3, v153
    s_waitcnt lgkmcnt(14)
    v_mfma_f32_32x32x16_bf16 v[32:47], a[40:43], v[192:195], v[32:47]
    buffer_load_dwordx4 v252, s[24:27], s71 offen offset:3072 sc1 lds
    s_add_u32 m0, m0, 4096
    s_add_u32 s71, s71, 4096
    ds_read_b64_tr_b16 a[24:25], v249 offset:38528
    ds_read_b64_tr_b16 a[26:27], v249 offset:38768
    v_lshlrev_b32 v153, 4, v153
    s_waitcnt lgkmcnt(14)
    v_mfma_f32_32x32x16_bf16 v[48:63], a[44:47], v[192:195], v[48:63]
    ds_read_b64_tr_b16 a[28:29], v249 offset:38576
    ds_read_b64_tr_b16 a[30:31], v249 offset:38816
    v_cmp_gt_u32 vcc, 24, v225
    v_mov_b32 v234, 0x80000000
    s_waitcnt vmcnt(22) lgkmcnt(14)
    v_mfma_f32_32x32x16_bf16 v[0:15], a[0:3], v[196:199], v[0:15]
    ds_read_b64_tr_b16 a[32:33], v249 offset:42240
    ds_read_b64_tr_b16 a[34:35], v249 offset:42480
    v_cndmask_b32 v153, v234, v153, vcc
    v_mov_b32 v98, 0x3f803f80
    s_waitcnt lgkmcnt(14)
    v_mfma_f32_32x32x16_bf16 v[16:31], a[4:7], v[196:199], v[16:31]
    buffer_load_dwordx4 v252, s[24:27], s71 offen offset:0 sc1 lds
    ds_read_b64_tr_b16 a[36:37], v249 offset:42304
    ds_read_b64_tr_b16 a[38:39], v249 offset:42544
    v_mov_b32 v99, 0x3f80
    s_waitcnt lgkmcnt(14)
    v_mfma_f32_32x32x16_bf16 v[32:47], a[8:11], v[196:199], v[32:47]
    buffer_load_dwordx4 v252, s[24:27], s71 offen offset:1024 sc1 lds
    ds_read_b64_tr_b16 a[40:41], v249 offset:42368
    ds_read_b64_tr_b16 a[42:43], v249 offset:42608
    v_lshlrev_b32 v64, 4, v225
    s_waitcnt lgkmcnt(14)
    v_mfma_f32_32x32x16_bf16 v[48:63], a[12:15], v[196:199], v[48:63]
    ds_read_b64_tr_b16 a[44:45], v249 offset:42416
    ds_read_b64_tr_b16 a[46:47], v249 offset:42656
    v_add_u32 v64, 102400, v64
    s_waitcnt vmcnt(23) lgkmcnt(14)
    v_mfma_f32_32x32x16_bf16 v[0:15], a[16:19], v[200:203], v[0:15]
    ds_read_b64_tr_b16 a[0:1], v249 offset:46080
    ds_read_b64_tr_b16 a[2:3], v249 offset:46320
    s_waitcnt lgkmcnt(14)
    v_mfma_f32_32x32x16_bf16 v[16:31], a[20:23], v[200:203], v[16:31]
    buffer_load_dwordx4 v252, s[24:27], s71 offen offset:2048 sc1 lds
    ds_read_b64_tr_b16 a[4:5], v249 offset:46144
    ds_read_b64_tr_b16 a[6:7], v249 offset:46384
    s_waitcnt lgkmcnt(14)
    v_mfma_f32_32x32x16_bf16 v[32:47], a[24:27], v[200:203], v[32:47]
    buffer_load_dwordx4 v252, s[24:27], s71 offen offset:3072 sc1 lds
    s_add_u32 m0, m0, 4096
    s_add_u32 s71, s71, 4096
    ds_read_b64_tr_b16 a[8:9], v249 offset:46208
    ds_read_b64_tr_b16 a[10:11], v249 offset:46448
    s_waitcnt lgkmcnt(14)
    v_mfma_f32_32x32x16_bf16 v[48:63], a[28:31], v[200:203], v[48:63]
    ds_read_b64_tr_b16 a[12:13], v249 offset:46256
    ds_read_b64_tr_b16 a[14:15], v249 offset:46496
    s_waitcnt vmcnt(24) lgkmcnt(14)
    v_mfma_f32_32x32x16_bf16 v[0:15], a[32:35], v[204:207], v[0:15]
    ds_read_b64_tr_b16 a[16:17], v249 offset:49920
    ds_read_b64_tr_b16 a[18:19], v249 offset:50160
    s_waitcnt lgkmcnt(14)
    v_mfma_f32_32x32x16_bf16 v[16:31], a[36:39], v[204:207], v[16:31]
    buffer_load_dwordx4 v252, s[24:27], s71 offen offset:0 sc1 lds
    ds_read_b64_tr_b16 a[20:21], v249 offset:49984
    ds_read_b64_tr_b16 a[22:23], v249 offset:50224
    s_waitcnt lgkmcnt(14)
    v_mfma_f32_32x32x16_bf16 v[32:47], a[40:43], v[204:207], v[32:47]
    buffer_load_dwordx4 v252, s[24:27], s71 offen offset:1024 sc1 lds
    ds_read_b64_tr_b16 a[24:25], v249 offset:50048
    ds_read_b64_tr_b16 a[26:27], v249 offset:50288
    s_waitcnt lgkmcnt(14)
    v_mfma_f32_32x32x16_bf16 v[48:63], a[44:47], v[204:207], v[48:63]
    ds_read_b64_tr_b16 a[28:29], v249 offset:50096
    ds_read_b64_tr_b16 a[30:31], v249 offset:50336
    s_waitcnt vmcnt(25) lgkmcnt(14)
    v_mfma_f32_32x32x16_bf16 v[0:15], a[0:3], v[208:211], v[0:15]
    ds_read_b64_tr_b16 a[32:33], v249 offset:53760
    ds_read_b64_tr_b16 a[34:35], v249 offset:54000
    s_waitcnt lgkmcnt(14)
    v_mfma_f32_32x32x16_bf16 v[16:31], a[4:7], v[208:211], v[16:31]
    buffer_load_dwordx4 v252, s[24:27], s71 offen offset:2048 sc1 lds
    ds_read_b64_tr_b16 a[36:37], v249 offset:53824
    ds_read_b64_tr_b16 a[38:39], v249 offset:54064
    s_waitcnt lgkmcnt(14)
    v_mfma_f32_32x32x16_bf16 v[32:47], a[8:11], v[208:211], v[32:47]
    buffer_load_dwordx4 v252, s[24:27], s71 offen offset:3072 sc1 lds
    s_add_u32 m0, m0, 4096
    s_add_u32 s71, s71, 4096
    ds_read_b64_tr_b16 a[40:41], v249 offset:53888
    ds_read_b64_tr_b16 a[42:43], v249 offset:54128
    s_waitcnt lgkmcnt(14)
    v_mfma_f32_32x32x16_bf16 v[48:63], a[12:15], v[208:211], v[48:63]
    ds_read_b64_tr_b16 a[44:45], v249 offset:53936
    ds_read_b64_tr_b16 a[46:47], v249 offset:54176
    s_waitcnt vmcnt(26) lgkmcnt(14)
    v_mfma_f32_32x32x16_bf16 v[0:15], a[16:19], v[212:215], v[0:15]
    ds_read_b64_tr_b16 a[0:1], v249 offset:57600
    ds_read_b64_tr_b16 a[2:3], v249 offset:57840
    s_waitcnt lgkmcnt(14)
    v_mfma_f32_32x32x16_bf16 v[16:31], a[20:23], v[212:215], v[16:31]
    buffer_load_dwordx4 v252, s[24:27], s71 offen offset:0 sc1 lds
    ds_read_b64_tr_b16 a[4:5], v249 offset:57664
    ds_read_b64_tr_b16 a[6:7], v249 offset:57904
    s_waitcnt lgkmcnt(14)
    v_mfma_f32_32x32x16_bf16 v[32:47], a[24:27], v[212:215], v[32:47]
    ds_read_b64_tr_b16 a[8:9], v249 offset:57728
    ds_read_b64_tr_b16 a[10:11], v249 offset:57968
    s_waitcnt lgkmcnt(14)
    v_mfma_f32_32x32x16_bf16 v[48:63], a[28:31], v[212:215], v[48:63]
    ds_read_b64_tr_b16 a[12:13], v249 offset:57776
    ds_read_b64_tr_b16 a[14:15], v249 offset:58016
    s_waitcnt vmcnt(26) lgkmcnt(14)
    v_mfma_f32_32x32x16_bf16 v[0:15], a[32:35], v[216:219], v[0:15]
    s_waitcnt lgkmcnt(12)
    v_mfma_f32_32x32x16_bf16 v[16:31], a[36:39], v[216:219], v[16:31]
    s_waitcnt lgkmcnt(10)
    v_mfma_f32_32x32x16_bf16 v[32:47], a[40:43], v[216:219], v[32:47]
    s_waitcnt lgkmcnt(8)
    v_mfma_f32_32x32x16_bf16 v[48:63], a[44:47], v[216:219], v[48:63]
    s_waitcnt vmcnt(25) lgkmcnt(6)
    v_mfma_f32_32x32x16_bf16 v[0:15], a[0:3], v[220:223], v[0:15]
    s_waitcnt lgkmcnt(4)
    v_mfma_f32_32x32x16_bf16 v[16:31], a[4:7], v[220:223], v[16:31]
    s_waitcnt lgkmcnt(2)
    v_mfma_f32_32x32x16_bf16 v[32:47], a[8:11], v[220:223], v[32:47]
    s_waitcnt lgkmcnt(0)
    v_mfma_f32_32x32x16_bf16 v[48:63], a[12:15], v[220:223], v[48:63]
    s_barrier
    ds_read_b128 v[68:71], v64 offset:0
    ds_read_b128 v[72:75], v64 offset:512
    ds_read_b128 v[76:79], v64 offset:1024
    ds_read_b128 v[80:83], v64 offset:1536
    s_waitcnt lgkmcnt(0)
    v_add_f32 v69, v69, v73
    v_add_f32 v77, v77, v81
    v_add_f32 v69, v69, v77
    v_and_b32 v73, 0xffff0000, v69
    v_sub_f32 v69, v69, v73
    v_cvt_pk_bf16_f32 v69, v73, v69
    v_lshrrev_b32 v73, 16, v73
    v_accvgpr_write_b32 a230, v69
    v_accvgpr_write_b32 a231, v73
    s_nop 1
    v_mfma_f32_32x32x8_bf16 v[16:31], a[230:231], v[244:245], v[16:31]
    v_add_f32 v71, v71, v75
    v_add_f32 v79, v79, v83
    v_add_f32 v71, v71, v79
    v_and_b32 v75, 0xffff0000, v71
    v_sub_f32 v71, v71, v75
    v_cvt_pk_bf16_f32 v71, v75, v71
    v_lshrrev_b32 v75, 16, v75
    v_accvgpr_write_b32 a234, v71
    v_accvgpr_write_b32 a235, v75
    s_nop 1
    v_mfma_f32_32x32x8_bf16 v[48:63], a[234:235], v[244:245], v[48:63]
    v_add_f32 v70, v70, v74
    v_add_f32 v78, v78, v82
    v_add_f32 v70, v70, v78
    v_and_b32 v74, 0xffff0000, v70
    v_sub_f32 v70, v70, v74
    v_cvt_pk_bf16_f32 v70, v74, v70
    v_lshrrev_b32 v74, 16, v74
    v_accvgpr_write_b32 a232, v70
    v_accvgpr_write_b32 a233, v74
    s_nop 1
    v_mfma_f32_32x32x8_bf16 v[32:47], a[232:233], v[244:245], v[32:47]
    v_add_f32 v68, v68, v72
    v_add_f32 v76, v76, v80
    v_add_f32 v68, v68, v76
    v_and_b32 v72, 0xffff0000, v68
    v_sub_f32 v68, v68, v72
    v_cvt_pk_bf16_f32 v68, v72, v68
    v_lshrrev_b32 v72, 16, v72
    v_accvgpr_write_b32 a228, v68
    v_accvgpr_write_b32 a229, v72
    s_nop 1
    v_mfma_f32_32x32x8_bf16 v[0:15], a[228:229], v[244:245], v[0:15]
EPI_B:
    ds_write_b64 v227, v[110:111] offset:2880
    s_nop 5
    v_pk_mul_f32 v[16:17], v[16:17], v[242:243] op_sel_hi:[1,0]
    v_pk_mul_f32 v[18:19], v[18:19], v[242:243] op_sel_hi:[1,0]
    v_pk_mul_f32 v[20:21], v[20:21], v[242:243] op_sel_hi:[1,0]
    v_pk_mul_f32 v[22:23], v[22:23], v[242:243] op_sel_hi:[1,0]
    v_pk_mul_f32 v[24:25], v[24:25], v[242:243] op_sel_hi:[1,0]
    v_pk_mul_f32 v[26:27], v[26:27], v[242:243] op_sel_hi:[1,0]
    v_pk_mul_f32 v[28:29], v[28:29], v[242:243] op_sel_hi:[1,0]
    v_pk_mul_f32 v[30:31], v[30:31], v[242:243] op_sel_hi:[1,0]
    v_pk_mul_f32 v[56:57], v[56:57], v[242:243] op_sel_hi:[1,0]
    v_pk_mul_f32 v[58:59], v[58:59], v[242:243] op_sel_hi:[1,0]
    v_cvt_pk_bf16_f32 v88, v16, v17
    v_cvt_pk_bf16_f32 v89, v18, v19
    v_cvt_pk_bf16_f32 v90, v20, v21
    v_cvt_pk_bf16_f32 v91, v22, v23
    v_cvt_pk_bf16_f32 v92, v24, v25
    v_cvt_pk_bf16_f32 v93, v26, v27
    v_cvt_pk_bf16_f32 v94, v28, v29
    v_cvt_pk_bf16_f32 v95, v30, v31
    v_cvt_pk_bf16_f32 v96, v56, v57
    v_cvt_pk_bf16_f32 v97, v58, v59
    buffer_store_dwordx4 v[88:91], v252, s[24:27], s60 offen sc1
    buffer_store_dwordx4 v[92:95], v252, s[24:27], s61 offen sc1
    buffer_store_dwordx4 v[96:99], v229, s[24:27], s60 offen offset:1024 sc1
    v_pk_mul_f32 v[32:33], v[32:33], v[242:243] op_sel_hi:[1,0]
    v_pk_mul_f32 v[34:35], v[34:35], v[242:243] op_sel_hi:[1,0]
    v_pk_mul_f32 v[36:37], v[36:37], v[242:243] op_sel_hi:[1,0]
    v_pk_mul_f32 v[38:39], v[38:39], v[242:243] op_sel_hi:[1,0]
    v_pk_mul_f32 v[40:41], v[40:41], v[242:243] op_sel_hi:[1,0]
    v_pk_mul_f32 v[42:43], v[42:43], v[242:243] op_sel_hi:[1,0]
    v_pk_mul_f32 v[44:45], v[44:45], v[242:243] op_sel_hi:[1,0]
    v_pk_mul_f32 v[46:47], v[46:47], v[242:243] op_sel_hi:[1,0]
    v_pk_mul_f32 v[60:61], v[60:61], v[242:243] op_sel_hi:[1,0]
    v_pk_mul_f32 v[62:63], v[62:63], v[242:243] op_sel_hi:[1,0]
    v_cvt_pk_bf16_f32 v100, v32, v33
    v_cvt_pk_bf16_f32 v101, v34, v35
    v_cvt_pk_bf16_f32 v102, v36, v37
    v_cvt_pk_bf16_f32 v103, v38, v39
    v_cvt_pk_bf16_f32 v104, v40, v41
    v_cvt_pk_bf16_f32 v105, v42, v43
    v_cvt_pk_bf16_f32 v106, v44, v45
    v_cvt_pk_bf16_f32 v107, v46, v47
    v_cvt_pk_bf16_f32 v108, v60, v61
    v_cvt_pk_bf16_f32 v109, v62, v63
    ds_write_b64 v228, v[100:101] offset:0
    ds_write_b64 v228, v[102:103] offset:288
    ds_write_b64 v228, v[104:105] offset:1152
    ds_write_b64 v228, v[106:107] offset:1440
    ds_write_b64 v227, v[108:109] offset:2304
    ds_read_b64_tr_b16 v[112:113], v232 offset:0
    ds_read_b64_tr_b16 v[114:115], v232 offset:32
    ds_read_b64_tr_b16 v[116:117], v232 offset:128
    ds_read_b64_tr_b16 v[118:119], v232 offset:160
    ds_read_b64_tr_b16 v[120:121], v233 offset:0
    ds_read_b64_tr_b16 v[122:123], v233 offset:32
    ds_read_b64_tr_b16 v[124:125], v233 offset:128
    ds_read_b64_tr_b16 v[126:127], v233 offset:160
    v_mul_f32 v224, 0x3ea52b5c, v242
    v_pk_mul_f32 v[0:1], v[0:1], v[224:225] op_sel_hi:[1,0]
    v_pk_mul_f32 v[2:3], v[2:3], v[224:225] op_sel_hi:[1,0]
    v_pk_mul_f32 v[4:5], v[4:5], v[224:225] op_sel_hi:[1,0]
    v_pk_mul_f32 v[6:7], v[6:7], v[224:225] op_sel_hi:[1,0]
    v_pk_mul_f32 v[8:9], v[8:9], v[224:225] op_sel_hi:[1,0]
    v_pk_mul_f32 v[10:11], v[10:11], v[224:225] op_sel_hi:[1,0]
    v_pk_mul_f32 v[12:13], v[12:13], v[224:225] op_sel_hi:[1,0]
    v_pk_mul_f32 v[14:15], v[14:15], v[224:225] op_sel_hi:[1,0]
    v_pk_mul_f32 v[52:53], v[52:53], v[224:225] op_sel_hi:[1,0]
    v_pk_mul_f32 v[54:55], v[54:55], v[224:225] op_sel_hi:[1,0]
    v_cvt_pk_bf16_f32 v64, v0, v1
    v_cvt_pk_bf16_f32 v65, v2, v3
    v_cvt_pk_bf16_f32 v66, v4, v5
    v_cvt_pk_bf16_f32 v67, v6, v7
    v_cvt_pk_bf16_f32 v68, v8, v9
    v_cvt_pk_bf16_f32 v69, v10, v11
    v_cvt_pk_bf16_f32 v70, v12, v13
    v_cvt_pk_bf16_f32 v71, v14, v15
    v_cvt_pk_bf16_f32 v72, v52, v53
    v_cvt_pk_bf16_f32 v73, v54, v55
    s_waitcnt lgkmcnt(6)
    buffer_store_dwordx4 v[112:115], v153, s[24:27], s60 offen offset:1536 sc1
    s_waitcnt lgkmcnt(4)
    buffer_store_dwordx4 v[116:119], v153, s[24:27], s60 offen offset:2304 sc1
    s_waitcnt lgkmcnt(2)
    buffer_store_dwordx4 v[120:123], v153, s[24:27], s61 offen offset:1536 sc1
    s_waitcnt lgkmcnt(0)
    buffer_store_dwordx4 v[124:127], v153, s[24:27], s61 offen offset:2304 sc1
    v_cndmask_b32_e64 v76, v72, 0, s[52:53]
    v_cndmask_b32_e64 v77, v73, 0, s[52:53]
    v_cndmask_b32_e64 v78, 0, v72, s[52:53]
    v_cndmask_b32_e64 v79, 0, v73, s[52:53]
    v_mfma_f32_32x32x16_bf16 v[0:15], v[88:91], v[64:67], 0
    v_mfma_f32_32x32x16_bf16 v[16:31], v[92:95], v[68:71], 0
    v_mfma_f32_32x32x8_bf16 v[0:15], v[96:97], v[76:77], v[0:15]
    v_mfma_f32_32x32x8_bf16 v[16:31], v[96:97], v[78:79], v[16:31]
    s_mul_i32 s54, s42, 3072
    s_add_u32 s54, s54, 120832
    v_add_u32 v227, s54, v252
    v_mul_u32_u24 v228, 1024, v226
    v_add_u32 v228, v228, v227
    ds_write_b128 v227, v[64:67]
    ds_write_b128 v227, v[68:71] offset:1536
    ds_write_b128 v227, v[88:91] offset:16384
    ds_write_b128 v227, v[92:95] offset:17920
    ds_write_b128 v228, v[96:99] offset:17408
    s_nop 0
    v_max3_f32 v80, v0, v1, v2
    v_max3_f32 v80, v80, v3, v4
    v_max3_f32 v80, v80, v5, v6
    v_max3_f32 v80, v80, v7, v8
    v_max3_f32 v80, v80, v9, v10
    v_max3_f32 v80, v80, v11, v12
    v_max3_f32 v80, v80, v13, v14
    v_max_f32 v80, v80, v15
    v_max3_f32 v81, v16, v17, v18
    v_max3_f32 v81, v81, v19, v20
    v_max3_f32 v81, v81, v21, v22
    v_max3_f32 v81, v81, v23, v24
    v_max3_f32 v81, v81, v25, v26
    v_max3_f32 v81, v81, v27, v28
    v_max3_f32 v81, v81, v29, v30
    v_max_f32 v81, v81, v31
    s_nop 1
    v_permlane32_swap_b32 v80, v81
    v_max_f32 v80, v80, v81
    v_and_b32 v82, 0xffff0000, v80
    v_sub_f32 v83, v82, v80
    v_and_b32 v84, 0xffff0000, v83
    v_sub_f32 v83, v83, v84
    v_cvt_pk_bf16_f32 v74, -v82, v84
    v_cvt_pk_bf16_f32 v75, v83, 0
    ds_write_b128 v228, v[72:75] offset:1024
    s_and_b32 s54, s42, 1
    s_lshr_b32 s56, s42, 1
    s_mul_i32 s55, s54, 1536
    s_add_u32 s55, s55, 120832
    v_add_u32 v227, s55, v252
    v_add_u32 v228, s55, v152
    s_mul_i32 s57, s56, 6144
    v_add_u32 v225, s57, v227
    v_add_u32 v226, s57, v228
    s_cmp_eq_u32 s54, 0
    s_cselect_b64 vcc, -1, 0
    s_mul_i32 s58, s54, 3456
    v_cndmask_b32 v232, v233, v232, vcc
    v_subrev_u32 v232, s58, v232
    s_mul_i32 s54, s54, 196608
    s_add_u32 s62, s62, s54
    s_add_u32 s57, s57, s62
    s_add_u32 s57, s57, 3072
    s_add_u32 s74, s24, s57
    s_addc_u32 s75, s25, 0
    s_mov_b32 s50, 0
    v_mov_b32 v154, 0xdddddddd
    v_min_u32 v155, 752, v153
    v_mov_b32 v229, 0
    v_mov_b32 v230, 153600
    ds_write_b32 v230, v229
    s_waitcnt lgkmcnt(0)
    s_barrier
    ds_read_b128 a[0:3], v225 offset:16384
    ds_read_b64 a[12:13], v226 offset:17408
    ds_read_b128 v[128:131], v227 offset:0
    ds_read_b64 v[144:145], v228 offset:1024
    ds_read_b128 v[132:135], v227 offset:3072
    ds_read_b64 v[146:147], v228 offset:4096
    ds_read_b128 v[136:139], v227 offset:6144
    ds_read_b64 v[148:149], v228 offset:7168
    ds_read_b128 v[140:143], v227 offset:9216
    ds_read_b64 v[150:151], v228 offset:10240
    ds_read_b64_tr_b16 a[4:5], v232 offset:0
    ds_read_b64_tr_b16 a[6:7], v232 offset:32
    ds_read_b64_tr_b16 a[8:9], v232 offset:128
    ds_read_b64_tr_b16 a[10:11], v232 offset:160
    ds_read_b128 a[14:17], v225 offset:19456
    ds_read_b64 a[26:27], v226 offset:20480
    ds_read_b64_tr_b16 a[18:19], v232 offset:3456
    ds_read_b64_tr_b16 a[20:21], v232 offset:3488
    ds_read_b64_tr_b16 a[22:23], v232 offset:3584
    ds_read_b64_tr_b16 a[24:25], v232 offset:3616
ATT:
    v_mov_b64 v[64:65], 0
    v_mov_b64 v[66:67], 0
    v_mov_b64 v[68:69], 0
    v_mov_b64 v[70:71], 0
    v_mov_b64 v[72:73], 0
    v_mov_b64 v[74:75], 0
    v_mov_b64 v[76:77], 0
    v_mov_b64 v[78:79], 0
    v_mov_b64 v[80:81], 0
    v_mov_b64 v[82:83], 0
    v_mov_b64 v[84:85], 0
    v_mov_b64 v[86:87], 0
    v_mov_b64 v[88:89], 0
    v_mov_b64 v[90:91], 0
    v_mov_b64 v[92:93], 0
    v_mov_b64 v[94:95], 0
    v_mov_b64 v[96:97], 0
    v_mov_b64 v[98:99], 0
    v_mov_b64 v[100:101], 0
    v_mov_b64 v[102:103], 0
    v_mov_b64 v[104:105], 0
    v_mov_b64 v[106:107], 0
    v_mov_b64 v[108:109], 0
    v_mov_b64 v[110:111], 0
    v_mov_b64 v[112:113], 0
    v_mov_b64 v[114:115], 0
    v_mov_b64 v[116:117], 0
    v_mov_b64 v[118:119], 0
    v_mov_b64 v[120:121], 0
    v_mov_b64 v[122:123], 0
    v_mov_b64 v[124:125], 0
    v_mov_b64 v[126:127], 0
    s_mov_b32 s58, 4
    s_mul_i32 s60, s40, 12288
    s_add_u32 s60, s60, 12288
    s_cmp_eq_u32 s60, 196608
    s_cselect_b32 s60, 0, s60
    s_add_u32 s72, s74, s60
    s_addc_u32 s73, s75, 0
    s_add_u32 s60, s60, 12288
    s_cmp_eq_u32 s60, 196608
    s_cselect_b32 s60, 0, s60
    s_waitcnt lgkmcnt(0)
    v_mfma_f32_32x32x16_bf16 v[0:15], a[0:3], v[128:131], 0
    v_mfma_f32_32x32x8_bf16 v[0:15], a[12:13], v[144:145], v[0:15]
    s_nop 11
    v_mfma_f32_32x32x16_bf16 v[16:31], a[0:3], v[132:135], 0
    v_exp_f32 v0, v0
    v_exp_f32 v1, v1
    v_exp_f32 v2, v2
    v_exp_f32 v3, v3
    v_mfma_f32_32x32x8_bf16 v[16:31], a[12:13], v[146:147], v[16:31]
    v_exp_f32 v4, v4
    v_exp_f32 v5, v5
    v_exp_f32 v6, v6
    v_exp_f32 v7, v7
    v_exp_f32 v8, v8
    v_exp_f32 v9, v9
    v_exp_f32 v10, v10
    v_exp_f32 v11, v11
    v_exp_f32 v12, v12
    v_exp_f32 v13, v13
    v_exp_f32 v14, v14
    v_exp_f32 v15, v15
    v_mfma_f32_32x32x16_bf16 v[32:47], a[0:3], v[136:139], 0
    v_exp_f32 v16, v16
    v_exp_f32 v17, v17
    v_exp_f32 v18, v18
    v_exp_f32 v19, v19
    v_mfma_f32_32x32x8_bf16 v[32:47], a[12:13], v[148:149], v[32:47]
    v_exp_f32 v20, v20
    v_exp_f32 v21, v21
    v_exp_f32 v22, v22
    v_exp_f32 v23, v23
    v_smfmac_f32_32x32x32_bf16 v[64:79], a[4:7], v[0:7], v154
    v_exp_f32 v24, v24
    v_exp_f32 v25, v25
    v_exp_f32 v26, v26
    v_exp_f32 v27, v27
    v_smfmac_f32_32x32x32_bf16 v[64:79], a[8:11], v[8:15], v154
    v_exp_f32 v28, v28
    v_exp_f32 v29, v29
    v_exp_f32 v30, v30
    v_exp_f32 v31, v31
    v_mfma_f32_32x32x16_bf16 v[48:63], a[0:3], v[140:143], 0
    v_exp_f32 v32, v32
    v_exp_f32 v33, v33
    v_exp_f32 v34, v34
    v_exp_f32 v35, v35
    v_mfma_f32_32x32x8_bf16 v[48:63], a[12:13], v[150:151], v[48:63]
    v_exp_f32 v36, v36
    v_exp_f32 v37, v37
    v_exp_f32 v38, v38
    v_exp_f32 v39, v39
    v_smfmac_f32_32x32x32_bf16 v[80:95], a[4:7], v[16:23], v154
    v_exp_f32 v40, v40
    v_exp_f32 v41, v41
    v_exp_f32 v42, v42
    v_exp_f32 v43, v43
    v_smfmac_f32_32x32x32_bf16 v[80:95], a[8:11], v[24:31], v154
    v_exp_f32 v44, v44
    v_exp_f32 v45, v45
    v_exp_f32 v46, v46
    v_exp_f32 v47, v47
    s_cmp_lg_u32 s50, 0
    s_cbranch_scc1 NS_31
    s_add_u32 s45, s45, 16
    v_mov_b32 v247, 1
    s_waitcnt vmcnt(0)
    s_barrier
    s_cmp_lg_u32 s42, 0
    s_cbranch_scc1 SG_32
    s_mov_b64 exec, 0x3
    buffer_atomic_add v247, v254, s[24:27], s47 offen sc1
    s_mov_b64 exec, -1
SG_32:
NS_31:
    v_mfma_f32_32x32x16_bf16 v[0:15], a[14:17], v[128:131], 0
    v_exp_f32 v48, v48
    v_exp_f32 v49, v49
    v_exp_f32 v50, v50
    v_exp_f32 v51, v51
    v_mfma_f32_32x32x8_bf16 v[0:15], a[26:27], v[144:145], v[0:15]
    v_exp_f32 v52, v52
    v_exp_f32 v53, v53
    v_exp_f32 v54, v54
    v_exp_f32 v55, v55
    v_smfmac_f32_32x32x32_bf16 v[96:111], a[4:7], v[32:39], v154
    v_exp_f32 v56, v56
    v_exp_f32 v57, v57
    v_exp_f32 v58, v58
    v_exp_f32 v59, v59
    v_smfmac_f32_32x32x32_bf16 v[96:111], a[8:11], v[40:47], v154
    v_exp_f32 v60, v60
    v_exp_f32 v61, v61
    v_exp_f32 v62, v62
    v_exp_f32 v63, v63
    s_cmp_gt_u32 s42, 0
    s_cbranch_scc1 PX_35
    s_mov_b64 exec, 1
PL_33:
    v_mov_b32 v246, 0
    buffer_atomic_add v246, off, s[24:27], s51 sc0 sc1
    s_waitcnt vmcnt(0)
    v_cmp_gt_u32 vcc, s45, v246
    s_nop 4
    s_cbranch_vccz PD_34
    s_sub_u32 s48, s48, 1
    s_cmp_gt_i32 s48, 0
    s_cbranch_scc1 PL_33
    s_mov_b64 exec, -1
PX_35:
PD_34:
    s_mov_b64 exec, -1
    s_barrier
    global_load_dwordx4 a[28:31], v252, s[72:73] offset:-3072 sc1
    global_load_dwordx2 a[40:41], v152, s[72:73] offset:-2048 sc1
    global_load_dwordx4 a[32:35], v155, s[72:73] offset:-1536 sc1
    global_load_dwordx4 a[36:39], v155, s[72:73] offset:-768 sc1
    global_load_dwordx4 a[42:45], v252, s[72:73] offset:0 sc1
    global_load_dwordx2 a[54:55], v152, s[72:73] offset:1024 sc1
    global_load_dwordx4 a[46:49], v155, s[72:73] offset:1536 sc1
    global_load_dwordx4 a[50:53], v155, s[72:73] offset:2304 sc1
    s_branch ATT_K1
    .p2align 3
ATT_LOOP:
    v_mfma_f32_32x32x16_bf16 v[16:31], a[0:3], v[132:135], 0
    v_exp_f32 v0, v0
    v_exp_f32 v1, v1
    v_exp_f32 v2, v2
    v_exp_f32 v3, v3
    v_mfma_f32_32x32x8_bf16 v[16:31], a[12:13], v[146:147], v[16:31]
    v_exp_f32 v4, v4
    v_exp_f32 v5, v5
    v_exp_f32 v6, v6
    v_exp_f32 v7, v7
    v_smfmac_f32_32x32x32_bf16 v[112:127], a[46:49], v[48:55], v154
    v_exp_f32 v8, v8
    v_exp_f32 v9, v9
    v_exp_f32 v10, v10
    v_exp_f32 v11, v11
    v_smfmac_f32_32x32x32_bf16 v[112:127], a[50:53], v[56:63], v154
    global_load_dwordx4 a[42:45], v252, s[72:73] offset:0 sc1
    v_exp_f32 v12, v12
    v_exp_f32 v13, v13
    v_exp_f32 v14, v14
    v_exp_f32 v15, v15
    v_mfma_f32_32x32x16_bf16 v[32:47], a[0:3], v[136:139], 0
    s_waitcnt vmcnt(9)
    v_exp_f32 v16, v16
    v_exp_f32 v17, v17
    v_exp_f32 v18, v18
    v_exp_f32 v19, v19
    v_mfma_f32_32x32x8_bf16 v[32:47], a[12:13], v[148:149], v[32:47]
    v_exp_f32 v20, v20
    v_exp_f32 v21, v21
    v_exp_f32 v22, v22
    v_exp_f32 v23, v23
    v_smfmac_f32_32x32x32_bf16 v[64:79], a[4:7], v[0:7], v154
    v_exp_f32 v24, v24
    v_exp_f32 v25, v25
    v_exp_f32 v26, v26
    v_exp_f32 v27, v27
    v_smfmac_f32_32x32x32_bf16 v[64:79], a[8:11], v[8:15], v154
    global_load_dwordx2 a[54:55], v152, s[72:73] offset:1024 sc1
    v_exp_f32 v28, v28
    v_exp_f32 v29, v29
    v_exp_f32 v30, v30
    v_exp_f32 v31, v31
    v_mfma_f32_32x32x16_bf16 v[48:63], a[0:3], v[140:143], 0
    s_add_u32 s60, s60, 12288
    v_exp_f32 v32, v32
    v_exp_f32 v33, v33
    v_exp_f32 v34, v34
    v_exp_f32 v35, v35
    v_mfma_f32_32x32x8_bf16 v[48:63], a[12:13], v[150:151], v[48:63]
    v_exp_f32 v36, v36
    v_exp_f32 v37, v37
    v_exp_f32 v38, v38
    v_exp_f32 v39, v39
    v_smfmac_f32_32x32x32_bf16 v[80:95], a[4:7], v[16:23], v154
    s_cmp_eq_u32 s60, 196608
    s_cselect_b32 s60, 0, s60
    v_exp_f32 v40, v40
    v_exp_f32 v41, v41
    v_exp_f32 v42, v42
    v_exp_f32 v43, v43
    v_smfmac_f32_32x32x32_bf16 v[80:95], a[8:11], v[24:31], v154
    s_waitcnt vmcnt(8)
    global_load_dwordx4 a[46:49], v155, s[72:73] offset:1536 sc1
    v_exp_f32 v44, v44
    v_exp_f32 v45, v45
    v_exp_f32 v46, v46
    v_exp_f32 v47, v47
    v_mfma_f32_32x32x16_bf16 v[0:15], a[14:17], v[128:131], 0
    v_exp_f32 v48, v48
    v_exp_f32 v49, v49
    v_exp_f32 v50, v50
    v_exp_f32 v51, v51
    v_mfma_f32_32x32x8_bf16 v[0:15], a[26:27], v[144:145], v[0:15]
    v_exp_f32 v52, v52
    v_exp_f32 v53, v53
    v_exp_f32 v54, v54
    v_exp_f32 v55, v55
    v_smfmac_f32_32x32x32_bf16 v[96:111], a[4:7], v[32:39], v154
    v_exp_f32 v56, v56
    v_exp_f32 v57, v57
    v_exp_f32 v58, v58
    v_exp_f32 v59, v59
    v_smfmac_f32_32x32x32_bf16 v[96:111], a[8:11], v[40:47], v154
    global_load_dwordx4 a[50:53], v155, s[72:73] offset:2304 sc1
    v_exp_f32 v60, v60
    v_exp_f32 v61, v61
    v_exp_f32 v62, v62
    v_exp_f32 v63, v63
ATT_K1:
    v_mfma_f32_32x32x16_bf16 v[16:31], a[14:17], v[132:135], 0
    v_exp_f32 v0, v0
    v_exp_f32 v1, v1
    v_exp_f32 v2, v2
    v_exp_f32 v3, v3
    v_mfma_f32_32x32x8_bf16 v[16:31], a[26:27], v[146:147], v[16:31]
    v_exp_f32 v4, v4
    v_exp_f32 v5, v5
    v_exp_f32 v6, v6
    v_exp_f32 v7, v7
    v_smfmac_f32_32x32x32_bf16 v[112:127], a[4:7], v[48:55], v154
    s_add_u32 s72, s74, s60
    s_addc_u32 s73, s75, 0
    v_exp_f32 v8, v8
    v_exp_f32 v9, v9
    v_exp_f32 v10, v10
    v_exp_f32 v11, v11
    v_smfmac_f32_32x32x32_bf16 v[112:127], a[8:11], v[56:63], v154
    global_load_dwordx4 a[0:3], v252, s[72:73] offset:-3072 sc1
    v_exp_f32 v12, v12
    v_exp_f32 v13, v13
    v_exp_f32 v14, v14
    v_exp_f32 v15, v15
    v_mfma_f32_32x32x16_bf16 v[32:47], a[14:17], v[136:139], 0
    s_waitcnt vmcnt(9)
    v_exp_f32 v16, v16
    v_exp_f32 v17, v17
    v_exp_f32 v18, v18
    v_exp_f32 v19, v19
    v_mfma_f32_32x32x8_bf16 v[32:47], a[26:27], v[148:149], v[32:47]
    v_exp_f32 v20, v20
    v_exp_f32 v21, v21
    v_exp_f32 v22, v22
    v_exp_f32 v23, v23
    v_smfmac_f32_32x32x32_bf16 v[64:79], a[18:21], v[0:7], v154
    v_exp_f32 v24, v24
    v_exp_f32 v25, v25
    v_exp_f32 v26, v26
    v_exp_f32 v27, v27
    v_smfmac_f32_32x32x32_bf16 v[64:79], a[22:25], v[8:15], v154
    global_load_dwordx2 a[12:13], v152, s[72:73] offset:-2048 sc1
    v_exp_f32 v28, v28
    v_exp_f32 v29, v29
    v_exp_f32 v30, v30
    v_exp_f32 v31, v31
    v_mfma_f32_32x32x16_bf16 v[48:63], a[14:17], v[140:143], 0
    v_exp_f32 v32, v32
    v_exp_f32 v33, v33
    v_exp_f32 v34, v34
    v_exp_f32 v35, v35
    v_mfma_f32_32x32x8_bf16 v[48:63], a[26:27], v[150:151], v[48:63]
    v_exp_f32 v36, v36
    v_exp_f32 v37, v37
    v_exp_f32 v38, v38
    v_exp_f32 v39, v39
    v_smfmac_f32_32x32x32_bf16 v[80:95], a[18:21], v[16:23], v154
    v_exp_f32 v40, v40
    v_exp_f32 v41, v41
    v_exp_f32 v42, v42
    v_exp_f32 v43, v43
    v_smfmac_f32_32x32x32_bf16 v[80:95], a[22:25], v[24:31], v154
    s_waitcnt vmcnt(8)
    global_load_dwordx4 a[4:7], v155, s[72:73] offset:-1536 sc1
    v_exp_f32 v44, v44
    v_exp_f32 v45, v45
    v_exp_f32 v46, v46
    v_exp_f32 v47, v47
    v_mfma_f32_32x32x16_bf16 v[0:15], a[28:31], v[128:131], 0
    v_exp_f32 v48, v48
    v_exp_f32 v49, v49
    v_exp_f32 v50, v50
    v_exp_f32 v51, v51
    v_mfma_f32_32x32x8_bf16 v[0:15], a[40:41], v[144:145], v[0:15]
    v_exp_f32 v52, v52
    v_exp_f32 v53, v53
    v_exp_f32 v54, v54
    v_exp_f32 v55, v55
    v_smfmac_f32_32x32x32_bf16 v[96:111], a[18:21], v[32:39], v154
    v_exp_f32 v56, v56
    v_exp_f32 v57, v57
    v_exp_f32 v58, v58
    v_exp_f32 v59, v59
    v_smfmac_f32_32x32x32_bf16 v[96:111], a[22:25], v[40:47], v154
    global_load_dwordx4 a[8:11], v155, s[72:73] offset:-768 sc1
    v_exp_f32 v60, v60
    v_exp_f32 v61, v61
    v_exp_f32 v62, v62
    v_exp_f32 v63, v63
    v_mfma_f32_32x32x16_bf16 v[16:31], a[28:31], v[132:135], 0
    v_exp_f32 v0, v0
    v_exp_f32 v1, v1
    v_exp_f32 v2, v2
    v_exp_f32 v3, v3
    v_mfma_f32_32x32x8_bf16 v[16:31], a[40:41], v[146:147], v[16:31]
    v_exp_f32 v4, v4
    v_exp_f32 v5, v5
    v_exp_f32 v6, v6
    v_exp_f32 v7, v7
    v_smfmac_f32_32x32x32_bf16 v[112:127], a[18:21], v[48:55], v154
    v_exp_f32 v8, v8
    v_exp_f32 v9, v9
    v_exp_f32 v10, v10
    v_exp_f32 v11, v11
    v_smfmac_f32_32x32x32_bf16 v[112:127], a[22:25], v[56:63], v154
    global_load_dwordx4 a[14:17], v252, s[72:73] offset:0 sc1
    v_exp_f32 v12, v12
    v_exp_f32 v13, v13
    v_exp_f32 v14, v14
    v_exp_f32 v15, v15
    v_mfma_f32_32x32x16_bf16 v[32:47], a[28:31], v[136:139], 0
    s_waitcnt vmcnt(9)
    v_exp_f32 v16, v16
    v_exp_f32 v17, v17
    v_exp_f32 v18, v18
    v_exp_f32 v19, v19
    v_mfma_f32_32x32x8_bf16 v[32:47], a[40:41], v[148:149], v[32:47]
    v_exp_f32 v20, v20
    v_exp_f32 v21, v21
    v_exp_f32 v22, v22
    v_exp_f32 v23, v23
    v_smfmac_f32_32x32x32_bf16 v[64:79], a[32:35], v[0:7], v154
    v_exp_f32 v24, v24
    v_exp_f32 v25, v25
    v_exp_f32 v26, v26
    v_exp_f32 v27, v27
    v_smfmac_f32_32x32x32_bf16 v[64:79], a[36:39], v[8:15], v154
    global_load_dwordx2 a[26:27], v152, s[72:73] offset:1024 sc1
    v_exp_f32 v28, v28
    v_exp_f32 v29, v29
    v_exp_f32 v30, v30
    v_exp_f32 v31, v31
    v_mfma_f32_32x32x16_bf16 v[48:63], a[28:31], v[140:143], 0
    s_add_u32 s60, s60, 12288
    v_exp_f32 v32, v32
    v_exp_f32 v33, v33
    v_exp_f32 v34, v34
    v_exp_f32 v35, v35
    v_mfma_f32_32x32x8_bf16 v[48:63], a[40:41], v[150:151], v[48:63]
    v_exp_f32 v36, v36
    v_exp_f32 v37, v37
    v_exp_f32 v38, v38
    v_exp_f32 v39, v39
    v_smfmac_f32_32x32x32_bf16 v[80:95], a[32:35], v[16:23], v154
    s_cmp_eq_u32 s60, 196608
    s_cselect_b32 s60, 0, s60
    v_exp_f32 v40, v40
    v_exp_f32 v41, v41
    v_exp_f32 v42, v42
    v_exp_f32 v43, v43
    v_smfmac_f32_32x32x32_bf16 v[80:95], a[36:39], v[24:31], v154
    s_waitcnt vmcnt(8)
    global_load_dwordx4 a[18:21], v155, s[72:73] offset:1536 sc1
    v_exp_f32 v44, v44
    v_exp_f32 v45, v45
    v_exp_f32 v46, v46
    v_exp_f32 v47, v47
    v_mfma_f32_32x32x16_bf16 v[0:15], a[42:45], v[128:131], 0
    v_exp_f32 v48, v48
    v_exp_f32 v49, v49
    v_exp_f32 v50, v50
    v_exp_f32 v51, v51
    v_mfma_f32_32x32x8_bf16 v[0:15], a[54:55], v[144:145], v[0:15]
    v_exp_f32 v52, v52
    v_exp_f32 v53, v53
    v_exp_f32 v54, v54
    v_exp_f32 v55, v55
    v_smfmac_f32_32x32x32_bf16 v[96:111], a[32:35], v[32:39], v154
    v_exp_f32 v56, v56
    v_exp_f32 v57, v57
    v_exp_f32 v58, v58
    v_exp_f32 v59, v59
    v_smfmac_f32_32x32x32_bf16 v[96:111], a[36:39], v[40:47], v154
    global_load_dwordx4 a[22:25], v155, s[72:73] offset:2304 sc1
    v_exp_f32 v60, v60
    v_exp_f32 v61, v61
    v_exp_f32 v62, v62
    v_exp_f32 v63, v63
    v_mfma_f32_32x32x16_bf16 v[16:31], a[42:45], v[132:135], 0
    v_exp_f32 v0, v0
    v_exp_f32 v1, v1
    v_exp_f32 v2, v2
    v_exp_f32 v3, v3
    v_mfma_f32_32x32x8_bf16 v[16:31], a[54:55], v[146:147], v[16:31]
    v_exp_f32 v4, v4
    v_exp_f32 v5, v5
    v_exp_f32 v6, v6
    v_exp_f32 v7, v7
    v_smfmac_f32_32x32x32_bf16 v[112:127], a[32:35], v[48:55], v154
    s_add_u32 s72, s74, s60
    s_addc_u32 s73, s75, 0
    v_exp_f32 v8, v8
    v_exp_f32 v9, v9
    v_exp_f32 v10, v10
    v_exp_f32 v11, v11
    v_smfmac_f32_32x32x32_bf16 v[112:127], a[36:39], v[56:63], v154
    global_load_dwordx4 a[28:31], v252, s[72:73] offset:-3072 sc1
    v_exp_f32 v12, v12
    v_exp_f32 v13, v13
    v_exp_f32 v14, v14
    v_exp_f32 v15, v15
    v_mfma_f32_32x32x16_bf16 v[32:47], a[42:45], v[136:139], 0
    s_waitcnt vmcnt(9)
    v_exp_f32 v16, v16
    v_exp_f32 v17, v17
    v_exp_f32 v18, v18
    v_exp_f32 v19, v19
    v_mfma_f32_32x32x8_bf16 v[32:47], a[54:55], v[148:149], v[32:47]
    v_exp_f32 v20, v20
    v_exp_f32 v21, v21
    v_exp_f32 v22, v22
    v_exp_f32 v23, v23
    v_smfmac_f32_32x32x32_bf16 v[64:79], a[46:49], v[0:7], v154
    v_exp_f32 v24, v24
    v_exp_f32 v25, v25
    v_exp_f32 v26, v26
    v_exp_f32 v27, v27
    v_smfmac_f32_32x32x32_bf16 v[64:79], a[50:53], v[8:15], v154
    global_load_dwordx2 a[40:41], v152, s[72:73] offset:-2048 sc1
    v_exp_f32 v28, v28
    v_exp_f32 v29, v29
    v_exp_f32 v30, v30
    v_exp_f32 v31, v31
    v_mfma_f32_32x32x16_bf16 v[48:63], a[42:45], v[140:143], 0
    v_exp_f32 v32, v32
    v_exp_f32 v33, v33
    v_exp_f32 v34, v34
    v_exp_f32 v35, v35
    v_mfma_f32_32x32x8_bf16 v[48:63], a[54:55], v[150:151], v[48:63]
    v_exp_f32 v36, v36
    v_exp_f32 v37, v37
    v_exp_f32 v38, v38
    v_exp_f32 v39, v39
    v_smfmac_f32_32x32x32_bf16 v[80:95], a[46:49], v[16:23], v154
    v_exp_f32 v40, v40
    v_exp_f32 v41, v41
    v_exp_f32 v42, v42
    v_exp_f32 v43, v43
    v_smfmac_f32_32x32x32_bf16 v[80:95], a[50:53], v[24:31], v154
    s_waitcnt vmcnt(8)
    global_load_dwordx4 a[32:35], v155, s[72:73] offset:-1536 sc1
    v_exp_f32 v44, v44
    v_exp_f32 v45, v45
    v_exp_f32 v46, v46
    v_exp_f32 v47, v47
    v_mfma_f32_32x32x16_bf16 v[0:15], a[0:3], v[128:131], 0
    v_exp_f32 v48, v48
    v_exp_f32 v49, v49
    v_exp_f32 v50, v50
    v_exp_f32 v51, v51
    v_mfma_f32_32x32x8_bf16 v[0:15], a[12:13], v[144:145], v[0:15]
    v_exp_f32 v52, v52
    v_exp_f32 v53, v53
    v_exp_f32 v54, v54
    v_exp_f32 v55, v55
    v_smfmac_f32_32x32x32_bf16 v[96:111], a[46:49], v[32:39], v154
    v_exp_f32 v56, v56
    v_exp_f32 v57, v57
    v_exp_f32 v58, v58
    v_exp_f32 v59, v59
    v_smfmac_f32_32x32x32_bf16 v[96:111], a[50:53], v[40:47], v154
    global_load_dwordx4 a[36:39], v155, s[72:73] offset:-768 sc1
    v_exp_f32 v60, v60
    v_exp_f32 v61, v61
    v_exp_f32 v62, v62
    v_exp_f32 v63, v63
    v_mfma_f32_32x32x16_bf16 v[16:31], a[0:3], v[132:135], 0
    v_exp_f32 v0, v0
    v_exp_f32 v1, v1
    v_exp_f32 v2, v2
    v_exp_f32 v3, v3
    v_mfma_f32_32x32x8_bf16 v[16:31], a[12:13], v[146:147], v[16:31]
    v_exp_f32 v4, v4
    v_exp_f32 v5, v5
    v_exp_f32 v6, v6
    v_exp_f32 v7, v7
    v_smfmac_f32_32x32x32_bf16 v[112:127], a[46:49], v[48:55], v154
    v_exp_f32 v8, v8
    v_exp_f32 v9, v9
    v_exp_f32 v10, v10
    v_exp_f32 v11, v11
    v_smfmac_f32_32x32x32_bf16 v[112:127], a[50:53], v[56:63], v154
    global_load_dwordx4 a[42:45], v252, s[72:73] offset:0 sc1
    v_exp_f32 v12, v12
    v_exp_f32 v13, v13
    v_exp_f32 v14, v14
    v_exp_f32 v15, v15
    v_mfma_f32_32x32x16_bf16 v[32:47], a[0:3], v[136:139], 0
    s_waitcnt vmcnt(9)
    v_exp_f32 v16, v16
    v_exp_f32 v17, v17
    v_exp_f32 v18, v18
    v_exp_f32 v19, v19
    v_mfma_f32_32x32x8_bf16 v[32:47], a[12:13], v[148:149], v[32:47]
    v_exp_f32 v20, v20
    v_exp_f32 v21, v21
    v_exp_f32 v22, v22
    v_exp_f32 v23, v23
    v_smfmac_f32_32x32x32_bf16 v[64:79], a[4:7], v[0:7], v154
    v_exp_f32 v24, v24
    v_exp_f32 v25, v25
    v_exp_f32 v26, v26
    v_exp_f32 v27, v27
    v_smfmac_f32_32x32x32_bf16 v[64:79], a[8:11], v[8:15], v154
    global_load_dwordx2 a[54:55], v152, s[72:73] offset:1024 sc1
    v_exp_f32 v28, v28
    v_exp_f32 v29, v29
    v_exp_f32 v30, v30
    v_exp_f32 v31, v31
    v_mfma_f32_32x32x16_bf16 v[48:63], a[0:3], v[140:143], 0
    s_add_u32 s60, s60, 12288
    v_exp_f32 v32, v32
    v_exp_f32 v33, v33
    v_exp_f32 v34, v34
    v_exp_f32 v35, v35
    v_mfma_f32_32x32x8_bf16 v[48:63], a[12:13], v[150:151], v[48:63]
    v_exp_f32 v36, v36
    v_exp_f32 v37, v37
    v_exp_f32 v38, v38
    v_exp_f32 v39, v39
    v_smfmac_f32_32x32x32_bf16 v[80:95], a[4:7], v[16:23], v154
    s_cmp_eq_u32 s60, 196608
    s_cselect_b32 s60, 0, s60
    v_exp_f32 v40, v40
    v_exp_f32 v41, v41
    v_exp_f32 v42, v42
    v_exp_f32 v43, v43
    v_smfmac_f32_32x32x32_bf16 v[80:95], a[8:11], v[24:31], v154
    s_waitcnt vmcnt(8)
    global_load_dwordx4 a[46:49], v155, s[72:73] offset:1536 sc1
    v_exp_f32 v44, v44
    v_exp_f32 v45, v45
    v_exp_f32 v46, v46
    v_exp_f32 v47, v47
    v_mfma_f32_32x32x16_bf16 v[0:15], a[14:17], v[128:131], 0
    v_exp_f32 v48, v48
    v_exp_f32 v49, v49
    v_exp_f32 v50, v50
    v_exp_f32 v51, v51
    v_mfma_f32_32x32x8_bf16 v[0:15], a[26:27], v[144:145], v[0:15]
    v_exp_f32 v52, v52
    v_exp_f32 v53, v53
    v_exp_f32 v54, v54
    v_exp_f32 v55, v55
    v_smfmac_f32_32x32x32_bf16 v[96:111], a[4:7], v[32:39], v154
    v_exp_f32 v56, v56
    v_exp_f32 v57, v57
    v_exp_f32 v58, v58
    v_exp_f32 v59, v59
    v_smfmac_f32_32x32x32_bf16 v[96:111], a[8:11], v[40:47], v154
    global_load_dwordx4 a[50:53], v155, s[72:73] offset:2304 sc1
    v_exp_f32 v60, v60
    v_exp_f32 v61, v61
    v_exp_f32 v62, v62
    v_exp_f32 v63, v63
    v_mfma_f32_32x32x16_bf16 v[16:31], a[14:17], v[132:135], 0
    v_exp_f32 v0, v0
    v_exp_f32 v1, v1
    v_exp_f32 v2, v2
    v_exp_f32 v3, v3
    v_mfma_f32_32x32x8_bf16 v[16:31], a[26:27], v[146:147], v[16:31]
    v_exp_f32 v4, v4
    v_exp_f32 v5, v5
    v_exp_f32 v6, v6
    v_exp_f32 v7, v7
    v_smfmac_f32_32x32x32_bf16 v[112:127], a[4:7], v[48:55], v154
    s_add_u32 s72, s74, s60
    s_addc_u32 s73, s75, 0
    v_exp_f32 v8, v8
    v_exp_f32 v9, v9
    v_exp_f32 v10, v10
    v_exp_f32 v11, v11
    v_smfmac_f32_32x32x32_bf16 v[112:127], a[8:11], v[56:63], v154
    global_load_dwordx4 a[0:3], v252, s[72:73] offset:-3072 sc1
    v_exp_f32 v12, v12
    v_exp_f32 v13, v13
    v_exp_f32 v14, v14
    v_exp_f32 v15, v15
    v_mfma_f32_32x32x16_bf16 v[32:47], a[14:17], v[136:139], 0
    s_waitcnt vmcnt(9)
    v_exp_f32 v16, v16
    v_exp_f32 v17, v17
    v_exp_f32 v18, v18
    v_exp_f32 v19, v19
    v_mfma_f32_32x32x8_bf16 v[32:47], a[26:27], v[148:149], v[32:47]
    v_exp_f32 v20, v20
    v_exp_f32 v21, v21
    v_exp_f32 v22, v22
    v_exp_f32 v23, v23
    v_smfmac_f32_32x32x32_bf16 v[64:79], a[18:21], v[0:7], v154
    v_exp_f32 v24, v24
    v_exp_f32 v25, v25
    v_exp_f32 v26, v26
    v_exp_f32 v27, v27
    v_smfmac_f32_32x32x32_bf16 v[64:79], a[22:25], v[8:15], v154
    global_load_dwordx2 a[12:13], v152, s[72:73] offset:-2048 sc1
    v_exp_f32 v28, v28
    v_exp_f32 v29, v29
    v_exp_f32 v30, v30
    v_exp_f32 v31, v31
    v_mfma_f32_32x32x16_bf16 v[48:63], a[14:17], v[140:143], 0
    v_exp_f32 v32, v32
    v_exp_f32 v33, v33
    v_exp_f32 v34, v34
    v_exp_f32 v35, v35
    v_mfma_f32_32x32x8_bf16 v[48:63], a[26:27], v[150:151], v[48:63]
    v_exp_f32 v36, v36
    v_exp_f32 v37, v37
    v_exp_f32 v38, v38
    v_exp_f32 v39, v39
    v_smfmac_f32_32x32x32_bf16 v[80:95], a[18:21], v[16:23], v154
    v_exp_f32 v40, v40
    v_exp_f32 v41, v41
    v_exp_f32 v42, v42
    v_exp_f32 v43, v43
    v_smfmac_f32_32x32x32_bf16 v[80:95], a[22:25], v[24:31], v154
    s_waitcnt vmcnt(8)
    global_load_dwordx4 a[4:7], v155, s[72:73] offset:-1536 sc1
    v_exp_f32 v44, v44
    v_exp_f32 v45, v45
    v_exp_f32 v46, v46
    v_exp_f32 v47, v47
    v_mfma_f32_32x32x16_bf16 v[0:15], a[28:31], v[128:131], 0
    v_exp_f32 v48, v48
    v_exp_f32 v49, v49
    v_exp_f32 v50, v50
    v_exp_f32 v51, v51
    v_mfma_f32_32x32x8_bf16 v[0:15], a[40:41], v[144:145], v[0:15]
    v_exp_f32 v52, v52
    v_exp_f32 v53, v53
    v_exp_f32 v54, v54
    v_exp_f32 v55, v55
    v_smfmac_f32_32x32x32_bf16 v[96:111], a[18:21], v[32:39], v154
    v_exp_f32 v56, v56
    v_exp_f32 v57, v57
    v_exp_f32 v58, v58
    v_exp_f32 v59, v59
    v_smfmac_f32_32x32x32_bf16 v[96:111], a[22:25], v[40:47], v154
    global_load_dwordx4 a[8:11], v155, s[72:73] offset:-768 sc1
    v_exp_f32 v60, v60
    v_exp_f32 v61, v61
    v_exp_f32 v62, v62
    v_exp_f32 v63, v63
    v_mfma_f32_32x32x16_bf16 v[16:31], a[28:31], v[132:135], 0
    v_exp_f32 v0, v0
    v_exp_f32 v1, v1
    v_exp_f32 v2, v2
    v_exp_f32 v3, v3
    v_mfma_f32_32x32x8_bf16 v[16:31], a[40:41], v[146:147], v[16:31]
    v_exp_f32 v4, v4
    v_exp_f32 v5, v5
    v_exp_f32 v6, v6
    v_exp_f32 v7, v7
    v_smfmac_f32_32x32x32_bf16 v[112:127], a[18:21], v[48:55], v154
    v_exp_f32 v8, v8
    v_exp_f32 v9, v9
    v_exp_f32 v10, v10
    v_exp_f32 v11, v11
    v_smfmac_f32_32x32x32_bf16 v[112:127], a[22:25], v[56:63], v154
    global_load_dwordx4 a[14:17], v252, s[72:73] offset:0 sc1
    v_exp_f32 v12, v12
    v_exp_f32 v13, v13
    v_exp_f32 v14, v14
    v_exp_f32 v15, v15
    v_mfma_f32_32x32x16_bf16 v[32:47], a[28:31], v[136:139], 0
    s_waitcnt vmcnt(9)
    v_exp_f32 v16, v16
    v_exp_f32 v17, v17
    v_exp_f32 v18, v18
    v_exp_f32 v19, v19
    v_mfma_f32_32x32x8_bf16 v[32:47], a[40:41], v[148:149], v[32:47]
    v_exp_f32 v20, v20
    v_exp_f32 v21, v21
    v_exp_f32 v22, v22
    v_exp_f32 v23, v23
    v_smfmac_f32_32x32x32_bf16 v[64:79], a[32:35], v[0:7], v154
    v_exp_f32 v24, v24
    v_exp_f32 v25, v25
    v_exp_f32 v26, v26
    v_exp_f32 v27, v27
    v_smfmac_f32_32x32x32_bf16 v[64:79], a[36:39], v[8:15], v154
    global_load_dwordx2 a[26:27], v152, s[72:73] offset:1024 sc1
    v_exp_f32 v28, v28
    v_exp_f32 v29, v29
    v_exp_f32 v30, v30
    v_exp_f32 v31, v31
    v_mfma_f32_32x32x16_bf16 v[48:63], a[28:31], v[140:143], 0
    s_add_u32 s60, s60, 12288
    v_exp_f32 v32, v32
    v_exp_f32 v33, v33
    v_exp_f32 v34, v34
    v_exp_f32 v35, v35
    v_mfma_f32_32x32x8_bf16 v[48:63], a[40:41], v[150:151], v[48:63]
    v_exp_f32 v36, v36
    v_exp_f32 v37, v37
    v_exp_f32 v38, v38
    v_exp_f32 v39, v39
    v_smfmac_f32_32x32x32_bf16 v[80:95], a[32:35], v[16:23], v154
    s_cmp_eq_u32 s60, 196608
    s_cselect_b32 s60, 0, s60
    v_exp_f32 v40, v40
    v_exp_f32 v41, v41
    v_exp_f32 v42, v42
    v_exp_f32 v43, v43
    v_smfmac_f32_32x32x32_bf16 v[80:95], a[36:39], v[24:31], v154
    s_waitcnt vmcnt(8)
    global_load_dwordx4 a[18:21], v155, s[72:73] offset:1536 sc1
    v_exp_f32 v44, v44
    v_exp_f32 v45, v45
    v_exp_f32 v46, v46
    v_exp_f32 v47, v47
    v_mfma_f32_32x32x16_bf16 v[0:15], a[42:45], v[128:131], 0
    v_exp_f32 v48, v48
    v_exp_f32 v49, v49
    v_exp_f32 v50, v50
    v_exp_f32 v51, v51
    v_mfma_f32_32x32x8_bf16 v[0:15], a[54:55], v[144:145], v[0:15]
    v_exp_f32 v52, v52
    v_exp_f32 v53, v53
    v_exp_f32 v54, v54
    v_exp_f32 v55, v55
    v_smfmac_f32_32x32x32_bf16 v[96:111], a[32:35], v[32:39], v154
    v_exp_f32 v56, v56
    v_exp_f32 v57, v57
    v_exp_f32 v58, v58
    v_exp_f32 v59, v59
    v_smfmac_f32_32x32x32_bf16 v[96:111], a[36:39], v[40:47], v154
    global_load_dwordx4 a[22:25], v155, s[72:73] offset:2304 sc1
    v_exp_f32 v60, v60
    v_exp_f32 v61, v61
    v_exp_f32 v62, v62
    v_exp_f32 v63, v63
    v_mfma_f32_32x32x16_bf16 v[16:31], a[42:45], v[132:135], 0
    v_exp_f32 v0, v0
    v_exp_f32 v1, v1
    v_exp_f32 v2, v2
    v_exp_f32 v3, v3
    v_mfma_f32_32x32x8_bf16 v[16:31], a[54:55], v[146:147], v[16:31]
    v_exp_f32 v4, v4
    v_exp_f32 v5, v5
    v_exp_f32 v6, v6
    v_exp_f32 v7, v7
    v_smfmac_f32_32x32x32_bf16 v[112:127], a[32:35], v[48:55], v154
    s_add_u32 s72, s74, s60
    s_addc_u32 s73, s75, 0
    v_exp_f32 v8, v8
    v_exp_f32 v9, v9
    v_exp_f32 v10, v10
    v_exp_f32 v11, v11
    v_smfmac_f32_32x32x32_bf16 v[112:127], a[36:39], v[56:63], v154
    global_load_dwordx4 a[28:31], v252, s[72:73] offset:-3072 sc1
    v_exp_f32 v12, v12
    v_exp_f32 v13, v13
    v_exp_f32 v14, v14
    v_exp_f32 v15, v15
    v_mfma_f32_32x32x16_bf16 v[32:47], a[42:45], v[136:139], 0
    s_waitcnt vmcnt(9)
    v_exp_f32 v16, v16
    v_exp_f32 v17, v17
    v_exp_f32 v18, v18
    v_exp_f32 v19, v19
    v_mfma_f32_32x32x8_bf16 v[32:47], a[54:55], v[148:149], v[32:47]
    v_exp_f32 v20, v20
    v_exp_f32 v21, v21
    v_exp_f32 v22, v22
    v_exp_f32 v23, v23
    v_smfmac_f32_32x32x32_bf16 v[64:79], a[46:49], v[0:7], v154
    v_exp_f32 v24, v24
    v_exp_f32 v25, v25
    v_exp_f32 v26, v26
    v_exp_f32 v27, v27
    v_smfmac_f32_32x32x32_bf16 v[64:79], a[50:53], v[8:15], v154
    global_load_dwordx2 a[40:41], v152, s[72:73] offset:-2048 sc1
    v_exp_f32 v28, v28
    v_exp_f32 v29, v29
    v_exp_f32 v30, v30
    v_exp_f32 v31, v31
    v_mfma_f32_32x32x16_bf16 v[48:63], a[42:45], v[140:143], 0
    v_exp_f32 v32, v32
    v_exp_f32 v33, v33
    v_exp_f32 v34, v34
    v_exp_f32 v35, v35
    v_mfma_f32_32x32x8_bf16 v[48:63], a[54:55], v[150:151], v[48:63]
    v_exp_f32 v36, v36
    v_exp_f32 v37, v37
    v_exp_f32 v38, v38
    v_exp_f32 v39, v39
    v_smfmac_f32_32x32x32_bf16 v[80:95], a[46:49], v[16:23], v154
    v_exp_f32 v40, v40
    v_exp_f32 v41, v41
    v_exp_f32 v42, v42
    v_exp_f32 v43, v43
    v_smfmac_f32_32x32x32_bf16 v[80:95], a[50:53], v[24:31], v154
    s_waitcnt vmcnt(8)
    global_load_dwordx4 a[32:35], v155, s[72:73] offset:-1536 sc1
    v_exp_f32 v44, v44
    v_exp_f32 v45, v45
    v_exp_f32 v46, v46
    v_exp_f32 v47, v47
    v_mfma_f32_32x32x16_bf16 v[0:15], a[0:3], v[128:131], 0
    v_exp_f32 v48, v48
    v_exp_f32 v49, v49
    v_exp_f32 v50, v50
    v_exp_f32 v51, v51
    v_mfma_f32_32x32x8_bf16 v[0:15], a[12:13], v[144:145], v[0:15]
    v_exp_f32 v52, v52
    v_exp_f32 v53, v53
    v_exp_f32 v54, v54
    v_exp_f32 v55, v55
    v_smfmac_f32_32x32x32_bf16 v[96:111], a[46:49], v[32:39], v154
    s_sub_u32 s58, s58, 1
    s_cmp_lg_u32 s58, 0
    v_exp_f32 v56, v56
    v_exp_f32 v57, v57
    v_exp_f32 v58, v58
    v_exp_f32 v59, v59
    v_smfmac_f32_32x32x32_bf16 v[96:111], a[50:53], v[40:47], v154
    global_load_dwordx4 a[36:39], v155, s[72:73] offset:-768 sc1
    v_exp_f32 v60, v60
    v_exp_f32 v61, v61
    v_exp_f32 v62, v62
    v_exp_f32 v63, v63
    s_cbranch_scc1 ATT_LOOP
    v_smfmac_f32_32x32x32_bf16 v[112:127], a[46:49], v[48:55], v154
    v_smfmac_f32_32x32x32_bf16 v[112:127], a[50:53], v[56:63], v154
    s_mul_i32 s54, s42, 12288
    s_add_u32 s54, s54, 104448
    v_add_u32 v227, s54, v252
    s_mul_i32 s54, s42, 3072
    s_add_u32 s54, s54, 104448
    v_add_u32 v228, s54, v252
    s_mov_b32 s55, 0x71800000
    ds_write_b128 v227, v[64:67] offset:0
    ds_write_b128 v227, v[68:71] offset:1024
    ds_write_b128 v227, v[72:75] offset:2048
    ds_write_b128 v227, v[80:83] offset:3072
    ds_write_b128 v227, v[84:87] offset:4096
    ds_write_b128 v227, v[88:91] offset:5120
    ds_write_b128 v227, v[96:99] offset:6144
    ds_write_b128 v227, v[100:103] offset:7168
    ds_write_b128 v227, v[104:107] offset:8192
    ds_write_b128 v227, v[112:115] offset:9216
    ds_write_b128 v227, v[116:119] offset:10240
    ds_write_b128 v227, v[120:123] offset:11264
    v_add_f32 v0, v72, v88
    v_add_f32 v1, v104, v120
    v_add_f32 v0, v0, v1
    v_cmp_nlt_f32 vcc, v0, s55
    s_cmp_eq_u32 vcc_hi, 0
    s_cbranch_scc1 NF_36
    v_mov_b32 v229, 1
    ds_write_b32 v230, v229
NF_36:
    s_waitcnt lgkmcnt(0)
    s_barrier
    ds_read_b32 v229, v230
    ds_read_b128 v[160:163], v228 offset:0
    ds_read_b128 v[176:179], v228 offset:12288
    ds_read_b128 v[0:3], v228 offset:24576
    ds_read_b128 v[16:19], v228 offset:36864
    ds_read_b128 v[164:167], v228 offset:1024
    ds_read_b128 v[180:183], v228 offset:13312
    ds_read_b128 v[4:7], v228 offset:25600
    ds_read_b128 v[20:23], v228 offset:37888
    ds_read_b128 v[168:171], v228 offset:2048
    ds_read_b128 v[184:187], v228 offset:14336
    ds_read_b128 v[8:11], v228 offset:26624
    ds_read_b128 v[24:27], v228 offset:38912
    s_waitcnt lgkmcnt(12)
    v_readfirstlane_b32 s54, v229
    s_cmp_gt_u32 s54, s50
    s_cbranch_scc1 FALLBACK
    s_waitcnt lgkmcnt(8)
    v_pk_add_f32 v[160:161], v[160:161], v[0:1]
    v_pk_add_f32 v[176:177], v[176:177], v[16:17]
    v_pk_add_f32 v[162:163], v[162:163], v[2:3]
    v_pk_add_f32 v[178:179], v[178:179], v[18:19]
    s_waitcnt lgkmcnt(4)
    v_pk_add_f32 v[164:165], v[164:165], v[4:5]
    v_pk_add_f32 v[180:181], v[180:181], v[20:21]
    v_pk_add_f32 v[166:167], v[166:167], v[6:7]
    v_pk_add_f32 v[182:183], v[182:183], v[22:23]
    s_waitcnt lgkmcnt(0)
    v_pk_add_f32 v[168:169], v[168:169], v[8:9]
    v_pk_add_f32 v[184:185], v[184:185], v[24:25]
    v_pk_add_f32 v[170:171], v[170:171], v[10:11]
    v_pk_add_f32 v[186:187], v[186:187], v[26:27]
    s_mov_b32 s60, 0
    s_branch FIN
FALLBACK:
    s_waitcnt vmcnt(0) lgkmcnt(0)
    s_barrier
    s_mov_b32 s50, 1
    s_add_u32 s72, s24, s62
    s_addc_u32 s73, s25, 0
    s_mov_b32 s58, 64
    v_mov_b32 v160, 0xff800000
    v_cndmask_b32_e64 v144, v144, 0, s[52:53]
    v_cndmask_b32_e64 v145, v145, 0, s[52:53]
    v_mov_b32 v161, 0xff800000
    v_cndmask_b32_e64 v146, v146, 0, s[52:53]
    v_cndmask_b32_e64 v147, v147, 0, s[52:53]
    v_mov_b32 v162, 0xff800000
    v_cndmask_b32_e64 v148, v148, 0, s[52:53]
    v_cndmask_b32_e64 v149, v149, 0, s[52:53]
    v_mov_b32 v163, 0xff800000
    v_cndmask_b32_e64 v150, v150, 0, s[52:53]
    v_cndmask_b32_e64 v151, v151, 0, s[52:53]
FB_LOOP:
    global_load_dwordx4 a[14:17], v252, s[72:73] offset:0 sc1
    global_load_dwordx2 a[26:27], v152, s[72:73] offset:1024 sc1
    s_add_u32 s72, s72, 3072
    s_addc_u32 s73, s73, 0
    s_sub_u32 s58, s58, 1
    s_waitcnt vmcnt(0)
    v_mfma_f32_32x32x16_bf16 v[0:15], a[14:17], v[128:131], 0
    v_mfma_f32_32x32x8_bf16 v[0:15], a[26:27], v[144:145], v[0:15]
    v_mfma_f32_32x32x16_bf16 v[16:31], a[14:17], v[132:135], 0
    v_mfma_f32_32x32x8_bf16 v[16:31], a[26:27], v[146:147], v[16:31]
    v_mfma_f32_32x32x16_bf16 v[32:47], a[14:17], v[136:139], 0
    v_mfma_f32_32x32x8_bf16 v[32:47], a[26:27], v[148:149], v[32:47]
    v_mfma_f32_32x32x16_bf16 v[48:63], a[14:17], v[140:143], 0
    v_mfma_f32_32x32x8_bf16 v[48:63], a[26:27], v[150:151], v[48:63]
    s_nop 5
    v_max3_f32 v160, v160, v0, v1
    v_max3_f32 v160, v160, v2, v3
    v_max3_f32 v160, v160, v4, v5
    v_max3_f32 v160, v160, v6, v7
    v_max3_f32 v160, v160, v8, v9
    v_max3_f32 v160, v160, v10, v11
    v_max3_f32 v160, v160, v12, v13
    v_max3_f32 v160, v160, v14, v15
    v_max3_f32 v161, v161, v16, v17
    v_max3_f32 v161, v161, v18, v19
    v_max3_f32 v161, v161, v20, v21
    v_max3_f32 v161, v161, v22, v23
    v_max3_f32 v161, v161, v24, v25
    v_max3_f32 v161, v161, v26, v27
    v_max3_f32 v161, v161, v28, v29
    v_max3_f32 v161, v161, v30, v31
    v_max3_f32 v162, v162, v32, v33
    v_max3_f32 v162, v162, v34, v35
    v_max3_f32 v162, v162, v36, v37
    v_max3_f32 v162, v162, v38, v39
    v_max3_f32 v162, v162, v40, v41
    v_max3_f32 v162, v162, v42, v43
    v_max3_f32 v162, v162, v44, v45
    v_max3_f32 v162, v162, v46, v47
    v_max3_f32 v163, v163, v48, v49
    v_max3_f32 v163, v163, v50, v51
    v_max3_f32 v163, v163, v52, v53
    v_max3_f32 v163, v163, v54, v55
    v_max3_f32 v163, v163, v56, v57
    v_max3_f32 v163, v163, v58, v59
    v_max3_f32 v163, v163, v60, v61
    v_max3_f32 v163, v163, v62, v63
    s_cmp_lg_u32 s58, 0
    s_cbranch_scc1 FB_LOOP
    v_mov_b32 v164, v160
    s_nop 1
    v_permlane32_swap_b32 v160, v164
    v_max_f32 v164, v160, v164
    v_and_b32 v165, 0xffff0000, v164
    v_sub_f32 v166, v165, v164
    v_and_b32 v167, 0xffff0000, v166
    v_sub_f32 v166, v166, v167
    v_cvt_pk_bf16_f32 v168, -v165, v167
    v_cvt_pk_bf16_f32 v169, v166, 0
    v_cndmask_b32_e64 v144, v144, v168, s[52:53]
    v_cndmask_b32_e64 v145, v145, v169, s[52:53]
    v_mov_b32 v164, v161
    s_nop 1
    v_permlane32_swap_b32 v161, v164
    v_max_f32 v164, v161, v164
    v_and_b32 v165, 0xffff0000, v164
    v_sub_f32 v166, v165, v164
    v_and_b32 v167, 0xffff0000, v166
    v_sub_f32 v166, v166, v167
    v_cvt_pk_bf16_f32 v168, -v165, v167
    v_cvt_pk_bf16_f32 v169, v166, 0
    v_cndmask_b32_e64 v146, v146, v168, s[52:53]
    v_cndmask_b32_e64 v147, v147, v169, s[52:53]
    v_mov_b32 v164, v162
    s_nop 1
    v_permlane32_swap_b32 v162, v164
    v_max_f32 v164, v162, v164
    v_and_b32 v165, 0xffff0000, v164
    v_sub_f32 v166, v165, v164
    v_and_b32 v167, 0xffff0000, v166
    v_sub_f32 v166, v166, v167
    v_cvt_pk_bf16_f32 v168, -v165, v167
    v_cvt_pk_bf16_f32 v169, v166, 0
    v_cndmask_b32_e64 v148, v148, v168, s[52:53]
    v_cndmask_b32_e64 v149, v149, v169, s[52:53]
    v_mov_b32 v164, v163
    s_nop 1
    v_permlane32_swap_b32 v163, v164
    v_max_f32 v164, v163, v164
    v_and_b32 v165, 0xffff0000, v164
    v_sub_f32 v166, v165, v164
    v_and_b32 v167, 0xffff0000, v166
    v_sub_f32 v166, v166, v167
    v_cvt_pk_bf16_f32 v168, -v165, v167
    v_cvt_pk_bf16_f32 v169, v166, 0
    v_cndmask_b32_e64 v150, v150, v168, s[52:53]
    v_cndmask_b32_e64 v151, v151, v169, s[52:53]
    s_mul_i32 s60, s40, 12288
    s_add_u32 s72, s74, s60
    s_addc_u32 s73, s75, 0
    global_load_dwordx4 a[0:3], v252, s[72:73] offset:-3072 sc1
    global_load_dwordx2 a[12:13], v152, s[72:73] offset:-2048 sc1
    global_load_dwordx4 a[4:7], v155, s[72:73] offset:-1536 sc1
    global_load_dwordx4 a[8:11], v155, s[72:73] offset:-768 sc1
    global_load_dwordx4 a[14:17], v252, s[72:73] offset:0 sc1
    global_load_dwordx2 a[26:27], v152, s[72:73] offset:1024 sc1
    global_load_dwordx4 a[18:21], v155, s[72:73] offset:1536 sc1
    global_load_dwordx4 a[22:25], v155, s[72:73] offset:2304 sc1
    s_waitcnt vmcnt(0)
    s_branch ATT
END:
    s_endpgm
.section .rodata,"a"
.p2align 6
.amdhsa_kernel interleave_layers__linear_attn_block__softmax_full_mha__prompt_kernel
  .amdhsa_next_free_vgpr 512
  .amdhsa_next_free_sgpr 102
  .amdhsa_accum_offset 256
  .amdhsa_group_segment_fixed_size 0
  .amdhsa_kernarg_size 72
  .amdhsa_user_sgpr_count 2
  .amdhsa_user_sgpr_kernarg_segment_ptr 1
  .amdhsa_system_sgpr_workgroup_id_x 1
.end_amdhsa_kernel
```
